```python
import torch

def _softmax(x, axis=-1):
    return torch.softmax(x, dim=axis)

def _gelu(x):
    return torch.nn.functional.gelu(x, approximate='tanh')

def _silu(x):
    return torch.nn.functional.silu(x)

def _sigmoid(x):
    return torch.sigmoid(x)

def _layernorm(x, axis=-1, eps=1e-05):
    m = x.mean(dim=axis, keepdim=True)
    v = x.var(dim=axis, keepdim=True, unbiased=False)
    return (x - m) / torch.sqrt(v + eps)

def _scatter_add(tgt, idx, src, axis=0):
    return tgt.clone().index_add_(axis, idx, src)

def _segment_sum(src, seg, n):
    out = torch.zeros((n,) + src.shape[1:], dtype=src.dtype)
    return out.index_add_(0, seg, src)

def _pad(x, pw):
    flat = tuple((v for pair in reversed(pw) for v in pair))
    return torch.nn.functional.pad(x, flat)
kernel_name = 'parallel_sum__memory_aug_recurrent_mem_tr__geglu_ffn__prompt'

def setup_inputs():

    _w = lambda a: (lambda t: t.to(torch.bfloat16) if t.is_floating_point() else t)(torch.as_tensor(a))

    def _A_setup():
        B, S, Dm = (1, 2048, 512)
        H, Dh = (32, 128)
        M, seg = (8, 32)
        seg = min(seg, S)
        S = S // seg * seg
        return {'x': _w((lambda *s: torch.randn(*s, dtype=torch.bfloat16) * 0.05)(B, S, Dm)), 'mem0': _w((lambda *s: torch.randn(*s, dtype=torch.bfloat16) * 1.6)(B, M, Dm)), 'Wq': _w((lambda *s: torch.randn(*s, dtype=torch.bfloat16) * 0.8)(Dm, H, Dh) * Dm ** (-0.5)), 'Wk': _w((lambda *s: torch.randn(*s, dtype=torch.bfloat16) * 0.8)(Dm, H, Dh) * Dm ** (-0.5)), 'Wv': _w((lambda *s: torch.randn(*s, dtype=torch.bfloat16) * 1.6)(Dm, H, Dh) * Dm ** (-0.5)), 'Wo': _w((lambda *s: torch.randn(*s, dtype=torch.bfloat16) * 1.6)(H, Dh, Dm) * (H * Dh) ** (-0.5)), 'seg_len': seg}
    _A_in = _A_setup()

    def _B_setup():
        B, S, D, F = (1, 2048, 512, 1792)
        return {'x': _w((lambda *s: torch.randn(*s, dtype=torch.bfloat16) * 0.05)(B, S, D)), 'w_gate': _w((lambda *s: torch.randn(*s, dtype=torch.bfloat16) * 0.05)(D, F)), 'w_up': _w((lambda *s: torch.randn(*s, dtype=torch.bfloat16) * 0.05)(D, F)), 'w_down': _w((lambda *s: torch.randn(*s, dtype=torch.bfloat16) * 0.05)(F, D))}
    _B_in = _B_setup()
    return {'A_x': _A_in['x'], 'A_mem0': _A_in['mem0'], 'A_Wq': _A_in['Wq'], 'A_Wk': _A_in['Wk'], 'A_Wv': _A_in['Wv'], 'A_Wo': _A_in['Wo'], 'A_seg_len': _A_in['seg_len'], 'B_x': _B_in['x'], 'B_w_gate': _B_in['w_gate'], 'B_w_up': _B_in['w_up'], 'B_w_down': _B_in['w_down']}

def reference(A_x, A_mem0, A_Wq, A_Wk, A_Wv, A_Wo, A_seg_len, B_x, B_w_gate, B_w_up, B_w_down):

    def _A_ref(x, mem0, Wq, Wk, Wv, Wo, seg_len):
        B, S, Dm = x.shape
        H, Dh = (Wq.shape[1], Wq.shape[2])
        M = mem0.shape[1]
        scale = Dh ** (-0.5)
        n_seg = S // seg_len
        L = M + seg_len
        idx = torch.arange(L)
        mask = (idx[:, None] < M) | (idx[:, None] >= idx[None, :])
        mem = mem0
        outs = []
        for s in range(n_seg):
            xs = x[:, s * seg_len:(s + 1) * seg_len, :].clone()
            h = torch.concatenate([mem, xs], axis=1)
            q = torch.einsum('btd,dhe->bhte', h, Wq)
            k = torch.einsum('btd,dhe->bhte', h, Wk)
            v = torch.einsum('btd,dhe->bhte', h, Wv)
            scores = torch.einsum('bhqe,bhke->bhqk', q, k) * scale
            scores = torch.where(mask[None, None], scores, -1000000000.0)
            p = _softmax(scores, axis=-1)
            o = torch.einsum('bhqk,bhke->bhqe', p, v)
            o = torch.einsum('bhte,hed->btd', o, Wo)
            mem = o[:, :M, :].clone()
            outs.append(o[:, M:, :])
        return torch.concatenate(outs, axis=1)

    def _B_ref(x, w_gate, w_up, w_down):
        return _gelu(x @ w_gate) * (x @ w_up) @ w_down
    x = A_x
    xn = _layernorm(x, axis=-1)
    return x + _A_ref(xn, A_mem0, A_Wq, A_Wk, A_Wv, A_Wo, A_seg_len) + _B_ref(xn, B_w_gate, B_w_up, B_w_down)
```

```asm
; @launch grid=(256,1,1) block=(256,1,1) lds=163840
.amdgcn_target "amdgcn-amd-amdhsa--gfx950"
.text
.globl parallel_sum__memory_aug_recurrent_mem_tr__geglu_ffn__prompt_kernel
.p2align 8
.type parallel_sum__memory_aug_recurrent_mem_tr__geglu_ffn__prompt_kernel,@function
parallel_sum__memory_aug_recurrent_mem_tr__geglu_ffn__prompt_kernel:
    s_cmp_ge_u32 s2, 256
    s_cbranch_scc1 L_end
    s_load_dwordx16 s[44:59], s[0:1], 0
    s_load_dwordx8 s[60:67], s[0:1], 64
    s_load_dwordx4 s[68:71], s[0:1], 96
    s_getreg_b32 s3, hwreg(HW_REG_XCC_ID)
    v_lshrrev_b32 v1, 6, v0
    v_mov_b32 v4, 1
    v_readfirstlane_b32 s41, v1
    s_min_u32 s4, s3, 8
    s_lshl_b32 s4, s4, 2
    v_mov_b32 v3, s4
    s_cmp_eq_u32 s41, 0
    s_cbranch_scc1 L_noipf
    s_getpc_b64 s[6:7]
L_ipf:
    v_lshlrev_b32 v6, 7, v0
    v_mov_b32 v9, s7
    v_add_u32 v7, 4294959104, v6
    v_min_u32 v7, L_end-L_ipf, v7
    v_add_co_u32 v10, vcc, s6, v7
    s_nop 1
    v_addc_co_u32 v11, vcc, 0, v9, vcc
    global_load_dword v250, v[10:11], off
    v_add_u32 v7, 16384, v6
    v_min_u32 v7, L_end-L_ipf, v7
    v_add_co_u32 v10, vcc, s6, v7
    s_nop 1
    v_addc_co_u32 v11, vcc, 0, v9, vcc
    global_load_dword v251, v[10:11], off
    v_add_u32 v7, 40960, v6
    v_min_u32 v7, L_end-L_ipf, v7
    v_add_co_u32 v10, vcc, s6, v7
    s_nop 1
    v_addc_co_u32 v11, vcc, 0, v9, vcc
    global_load_dword v252, v[10:11], off
L_noipf:
    s_waitcnt lgkmcnt(0)
    s_mov_b32 s36, s68
    s_mov_b32 s37, s69
    s_cmp_lg_u32 s41, 0
    s_cbranch_scc1 L_notk
    s_mov_b64 exec, 1
    global_atomic_add v5, v3, v4, s[36:37] offset:0 sc0
    s_mov_b64 exec, -1
L_notk:
    s_mov_b32 s32, s44
    s_mov_b32 s33, s45
    s_mov_b32 s34, 0x200000
    s_mov_b32 s35, 0x20000
    s_mov_b32 s28, s46
    s_mov_b32 s29, s47
    s_mov_b32 s30, 0x2000
    s_mov_b32 s31, 0x20000
    s_mov_b32 s12, s48
    s_mov_b32 s13, s49
    s_mov_b32 s14, 0x400000
    s_mov_b32 s15, 0x20000
    s_mov_b32 s16, s50
    s_mov_b32 s17, s51
    s_mov_b32 s18, 0x400000
    s_mov_b32 s19, 0x20000
    s_mov_b32 s20, s52
    s_mov_b32 s21, s53
    s_mov_b32 s22, 0x400000
    s_mov_b32 s23, 0x20000
    s_mov_b32 s24, s54
    s_mov_b32 s25, s55
    s_mov_b32 s26, 0x400000
    s_mov_b32 s27, 0x20000
    s_mov_b32 s80, s60
    s_mov_b32 s81, s61
    s_mov_b32 s82, 0x1c0000
    s_mov_b32 s83, 0x20000
    s_mov_b32 s84, s62
    s_mov_b32 s85, s63
    s_mov_b32 s86, 0x1c0000
    s_mov_b32 s87, 0x20000
    s_mov_b32 s88, s64
    s_mov_b32 s89, s65
    s_mov_b32 s90, 0x1c0000
    s_mov_b32 s91, 0x20000
    s_mov_b32 s92, s66
    s_mov_b32 s93, s67
    s_mov_b32 s94, 0x200000
    s_mov_b32 s95, 0x20000
    s_mov_b32 s8, s70
    s_mov_b32 s9, s71
    s_mov_b32 s10, 0x10000000
    s_mov_b32 s11, 0x20000
    s_cmp_lg_u32 s41, 0
    s_cbranch_scc1 L_tk_wait
    s_waitcnt vmcnt(0)
L_pfd:
    s_cmp_lg_u32 s41, 0
    s_cbranch_scc1 L_tk_wait
    v_readfirstlane_b32 s5, v5
    s_lshl_b32 s38, s3, 5
    s_add_u32 s38, s38, s5
    s_cmp_ge_u32 s3, 8
    s_cbranch_scc1 L_ovf
    s_cmp_lt_u32 s5, 32
    s_cbranch_scc1 L_tk_pub
L_ovf:
    v_mov_b32 v3, 0
    s_mov_b64 exec, 1
    global_atomic_add v5, v3, v4, s[36:37] offset:192 sc0 sc1
    s_mov_b64 exec, -1
    v_lshlrev_b32 v6, 3, v0
    v_min_u32 v6, 64, v6
    s_mov_b32 s6, 0
    s_waitcnt vmcnt(0)
    v_readfirstlane_b32 s5, v5
L_ovf_poll:
    global_load_dword v7, v6, s[36:37] offset:128 sc1
    s_add_u32 s6, s6, 1
    s_cmp_gt_u32 s6, 400000
    s_cbranch_scc1 L_ovf_fail
    s_waitcnt vmcnt(0)
    v_readlane_b32 s7, v7, 8
    v_readlane_b32 s4, v7, 0
    s_bcnt1_i32_b32 s4, s4
    s_add_u32 s7, s7, s4
    v_readlane_b32 s4, v7, 1
    s_bcnt1_i32_b32 s4, s4
    s_add_u32 s7, s7, s4
    v_readlane_b32 s4, v7, 2
    s_bcnt1_i32_b32 s4, s4
    s_add_u32 s7, s7, s4
    v_readlane_b32 s4, v7, 3
    s_bcnt1_i32_b32 s4, s4
    s_add_u32 s7, s7, s4
    v_readlane_b32 s4, v7, 4
    s_bcnt1_i32_b32 s4, s4
    s_add_u32 s7, s7, s4
    v_readlane_b32 s4, v7, 5
    s_bcnt1_i32_b32 s4, s4
    s_add_u32 s7, s7, s4
    v_readlane_b32 s4, v7, 6
    s_bcnt1_i32_b32 s4, s4
    s_add_u32 s7, s7, s4
    v_readlane_b32 s4, v7, 7
    s_bcnt1_i32_b32 s4, s4
    s_add_u32 s7, s7, s4
    s_cmp_lg_u32 s7, 256
    s_cbranch_scc1 L_ovf_poll
    s_mov_b32 s6, 0
L_ovf_word:
    v_readlane_b32 s4, v7, s6
    s_bcnt0_i32_b32 s7, s4
    s_cmp_lt_u32 s5, s7
    s_cbranch_scc1 L_ovf_bit
    s_sub_u32 s5, s5, s7
    s_add_u32 s6, s6, 1
    s_cmp_lt_u32 s6, 8
    s_cbranch_scc1 L_ovf_word
L_ovf_fail:
    s_mov_b32 s38, 0x10000
    s_branch L_tk_pub
L_ovf_bit:
    s_ff0_i32_b32 s7, s4
    s_cmp_eq_u32 s5, 0
    s_cbranch_scc1 L_ovf_got
    s_bitset1_b32 s4, s7
    s_sub_u32 s5, s5, 1
    s_branch L_ovf_bit
L_ovf_got:
    s_lshl_b32 s38, s6, 5
    s_add_u32 s38, s38, s7
    s_bitset1_b32 s38, 8
L_tk_pub:
    v_mov_b32 v3, 0
    v_mov_b32 v5, s38
    ds_write_b32 v3, v5
    s_waitcnt lgkmcnt(0)
L_tk_wait:
    s_barrier
    v_mov_b32 v3, 0
    ds_read_b32 v5, v3
    s_waitcnt lgkmcnt(0)
    v_readfirstlane_b32 s38, v5
    s_barrier
    s_cmp_ge_u32 s38, 512
    s_cbranch_scc1 L_end
    s_lshr_b32 s39, s38, 8
    s_and_b32 s38, s38, 255
    s_mov_b32 s40, s38
    s_cmp_lt_u32 s38, 32
    s_cbranch_scc1 L_chain
    s_sub_u32 s47, s38, 32
    s_mul_i32 s40, s47, 9363
    s_lshr_b32 s40, s40, 16
    s_mul_i32 s48, s40, 7
    s_sub_u32 s43, s47, s48
    s_cmp_eq_u32 s43, 0
    s_cselect_b32 s44, 10, 9
    s_and_b32 s77, s41, 1
    v_and_b32 v16, 63, v0
    v_mov_b32 v25, v0
    v_lshlrev_b32 v0, 4, v16
    s_mul_i32 s47, s41, 7
    s_add_u32 s47, s47, s43
    s_lshl_b32 s48, s47, 5
    s_add_u32 s48, s48, s40
    s_lshl_b32 s48, s48, 10
    v_add_u32 v17, s48, v0
    v_mul_u32_u24 v18, 14336, v16
    s_lshl_b32 s48, s43, 11
    s_lshl_b32 s74, s40, 6
    s_add_u32 s74, s74, s48
    s_add_u32 s74, s74, 655360
    v_mov_b32 v19, 131072
    v_cmp_le_u32 vcc, s44, v16
    s_nop 1
    v_cndmask_b32 v18, v18, v19, vcc
    v_mov_b32 v19, 0
    v_cmp_ge_u32 vcc, s44, v25
    s_mov_b64 exec, vcc
    buffer_store_dword v19, v18, s[8:11], s74 offen sc1
    s_mov_b64 exec, -1
    buffer_load_dwordx4 v[32:35], v17, s[32:35], 0 offen
    v_add_u32 v17, 917504, v17
    buffer_load_dwordx4 v[36:39], v17, s[32:35], 0 offen
    v_add_u32 v17, 917504, v17
    buffer_load_dwordx4 v[40:43], v17, s[32:35], 0 offen
    v_lshrrev_b32 v20, 5, v16
    v_bfe_u32 v21, v16, 4, 1
    v_and_b32 v22, 15, v16
    v_and_b32 v23, 31, v16
    v_lshlrev_b32 v24, 4, v22
    v_lshl_add_u32 v1, v20, 8, v24
    v_lshl_add_u32 v2, v21, 11, v1
    v_lshl_add_u32 v1, v21, 10, v1
    v_lshl_add_u32 v3, v20, 8, v1
    v_mov_b32 v5, 1
    v_and_b32 v10, 3, v16
    v_lshlrev_b32 v10, 10, v10
    s_mov_b32 s58, 0x05040100
    s_mov_b32 s59, 0x07060302
    s_lshl_b32 s47, s47, 15
    s_lshl_b32 s48, s40, 4
    s_add_u32 s47, s47, s48
    s_add_u32 s47, s47, 2097152
    v_lshlrev_b32 v17, 9, v16
    v_add_u32 v17, s47, v17
    s_mov_b32 s62, 4194304
    s_mov_b32 s63, 0x20000
    s_cmp_lt_u32 s41, 2
    s_cselect_b32 s60, s16, s20
    s_cselect_b32 s61, s17, s21
    v_lshlrev_b32 v6, 16, v20
    v_lshl_add_u32 v6, v23, 2, v6
    s_lshl_b32 s47, s40, 8
    s_lshl_b32 s48, s77, 7
    s_add_u32 s47, s47, s48
    v_add_u32 v6, s47, v6
    s_mov_b32 s50, 0
    s_mov_b32 s51, 8192
    s_mov_b32 s52, 16384
    s_mov_b32 s53, 24576
    s_mov_b32 s54, 32768
    s_mov_b32 s55, 40960
    s_mov_b32 s56, 49152
    s_mov_b32 s57, 57344
    buffer_load_dword v96, v6, s[60:63], s50 offen
    buffer_load_dword v97, v6, s[60:63], s51 offen
    buffer_load_dword v98, v6, s[60:63], s52 offen
    buffer_load_dword v99, v6, s[60:63], s53 offen
    buffer_load_dword v100, v6, s[60:63], s54 offen
    buffer_load_dword v101, v6, s[60:63], s55 offen
    buffer_load_dword v102, v6, s[60:63], s56 offen
    buffer_load_dword v103, v6, s[60:63], s57 offen
    v_add_u32 v6, 131072, v6
    buffer_load_dword v104, v6, s[60:63], s50 offen
    buffer_load_dword v105, v6, s[60:63], s51 offen
    buffer_load_dword v106, v6, s[60:63], s52 offen
    buffer_load_dword v107, v6, s[60:63], s53 offen
    buffer_load_dword v108, v6, s[60:63], s54 offen
    buffer_load_dword v109, v6, s[60:63], s55 offen
    buffer_load_dword v110, v6, s[60:63], s56 offen
    buffer_load_dword v111, v6, s[60:63], s57 offen
    v_add_u32 v6, 131072, v6
    buffer_load_dword v112, v6, s[60:63], s50 offen
    buffer_load_dword v113, v6, s[60:63], s51 offen
    buffer_load_dword v114, v6, s[60:63], s52 offen
    buffer_load_dword v115, v6, s[60:63], s53 offen
    buffer_load_dword v116, v6, s[60:63], s54 offen
    buffer_load_dword v117, v6, s[60:63], s55 offen
    buffer_load_dword v118, v6, s[60:63], s56 offen
    buffer_load_dword v119, v6, s[60:63], s57 offen
    v_add_u32 v6, 131072, v6
    buffer_load_dword v120, v6, s[60:63], s50 offen
    buffer_load_dword v121, v6, s[60:63], s51 offen
    buffer_load_dword v122, v6, s[60:63], s52 offen
    buffer_load_dword v123, v6, s[60:63], s53 offen
    buffer_load_dword v124, v6, s[60:63], s54 offen
    buffer_load_dword v125, v6, s[60:63], s55 offen
    buffer_load_dword v126, v6, s[60:63], s56 offen
    buffer_load_dword v127, v6, s[60:63], s57 offen
    v_add_u32 v6, 131072, v6
    buffer_load_dword v128, v6, s[60:63], s50 offen
    buffer_load_dword v129, v6, s[60:63], s51 offen
    buffer_load_dword v130, v6, s[60:63], s52 offen
    buffer_load_dword v131, v6, s[60:63], s53 offen
    buffer_load_dword v132, v6, s[60:63], s54 offen
    buffer_load_dword v133, v6, s[60:63], s55 offen
    buffer_load_dword v134, v6, s[60:63], s56 offen
    buffer_load_dword v135, v6, s[60:63], s57 offen
    v_add_u32 v6, 131072, v6
    buffer_load_dword v136, v6, s[60:63], s50 offen
    buffer_load_dword v137, v6, s[60:63], s51 offen
    buffer_load_dword v138, v6, s[60:63], s52 offen
    buffer_load_dword v139, v6, s[60:63], s53 offen
    buffer_load_dword v140, v6, s[60:63], s54 offen
    buffer_load_dword v141, v6, s[60:63], s55 offen
    buffer_load_dword v142, v6, s[60:63], s56 offen
    buffer_load_dword v143, v6, s[60:63], s57 offen
    v_add_u32 v6, 131072, v6
    s_mov_b32 s48, 0xffff0000
    s_waitcnt vmcnt(48)
    v_lshlrev_b32 v48, 16, v32
    v_and_b32 v49, s48, v32
    v_lshlrev_b32 v50, 16, v33
    v_and_b32 v51, s48, v33
    v_lshlrev_b32 v52, 16, v34
    v_and_b32 v53, s48, v34
    v_lshlrev_b32 v54, 16, v35
    v_and_b32 v55, s48, v35
    v_pk_add_f32 v[72:73], v[48:49], v[50:51]
    v_pk_add_f32 v[78:79], v[52:53], v[54:55]
    v_pk_add_f32 v[72:73], v[72:73], v[78:79]
    v_add_f32 v72, v72, v73
    v_lshlrev_b32 v56, 16, v36
    v_and_b32 v57, s48, v36
    v_lshlrev_b32 v58, 16, v37
    v_and_b32 v59, s48, v37
    v_lshlrev_b32 v60, 16, v38
    v_and_b32 v61, s48, v38
    v_lshlrev_b32 v62, 16, v39
    v_and_b32 v63, s48, v39
    v_pk_add_f32 v[74:75], v[56:57], v[58:59]
    v_pk_add_f32 v[78:79], v[60:61], v[62:63]
    v_pk_add_f32 v[74:75], v[74:75], v[78:79]
    v_add_f32 v74, v74, v75
    v_lshlrev_b32 v64, 16, v40
    v_and_b32 v65, s48, v40
    v_lshlrev_b32 v66, 16, v41
    v_and_b32 v67, s48, v41
    v_lshlrev_b32 v68, 16, v42
    v_and_b32 v69, s48, v42
    v_lshlrev_b32 v70, 16, v43
    v_and_b32 v71, s48, v43
    v_pk_add_f32 v[76:77], v[64:65], v[66:67]
    v_pk_add_f32 v[78:79], v[68:69], v[70:71]
    v_pk_add_f32 v[76:77], v[76:77], v[78:79]
    v_add_f32 v76, v76, v77
    v_add_f32 v72, v72, v72 quad_perm:[1,0,3,2] row_mask:0xf bank_mask:0xf
    v_add_f32 v74, v74, v74 quad_perm:[1,0,3,2] row_mask:0xf bank_mask:0xf
    v_add_f32 v76, v76, v76 quad_perm:[1,0,3,2] row_mask:0xf bank_mask:0xf
    v_add_f32 v72, v72, v72 quad_perm:[2,3,0,1] row_mask:0xf bank_mask:0xf
    v_add_f32 v74, v74, v74 quad_perm:[2,3,0,1] row_mask:0xf bank_mask:0xf
    v_add_f32 v76, v76, v76 quad_perm:[2,3,0,1] row_mask:0xf bank_mask:0xf
    v_add_f32 v72, v72, v72 row_half_mirror row_mask:0xf bank_mask:0xf
    v_add_f32 v74, v74, v74 row_half_mirror row_mask:0xf bank_mask:0xf
    v_add_f32 v76, v76, v76 row_half_mirror row_mask:0xf bank_mask:0xf
    v_add_f32 v72, v72, v72 row_mirror row_mask:0xf bank_mask:0xf
    v_add_f32 v74, v74, v74 row_mirror row_mask:0xf bank_mask:0xf
    v_add_f32 v76, v76, v76 row_mirror row_mask:0xf bank_mask:0xf
    v_mov_b32 v73, v72
    v_mov_b32 v75, v74
    v_mov_b32 v77, v76
    v_permlane16_swap_b32 v72, v73
    v_permlane16_swap_b32 v74, v75
    v_permlane16_swap_b32 v76, v77
    v_add_f32 v72, v72, v73
    v_add_f32 v74, v74, v75
    v_add_f32 v76, v76, v77
    v_mov_b32 v73, v72
    v_mov_b32 v75, v74
    v_mov_b32 v77, v76
    v_permlane32_swap_b32 v72, v73
    v_permlane32_swap_b32 v74, v75
    v_permlane32_swap_b32 v76, v77
    v_add_f32 v72, v72, v73
    v_add_f32 v74, v74, v75
    v_add_f32 v76, v76, v77
    v_mul_f32 v72, 0xbb000000, v72
    v_pk_add_f32 v[48:49], v[48:49], v[72:73] op_sel_hi:[1,0]
    v_pk_add_f32 v[50:51], v[50:51], v[72:73] op_sel_hi:[1,0]
    v_pk_add_f32 v[52:53], v[52:53], v[72:73] op_sel_hi:[1,0]
    v_pk_add_f32 v[54:55], v[54:55], v[72:73] op_sel_hi:[1,0]
    v_pk_mul_f32 v[72:73], v[48:49], v[48:49]
    v_pk_fma_f32 v[72:73], v[50:51], v[50:51], v[72:73]
    v_pk_fma_f32 v[72:73], v[52:53], v[52:53], v[72:73]
    v_pk_fma_f32 v[72:73], v[54:55], v[54:55], v[72:73]
    v_add_f32 v72, v72, v73
    v_mul_f32 v74, 0xbb000000, v74
    v_pk_add_f32 v[56:57], v[56:57], v[74:75] op_sel_hi:[1,0]
    v_pk_add_f32 v[58:59], v[58:59], v[74:75] op_sel_hi:[1,0]
    v_pk_add_f32 v[60:61], v[60:61], v[74:75] op_sel_hi:[1,0]
    v_pk_add_f32 v[62:63], v[62:63], v[74:75] op_sel_hi:[1,0]
    v_pk_mul_f32 v[74:75], v[56:57], v[56:57]
    v_pk_fma_f32 v[74:75], v[58:59], v[58:59], v[74:75]
    v_pk_fma_f32 v[74:75], v[60:61], v[60:61], v[74:75]
    v_pk_fma_f32 v[74:75], v[62:63], v[62:63], v[74:75]
    v_add_f32 v74, v74, v75
    v_mul_f32 v76, 0xbb000000, v76
    v_pk_add_f32 v[64:65], v[64:65], v[76:77] op_sel_hi:[1,0]
    v_pk_add_f32 v[66:67], v[66:67], v[76:77] op_sel_hi:[1,0]
    v_pk_add_f32 v[68:69], v[68:69], v[76:77] op_sel_hi:[1,0]
    v_pk_add_f32 v[70:71], v[70:71], v[76:77] op_sel_hi:[1,0]
    v_pk_mul_f32 v[76:77], v[64:65], v[64:65]
    v_pk_fma_f32 v[76:77], v[66:67], v[66:67], v[76:77]
    v_pk_fma_f32 v[76:77], v[68:69], v[68:69], v[76:77]
    v_pk_fma_f32 v[76:77], v[70:71], v[70:71], v[76:77]
    v_add_f32 v76, v76, v77
    v_add_f32 v72, v72, v72 quad_perm:[1,0,3,2] row_mask:0xf bank_mask:0xf
    v_add_f32 v74, v74, v74 quad_perm:[1,0,3,2] row_mask:0xf bank_mask:0xf
    v_add_f32 v76, v76, v76 quad_perm:[1,0,3,2] row_mask:0xf bank_mask:0xf
    v_add_f32 v72, v72, v72 quad_perm:[2,3,0,1] row_mask:0xf bank_mask:0xf
    v_add_f32 v74, v74, v74 quad_perm:[2,3,0,1] row_mask:0xf bank_mask:0xf
    v_add_f32 v76, v76, v76 quad_perm:[2,3,0,1] row_mask:0xf bank_mask:0xf
    v_add_f32 v72, v72, v72 row_half_mirror row_mask:0xf bank_mask:0xf
    v_add_f32 v74, v74, v74 row_half_mirror row_mask:0xf bank_mask:0xf
    v_add_f32 v76, v76, v76 row_half_mirror row_mask:0xf bank_mask:0xf
    v_add_f32 v72, v72, v72 row_mirror row_mask:0xf bank_mask:0xf
    v_add_f32 v74, v74, v74 row_mirror row_mask:0xf bank_mask:0xf
    v_add_f32 v76, v76, v76 row_mirror row_mask:0xf bank_mask:0xf
    v_mov_b32 v73, v72
    v_mov_b32 v75, v74
    v_mov_b32 v77, v76
    v_permlane16_swap_b32 v72, v73
    v_permlane16_swap_b32 v74, v75
    v_permlane16_swap_b32 v76, v77
    v_add_f32 v72, v72, v73
    v_add_f32 v74, v74, v75
    v_add_f32 v76, v76, v77
    v_mov_b32 v73, v72
    v_mov_b32 v75, v74
    v_mov_b32 v77, v76
    v_permlane32_swap_b32 v72, v73
    v_permlane32_swap_b32 v74, v75
    v_permlane32_swap_b32 v76, v77
    v_add_f32 v72, v72, v73
    v_add_f32 v74, v74, v75
    v_add_f32 v76, v76, v77
    v_mov_b32 v78, 0x3727c5ac
    v_fmamk_f32 v72, v72, 0x3b000000, v78
    v_rsq_f32 v72, v72
    s_nop 0
    v_pk_mul_f32 v[48:49], v[48:49], v[72:73] op_sel_hi:[1,0]
    v_pk_mul_f32 v[50:51], v[50:51], v[72:73] op_sel_hi:[1,0]
    v_pk_mul_f32 v[52:53], v[52:53], v[72:73] op_sel_hi:[1,0]
    v_pk_mul_f32 v[54:55], v[54:55], v[72:73] op_sel_hi:[1,0]
    v_cvt_pk_bf16_f32 v32, v48, v49
    v_cvt_pk_bf16_f32 v33, v50, v51
    v_cvt_pk_bf16_f32 v34, v52, v53
    v_cvt_pk_bf16_f32 v35, v54, v55
    buffer_store_dwordx4 v[32:35], v17, s[8:11], 0 offen sc1
    v_fmamk_f32 v74, v74, 0x3b000000, v78
    v_rsq_f32 v74, v74
    s_nop 0
    v_pk_mul_f32 v[56:57], v[56:57], v[74:75] op_sel_hi:[1,0]
    v_pk_mul_f32 v[58:59], v[58:59], v[74:75] op_sel_hi:[1,0]
    v_pk_mul_f32 v[60:61], v[60:61], v[74:75] op_sel_hi:[1,0]
    v_pk_mul_f32 v[62:63], v[62:63], v[74:75] op_sel_hi:[1,0]
    v_cvt_pk_bf16_f32 v36, v56, v57
    v_cvt_pk_bf16_f32 v37, v58, v59
    v_cvt_pk_bf16_f32 v38, v60, v61
    v_cvt_pk_bf16_f32 v39, v62, v63
    v_add_u32 v17, 917504, v17
    buffer_store_dwordx4 v[36:39], v17, s[8:11], 0 offen sc1
    v_fmamk_f32 v76, v76, 0x3b000000, v78
    v_rsq_f32 v76, v76
    s_nop 0
    v_pk_mul_f32 v[64:65], v[64:65], v[76:77] op_sel_hi:[1,0]
    v_pk_mul_f32 v[66:67], v[66:67], v[76:77] op_sel_hi:[1,0]
    v_pk_mul_f32 v[68:69], v[68:69], v[76:77] op_sel_hi:[1,0]
    v_pk_mul_f32 v[70:71], v[70:71], v[76:77] op_sel_hi:[1,0]
    v_cvt_pk_bf16_f32 v40, v64, v65
    v_cvt_pk_bf16_f32 v41, v66, v67
    v_cvt_pk_bf16_f32 v42, v68, v69
    v_cvt_pk_bf16_f32 v43, v70, v71
    v_add_u32 v17, 917504, v17
    buffer_store_dwordx4 v[40:43], v17, s[8:11], 0 offen sc1
    s_cmp_lt_u32 s40, 28
    s_cselect_b32 s82, s82, 0
    s_cselect_b32 s86, s86, 0
    s_cselect_b32 s90, s90, 0
    s_mov_b32 s46, 0
    s_cmp_eq_u32 s41, 2
    s_cselect_b32 s64, 1, 0
    s_mov_b32 s65, 0
    s_mov_b32 s75, 14336
    s_mov_b32 s62, 4194304
    s_mov_b32 s63, 0x20000
    s_cmp_lt_u32 s41, 2
    s_cselect_b32 s60, s16, s20
    s_cselect_b32 s61, s17, s21
    s_branch L_wl_mid
L_pass:
    s_cmp_gt_u32 s41, 1
    s_cselect_b32 s47, s46, 0
    s_cmp_lg_u32 s47, 0
    s_cbranch_scc1 L_wl_f
    s_mov_b32 s50, 0
    s_mov_b32 s51, 8192
    s_mov_b32 s52, 16384
    s_mov_b32 s53, 24576
    s_mov_b32 s54, 32768
    s_mov_b32 s55, 40960
    s_mov_b32 s56, 49152
    s_mov_b32 s57, 57344
    v_lshlrev_b32 v6, 16, v20
    v_lshl_add_u32 v6, v23, 2, v6
    s_lshl_b32 s47, s40, 8
    s_lshl_b32 s48, s77, 7
    s_add_u32 s47, s47, s48
    v_add_u32 v6, s47, v6
    buffer_load_dword v96, v6, s[60:63], s50 offen
    buffer_load_dword v97, v6, s[60:63], s51 offen
    buffer_load_dword v98, v6, s[60:63], s52 offen
    buffer_load_dword v99, v6, s[60:63], s53 offen
    buffer_load_dword v100, v6, s[60:63], s54 offen
    buffer_load_dword v101, v6, s[60:63], s55 offen
    buffer_load_dword v102, v6, s[60:63], s56 offen
    buffer_load_dword v103, v6, s[60:63], s57 offen
    v_add_u32 v6, 131072, v6
    buffer_load_dword v104, v6, s[60:63], s50 offen
    buffer_load_dword v105, v6, s[60:63], s51 offen
    buffer_load_dword v106, v6, s[60:63], s52 offen
    buffer_load_dword v107, v6, s[60:63], s53 offen
    buffer_load_dword v108, v6, s[60:63], s54 offen
    buffer_load_dword v109, v6, s[60:63], s55 offen
    buffer_load_dword v110, v6, s[60:63], s56 offen
    buffer_load_dword v111, v6, s[60:63], s57 offen
    v_add_u32 v6, 131072, v6
    buffer_load_dword v112, v6, s[60:63], s50 offen
    buffer_load_dword v113, v6, s[60:63], s51 offen
    buffer_load_dword v114, v6, s[60:63], s52 offen
    buffer_load_dword v115, v6, s[60:63], s53 offen
    buffer_load_dword v116, v6, s[60:63], s54 offen
    buffer_load_dword v117, v6, s[60:63], s55 offen
    buffer_load_dword v118, v6, s[60:63], s56 offen
    buffer_load_dword v119, v6, s[60:63], s57 offen
    v_add_u32 v6, 131072, v6
    buffer_load_dword v120, v6, s[60:63], s50 offen
    buffer_load_dword v121, v6, s[60:63], s51 offen
    buffer_load_dword v122, v6, s[60:63], s52 offen
    buffer_load_dword v123, v6, s[60:63], s53 offen
    buffer_load_dword v124, v6, s[60:63], s54 offen
    buffer_load_dword v125, v6, s[60:63], s55 offen
    buffer_load_dword v126, v6, s[60:63], s56 offen
    buffer_load_dword v127, v6, s[60:63], s57 offen
    v_add_u32 v6, 131072, v6
    buffer_load_dword v128, v6, s[60:63], s50 offen
    buffer_load_dword v129, v6, s[60:63], s51 offen
    buffer_load_dword v130, v6, s[60:63], s52 offen
    buffer_load_dword v131, v6, s[60:63], s53 offen
    buffer_load_dword v132, v6, s[60:63], s54 offen
    buffer_load_dword v133, v6, s[60:63], s55 offen
    buffer_load_dword v134, v6, s[60:63], s56 offen
    buffer_load_dword v135, v6, s[60:63], s57 offen
    v_add_u32 v6, 131072, v6
    buffer_load_dword v136, v6, s[60:63], s50 offen
    buffer_load_dword v137, v6, s[60:63], s51 offen
    buffer_load_dword v138, v6, s[60:63], s52 offen
    buffer_load_dword v139, v6, s[60:63], s53 offen
    buffer_load_dword v140, v6, s[60:63], s54 offen
    buffer_load_dword v141, v6, s[60:63], s55 offen
    buffer_load_dword v142, v6, s[60:63], s56 offen
    buffer_load_dword v143, v6, s[60:63], s57 offen
    v_add_u32 v6, 131072, v6
L_wl_mid:
    buffer_load_dword v144, v6, s[60:63], s50 offen
    buffer_load_dword v145, v6, s[60:63], s51 offen
    buffer_load_dword v146, v6, s[60:63], s52 offen
    buffer_load_dword v147, v6, s[60:63], s53 offen
    buffer_load_dword v148, v6, s[60:63], s54 offen
    buffer_load_dword v149, v6, s[60:63], s55 offen
    buffer_load_dword v150, v6, s[60:63], s56 offen
    buffer_load_dword v151, v6, s[60:63], s57 offen
    v_add_u32 v6, 131072, v6
    s_waitcnt vmcnt(48)
    v_perm_b32 v80, v97, v96, s58
    v_perm_b32 v81, v99, v98, s58
    v_perm_b32 v82, v101, v100, s58
    v_perm_b32 v83, v103, v102, s58
    v_perm_b32 v84, v97, v96, s59
    v_perm_b32 v85, v99, v98, s59
    v_perm_b32 v86, v101, v100, s59
    v_perm_b32 v87, v103, v102, s59
    v_accvgpr_write_b32 a0, v80
    v_accvgpr_write_b32 a1, v81
    v_accvgpr_write_b32 a2, v82
    v_accvgpr_write_b32 a3, v83
    v_accvgpr_write_b32 a4, v84
    v_accvgpr_write_b32 a5, v85
    v_accvgpr_write_b32 a6, v86
    v_accvgpr_write_b32 a7, v87
    buffer_load_dword v96, v6, s[60:63], s50 offen
    buffer_load_dword v97, v6, s[60:63], s51 offen
    buffer_load_dword v98, v6, s[60:63], s52 offen
    buffer_load_dword v99, v6, s[60:63], s53 offen
    buffer_load_dword v100, v6, s[60:63], s54 offen
    buffer_load_dword v101, v6, s[60:63], s55 offen
    buffer_load_dword v102, v6, s[60:63], s56 offen
    buffer_load_dword v103, v6, s[60:63], s57 offen
    v_add_u32 v6, 131072, v6
    s_waitcnt vmcnt(48)
    v_perm_b32 v80, v105, v104, s58
    v_perm_b32 v81, v107, v106, s58
    v_perm_b32 v82, v109, v108, s58
    v_perm_b32 v83, v111, v110, s58
    v_perm_b32 v84, v105, v104, s59
    v_perm_b32 v85, v107, v106, s59
    v_perm_b32 v86, v109, v108, s59
    v_perm_b32 v87, v111, v110, s59
    v_accvgpr_write_b32 a8, v80
    v_accvgpr_write_b32 a9, v81
    v_accvgpr_write_b32 a10, v82
    v_accvgpr_write_b32 a11, v83
    v_accvgpr_write_b32 a12, v84
    v_accvgpr_write_b32 a13, v85
    v_accvgpr_write_b32 a14, v86
    v_accvgpr_write_b32 a15, v87
    buffer_load_dword v104, v6, s[60:63], s50 offen
    buffer_load_dword v105, v6, s[60:63], s51 offen
    buffer_load_dword v106, v6, s[60:63], s52 offen
    buffer_load_dword v107, v6, s[60:63], s53 offen
    buffer_load_dword v108, v6, s[60:63], s54 offen
    buffer_load_dword v109, v6, s[60:63], s55 offen
    buffer_load_dword v110, v6, s[60:63], s56 offen
    buffer_load_dword v111, v6, s[60:63], s57 offen
    v_add_u32 v6, 131072, v6
    s_waitcnt vmcnt(48)
    v_perm_b32 v80, v113, v112, s58
    v_perm_b32 v81, v115, v114, s58
    v_perm_b32 v82, v117, v116, s58
    v_perm_b32 v83, v119, v118, s58
    v_perm_b32 v84, v113, v112, s59
    v_perm_b32 v85, v115, v114, s59
    v_perm_b32 v86, v117, v116, s59
    v_perm_b32 v87, v119, v118, s59
    v_accvgpr_write_b32 a16, v80
    v_accvgpr_write_b32 a17, v81
    v_accvgpr_write_b32 a18, v82
    v_accvgpr_write_b32 a19, v83
    v_accvgpr_write_b32 a20, v84
    v_accvgpr_write_b32 a21, v85
    v_accvgpr_write_b32 a22, v86
    v_accvgpr_write_b32 a23, v87
    buffer_load_dword v112, v6, s[60:63], s50 offen
    buffer_load_dword v113, v6, s[60:63], s51 offen
    buffer_load_dword v114, v6, s[60:63], s52 offen
    buffer_load_dword v115, v6, s[60:63], s53 offen
    buffer_load_dword v116, v6, s[60:63], s54 offen
    buffer_load_dword v117, v6, s[60:63], s55 offen
    buffer_load_dword v118, v6, s[60:63], s56 offen
    buffer_load_dword v119, v6, s[60:63], s57 offen
    v_add_u32 v6, 131072, v6
    s_waitcnt vmcnt(48)
    v_perm_b32 v80, v121, v120, s58
    v_perm_b32 v81, v123, v122, s58
    v_perm_b32 v82, v125, v124, s58
    v_perm_b32 v83, v127, v126, s58
    v_perm_b32 v84, v121, v120, s59
    v_perm_b32 v85, v123, v122, s59
    v_perm_b32 v86, v125, v124, s59
    v_perm_b32 v87, v127, v126, s59
    v_accvgpr_write_b32 a24, v80
    v_accvgpr_write_b32 a25, v81
    v_accvgpr_write_b32 a26, v82
    v_accvgpr_write_b32 a27, v83
    v_accvgpr_write_b32 a28, v84
    v_accvgpr_write_b32 a29, v85
    v_accvgpr_write_b32 a30, v86
    v_accvgpr_write_b32 a31, v87
    buffer_load_dword v120, v6, s[60:63], s50 offen
    buffer_load_dword v121, v6, s[60:63], s51 offen
    buffer_load_dword v122, v6, s[60:63], s52 offen
    buffer_load_dword v123, v6, s[60:63], s53 offen
    buffer_load_dword v124, v6, s[60:63], s54 offen
    buffer_load_dword v125, v6, s[60:63], s55 offen
    buffer_load_dword v126, v6, s[60:63], s56 offen
    buffer_load_dword v127, v6, s[60:63], s57 offen
    v_add_u32 v6, 131072, v6
    s_waitcnt vmcnt(48)
    v_perm_b32 v80, v129, v128, s58
    v_perm_b32 v81, v131, v130, s58
    v_perm_b32 v82, v133, v132, s58
    v_perm_b32 v83, v135, v134, s58
    v_perm_b32 v84, v129, v128, s59
    v_perm_b32 v85, v131, v130, s59
    v_perm_b32 v86, v133, v132, s59
    v_perm_b32 v87, v135, v134, s59
    v_accvgpr_write_b32 a32, v80
    v_accvgpr_write_b32 a33, v81
    v_accvgpr_write_b32 a34, v82
    v_accvgpr_write_b32 a35, v83
    v_accvgpr_write_b32 a36, v84
    v_accvgpr_write_b32 a37, v85
    v_accvgpr_write_b32 a38, v86
    v_accvgpr_write_b32 a39, v87
    buffer_load_dword v128, v6, s[60:63], s50 offen
    buffer_load_dword v129, v6, s[60:63], s51 offen
    buffer_load_dword v130, v6, s[60:63], s52 offen
    buffer_load_dword v131, v6, s[60:63], s53 offen
    buffer_load_dword v132, v6, s[60:63], s54 offen
    buffer_load_dword v133, v6, s[60:63], s55 offen
    buffer_load_dword v134, v6, s[60:63], s56 offen
    buffer_load_dword v135, v6, s[60:63], s57 offen
    v_add_u32 v6, 131072, v6
    s_waitcnt vmcnt(48)
    v_perm_b32 v80, v137, v136, s58
    v_perm_b32 v81, v139, v138, s58
    v_perm_b32 v82, v141, v140, s58
    v_perm_b32 v83, v143, v142, s58
    v_perm_b32 v84, v137, v136, s59
    v_perm_b32 v85, v139, v138, s59
    v_perm_b32 v86, v141, v140, s59
    v_perm_b32 v87, v143, v142, s59
    v_accvgpr_write_b32 a40, v80
    v_accvgpr_write_b32 a41, v81
    v_accvgpr_write_b32 a42, v82
    v_accvgpr_write_b32 a43, v83
    v_accvgpr_write_b32 a44, v84
    v_accvgpr_write_b32 a45, v85
    v_accvgpr_write_b32 a46, v86
    v_accvgpr_write_b32 a47, v87
    buffer_load_dword v136, v6, s[60:63], s50 offen
    buffer_load_dword v137, v6, s[60:63], s51 offen
    buffer_load_dword v138, v6, s[60:63], s52 offen
    buffer_load_dword v139, v6, s[60:63], s53 offen
    buffer_load_dword v140, v6, s[60:63], s54 offen
    buffer_load_dword v141, v6, s[60:63], s55 offen
    buffer_load_dword v142, v6, s[60:63], s56 offen
    buffer_load_dword v143, v6, s[60:63], s57 offen
    v_add_u32 v6, 131072, v6
    s_waitcnt vmcnt(48)
    s_cmp_lg_u32 s46, 0
    s_cbranch_scc1 L_w_noinit
    s_barrier
    s_cmp_lg_u32 s41, 0
    s_cbranch_scc1 L_w_noinit
    s_lshr_b32 s47, s38, 5
    s_lshl_b32 s47, s47, 1
    s_add_u32 s47, s47, s39
    s_lshl_b32 s47, s47, 2
    v_mov_b32 v17, s47
    s_and_b32 s47, s38, 31
    s_lshl_b32 s47, 1, s47
    v_mov_b32 v18, s47
    s_mov_b64 exec, 1
    global_atomic_or v17, v18, s[36:37] offset:128 sc1
    s_mov_b64 exec, -1
L_w_noinit:
    v_perm_b32 v80, v145, v144, s58
    v_perm_b32 v81, v147, v146, s58
    v_perm_b32 v82, v149, v148, s58
    v_perm_b32 v83, v151, v150, s58
    v_perm_b32 v84, v145, v144, s59
    v_perm_b32 v85, v147, v146, s59
    v_perm_b32 v86, v149, v148, s59
    v_perm_b32 v87, v151, v150, s59
    v_accvgpr_write_b32 a48, v80
    v_accvgpr_write_b32 a49, v81
    v_accvgpr_write_b32 a50, v82
    v_accvgpr_write_b32 a51, v83
    v_accvgpr_write_b32 a52, v84
    v_accvgpr_write_b32 a53, v85
    v_accvgpr_write_b32 a54, v86
    v_accvgpr_write_b32 a55, v87
    buffer_load_dword v144, v6, s[60:63], s50 offen
    buffer_load_dword v145, v6, s[60:63], s51 offen
    buffer_load_dword v146, v6, s[60:63], s52 offen
    buffer_load_dword v147, v6, s[60:63], s53 offen
    buffer_load_dword v148, v6, s[60:63], s54 offen
    buffer_load_dword v149, v6, s[60:63], s55 offen
    buffer_load_dword v150, v6, s[60:63], s56 offen
    buffer_load_dword v151, v6, s[60:63], s57 offen
    v_add_u32 v6, 131072, v6
    s_waitcnt vmcnt(48)
    v_perm_b32 v80, v97, v96, s58
    v_perm_b32 v81, v99, v98, s58
    v_perm_b32 v82, v101, v100, s58
    v_perm_b32 v83, v103, v102, s58
    v_perm_b32 v84, v97, v96, s59
    v_perm_b32 v85, v99, v98, s59
    v_perm_b32 v86, v101, v100, s59
    v_perm_b32 v87, v103, v102, s59
    v_accvgpr_write_b32 a56, v80
    v_accvgpr_write_b32 a57, v81
    v_accvgpr_write_b32 a58, v82
    v_accvgpr_write_b32 a59, v83
    v_accvgpr_write_b32 a60, v84
    v_accvgpr_write_b32 a61, v85
    v_accvgpr_write_b32 a62, v86
    v_accvgpr_write_b32 a63, v87
    buffer_load_dword v96, v6, s[60:63], s50 offen
    buffer_load_dword v97, v6, s[60:63], s51 offen
    buffer_load_dword v98, v6, s[60:63], s52 offen
    buffer_load_dword v99, v6, s[60:63], s53 offen
    buffer_load_dword v100, v6, s[60:63], s54 offen
    buffer_load_dword v101, v6, s[60:63], s55 offen
    buffer_load_dword v102, v6, s[60:63], s56 offen
    buffer_load_dword v103, v6, s[60:63], s57 offen
    v_add_u32 v6, 131072, v6
    s_waitcnt vmcnt(48)
    v_perm_b32 v80, v105, v104, s58
    v_perm_b32 v81, v107, v106, s58
    v_perm_b32 v82, v109, v108, s58
    v_perm_b32 v83, v111, v110, s58
    v_perm_b32 v84, v105, v104, s59
    v_perm_b32 v85, v107, v106, s59
    v_perm_b32 v86, v109, v108, s59
    v_perm_b32 v87, v111, v110, s59
    v_accvgpr_write_b32 a64, v80
    v_accvgpr_write_b32 a65, v81
    v_accvgpr_write_b32 a66, v82
    v_accvgpr_write_b32 a67, v83
    v_accvgpr_write_b32 a68, v84
    v_accvgpr_write_b32 a69, v85
    v_accvgpr_write_b32 a70, v86
    v_accvgpr_write_b32 a71, v87
    buffer_load_dword v104, v6, s[60:63], s50 offen
    buffer_load_dword v105, v6, s[60:63], s51 offen
    buffer_load_dword v106, v6, s[60:63], s52 offen
    buffer_load_dword v107, v6, s[60:63], s53 offen
    buffer_load_dword v108, v6, s[60:63], s54 offen
    buffer_load_dword v109, v6, s[60:63], s55 offen
    buffer_load_dword v110, v6, s[60:63], s56 offen
    buffer_load_dword v111, v6, s[60:63], s57 offen
    v_add_u32 v6, 131072, v6
    s_waitcnt vmcnt(48)
    v_perm_b32 v80, v113, v112, s58
    v_perm_b32 v81, v115, v114, s58
    v_perm_b32 v82, v117, v116, s58
    v_perm_b32 v83, v119, v118, s58
    v_perm_b32 v84, v113, v112, s59
    v_perm_b32 v85, v115, v114, s59
    v_perm_b32 v86, v117, v116, s59
    v_perm_b32 v87, v119, v118, s59
    v_accvgpr_write_b32 a72, v80
    v_accvgpr_write_b32 a73, v81
    v_accvgpr_write_b32 a74, v82
    v_accvgpr_write_b32 a75, v83
    v_accvgpr_write_b32 a76, v84
    v_accvgpr_write_b32 a77, v85
    v_accvgpr_write_b32 a78, v86
    v_accvgpr_write_b32 a79, v87
    buffer_load_dword v112, v6, s[60:63], s50 offen
    buffer_load_dword v113, v6, s[60:63], s51 offen
    buffer_load_dword v114, v6, s[60:63], s52 offen
    buffer_load_dword v115, v6, s[60:63], s53 offen
    buffer_load_dword v116, v6, s[60:63], s54 offen
    buffer_load_dword v117, v6, s[60:63], s55 offen
    buffer_load_dword v118, v6, s[60:63], s56 offen
    buffer_load_dword v119, v6, s[60:63], s57 offen
    v_add_u32 v6, 131072, v6
    s_waitcnt vmcnt(48)
    v_perm_b32 v80, v121, v120, s58
    v_perm_b32 v81, v123, v122, s58
    v_perm_b32 v82, v125, v124, s58
    v_perm_b32 v83, v127, v126, s58
    v_perm_b32 v84, v121, v120, s59
    v_perm_b32 v85, v123, v122, s59
    v_perm_b32 v86, v125, v124, s59
    v_perm_b32 v87, v127, v126, s59
    v_accvgpr_write_b32 a80, v80
    v_accvgpr_write_b32 a81, v81
    v_accvgpr_write_b32 a82, v82
    v_accvgpr_write_b32 a83, v83
    v_accvgpr_write_b32 a84, v84
    v_accvgpr_write_b32 a85, v85
    v_accvgpr_write_b32 a86, v86
    v_accvgpr_write_b32 a87, v87
    buffer_load_dword v120, v6, s[60:63], s50 offen
    buffer_load_dword v121, v6, s[60:63], s51 offen
    buffer_load_dword v122, v6, s[60:63], s52 offen
    buffer_load_dword v123, v6, s[60:63], s53 offen
    buffer_load_dword v124, v6, s[60:63], s54 offen
    buffer_load_dword v125, v6, s[60:63], s55 offen
    buffer_load_dword v126, v6, s[60:63], s56 offen
    buffer_load_dword v127, v6, s[60:63], s57 offen
    v_add_u32 v6, 131072, v6
    s_waitcnt vmcnt(48)
    v_perm_b32 v80, v129, v128, s58
    v_perm_b32 v81, v131, v130, s58
    v_perm_b32 v82, v133, v132, s58
    v_perm_b32 v83, v135, v134, s58
    v_perm_b32 v84, v129, v128, s59
    v_perm_b32 v85, v131, v130, s59
    v_perm_b32 v86, v133, v132, s59
    v_perm_b32 v87, v135, v134, s59
    v_accvgpr_write_b32 a88, v80
    v_accvgpr_write_b32 a89, v81
    v_accvgpr_write_b32 a90, v82
    v_accvgpr_write_b32 a91, v83
    v_accvgpr_write_b32 a92, v84
    v_accvgpr_write_b32 a93, v85
    v_accvgpr_write_b32 a94, v86
    v_accvgpr_write_b32 a95, v87
    buffer_load_dword v128, v6, s[60:63], s50 offen
    buffer_load_dword v129, v6, s[60:63], s51 offen
    buffer_load_dword v130, v6, s[60:63], s52 offen
    buffer_load_dword v131, v6, s[60:63], s53 offen
    buffer_load_dword v132, v6, s[60:63], s54 offen
    buffer_load_dword v133, v6, s[60:63], s55 offen
    buffer_load_dword v134, v6, s[60:63], s56 offen
    buffer_load_dword v135, v6, s[60:63], s57 offen
    v_add_u32 v6, 131072, v6
    s_waitcnt vmcnt(48)
    v_perm_b32 v80, v137, v136, s58
    v_perm_b32 v81, v139, v138, s58
    v_perm_b32 v82, v141, v140, s58
    v_perm_b32 v83, v143, v142, s58
    v_perm_b32 v84, v137, v136, s59
    v_perm_b32 v85, v139, v138, s59
    v_perm_b32 v86, v141, v140, s59
    v_perm_b32 v87, v143, v142, s59
    v_accvgpr_write_b32 a96, v80
    v_accvgpr_write_b32 a97, v81
    v_accvgpr_write_b32 a98, v82
    v_accvgpr_write_b32 a99, v83
    v_accvgpr_write_b32 a100, v84
    v_accvgpr_write_b32 a101, v85
    v_accvgpr_write_b32 a102, v86
    v_accvgpr_write_b32 a103, v87
    buffer_load_dword v136, v6, s[60:63], s50 offen
    buffer_load_dword v137, v6, s[60:63], s51 offen
    buffer_load_dword v138, v6, s[60:63], s52 offen
    buffer_load_dword v139, v6, s[60:63], s53 offen
    buffer_load_dword v140, v6, s[60:63], s54 offen
    buffer_load_dword v141, v6, s[60:63], s55 offen
    buffer_load_dword v142, v6, s[60:63], s56 offen
    buffer_load_dword v143, v6, s[60:63], s57 offen
    v_add_u32 v6, 131072, v6
    s_waitcnt vmcnt(48)
    v_perm_b32 v80, v145, v144, s58
    v_perm_b32 v81, v147, v146, s58
    v_perm_b32 v82, v149, v148, s58
    v_perm_b32 v83, v151, v150, s58
    v_perm_b32 v84, v145, v144, s59
    v_perm_b32 v85, v147, v146, s59
    v_perm_b32 v86, v149, v148, s59
    v_perm_b32 v87, v151, v150, s59
    v_accvgpr_write_b32 a104, v80
    v_accvgpr_write_b32 a105, v81
    v_accvgpr_write_b32 a106, v82
    v_accvgpr_write_b32 a107, v83
    v_accvgpr_write_b32 a108, v84
    v_accvgpr_write_b32 a109, v85
    v_accvgpr_write_b32 a110, v86
    v_accvgpr_write_b32 a111, v87
    buffer_load_dword v144, v6, s[60:63], s50 offen
    buffer_load_dword v145, v6, s[60:63], s51 offen
    buffer_load_dword v146, v6, s[60:63], s52 offen
    buffer_load_dword v147, v6, s[60:63], s53 offen
    buffer_load_dword v148, v6, s[60:63], s54 offen
    buffer_load_dword v149, v6, s[60:63], s55 offen
    buffer_load_dword v150, v6, s[60:63], s56 offen
    buffer_load_dword v151, v6, s[60:63], s57 offen
    v_add_u32 v6, 131072, v6
    s_waitcnt vmcnt(48)
    v_perm_b32 v80, v97, v96, s58
    v_perm_b32 v81, v99, v98, s58
    v_perm_b32 v82, v101, v100, s58
    v_perm_b32 v83, v103, v102, s58
    v_perm_b32 v84, v97, v96, s59
    v_perm_b32 v85, v99, v98, s59
    v_perm_b32 v86, v101, v100, s59
    v_perm_b32 v87, v103, v102, s59
    v_accvgpr_write_b32 a112, v80
    v_accvgpr_write_b32 a113, v81
    v_accvgpr_write_b32 a114, v82
    v_accvgpr_write_b32 a115, v83
    v_accvgpr_write_b32 a116, v84
    v_accvgpr_write_b32 a117, v85
    v_accvgpr_write_b32 a118, v86
    v_accvgpr_write_b32 a119, v87
    buffer_load_dword v96, v6, s[60:63], s50 offen
    buffer_load_dword v97, v6, s[60:63], s51 offen
    buffer_load_dword v98, v6, s[60:63], s52 offen
    buffer_load_dword v99, v6, s[60:63], s53 offen
    buffer_load_dword v100, v6, s[60:63], s54 offen
    buffer_load_dword v101, v6, s[60:63], s55 offen
    buffer_load_dword v102, v6, s[60:63], s56 offen
    buffer_load_dword v103, v6, s[60:63], s57 offen
    v_add_u32 v6, 131072, v6
    s_waitcnt vmcnt(48)
    v_perm_b32 v80, v105, v104, s58
    v_perm_b32 v81, v107, v106, s58
    v_perm_b32 v82, v109, v108, s58
    v_perm_b32 v83, v111, v110, s58
    v_perm_b32 v84, v105, v104, s59
    v_perm_b32 v85, v107, v106, s59
    v_perm_b32 v86, v109, v108, s59
    v_perm_b32 v87, v111, v110, s59
    v_accvgpr_write_b32 a120, v80
    v_accvgpr_write_b32 a121, v81
    v_accvgpr_write_b32 a122, v82
    v_accvgpr_write_b32 a123, v83
    v_accvgpr_write_b32 a124, v84
    v_accvgpr_write_b32 a125, v85
    v_accvgpr_write_b32 a126, v86
    v_accvgpr_write_b32 a127, v87
    buffer_load_dword v104, v6, s[60:63], s50 offen
    buffer_load_dword v105, v6, s[60:63], s51 offen
    buffer_load_dword v106, v6, s[60:63], s52 offen
    buffer_load_dword v107, v6, s[60:63], s53 offen
    buffer_load_dword v108, v6, s[60:63], s54 offen
    buffer_load_dword v109, v6, s[60:63], s55 offen
    buffer_load_dword v110, v6, s[60:63], s56 offen
    buffer_load_dword v111, v6, s[60:63], s57 offen
    v_add_u32 v6, 131072, v6
    s_waitcnt vmcnt(48)
    v_perm_b32 v80, v113, v112, s58
    v_perm_b32 v81, v115, v114, s58
    v_perm_b32 v82, v117, v116, s58
    v_perm_b32 v83, v119, v118, s58
    v_perm_b32 v84, v113, v112, s59
    v_perm_b32 v85, v115, v114, s59
    v_perm_b32 v86, v117, v116, s59
    v_perm_b32 v87, v119, v118, s59
    v_accvgpr_write_b32 a128, v80
    v_accvgpr_write_b32 a129, v81
    v_accvgpr_write_b32 a130, v82
    v_accvgpr_write_b32 a131, v83
    v_accvgpr_write_b32 a132, v84
    v_accvgpr_write_b32 a133, v85
    v_accvgpr_write_b32 a134, v86
    v_accvgpr_write_b32 a135, v87
    buffer_load_dword v112, v6, s[60:63], s50 offen
    buffer_load_dword v113, v6, s[60:63], s51 offen
    buffer_load_dword v114, v6, s[60:63], s52 offen
    buffer_load_dword v115, v6, s[60:63], s53 offen
    buffer_load_dword v116, v6, s[60:63], s54 offen
    buffer_load_dword v117, v6, s[60:63], s55 offen
    buffer_load_dword v118, v6, s[60:63], s56 offen
    buffer_load_dword v119, v6, s[60:63], s57 offen
    v_add_u32 v6, 131072, v6
    s_waitcnt vmcnt(48)
    v_perm_b32 v80, v121, v120, s58
    v_perm_b32 v81, v123, v122, s58
    v_perm_b32 v82, v125, v124, s58
    v_perm_b32 v83, v127, v126, s58
    v_perm_b32 v84, v121, v120, s59
    v_perm_b32 v85, v123, v122, s59
    v_perm_b32 v86, v125, v124, s59
    v_perm_b32 v87, v127, v126, s59
    v_accvgpr_write_b32 a136, v80
    v_accvgpr_write_b32 a137, v81
    v_accvgpr_write_b32 a138, v82
    v_accvgpr_write_b32 a139, v83
    v_accvgpr_write_b32 a140, v84
    v_accvgpr_write_b32 a141, v85
    v_accvgpr_write_b32 a142, v86
    v_accvgpr_write_b32 a143, v87
    buffer_load_dword v120, v6, s[60:63], s50 offen
    buffer_load_dword v121, v6, s[60:63], s51 offen
    buffer_load_dword v122, v6, s[60:63], s52 offen
    buffer_load_dword v123, v6, s[60:63], s53 offen
    buffer_load_dword v124, v6, s[60:63], s54 offen
    buffer_load_dword v125, v6, s[60:63], s55 offen
    buffer_load_dword v126, v6, s[60:63], s56 offen
    buffer_load_dword v127, v6, s[60:63], s57 offen
    v_add_u32 v6, 131072, v6
    s_waitcnt vmcnt(48)
    v_perm_b32 v80, v129, v128, s58
    v_perm_b32 v81, v131, v130, s58
    v_perm_b32 v82, v133, v132, s58
    v_perm_b32 v83, v135, v134, s58
    v_perm_b32 v84, v129, v128, s59
    v_perm_b32 v85, v131, v130, s59
    v_perm_b32 v86, v133, v132, s59
    v_perm_b32 v87, v135, v134, s59
    v_accvgpr_write_b32 a144, v80
    v_accvgpr_write_b32 a145, v81
    v_accvgpr_write_b32 a146, v82
    v_accvgpr_write_b32 a147, v83
    v_accvgpr_write_b32 a148, v84
    v_accvgpr_write_b32 a149, v85
    v_accvgpr_write_b32 a150, v86
    v_accvgpr_write_b32 a151, v87
    buffer_load_dword v128, v6, s[60:63], s50 offen
    buffer_load_dword v129, v6, s[60:63], s51 offen
    buffer_load_dword v130, v6, s[60:63], s52 offen
    buffer_load_dword v131, v6, s[60:63], s53 offen
    buffer_load_dword v132, v6, s[60:63], s54 offen
    buffer_load_dword v133, v6, s[60:63], s55 offen
    buffer_load_dword v134, v6, s[60:63], s56 offen
    buffer_load_dword v135, v6, s[60:63], s57 offen
    v_add_u32 v6, 131072, v6
    s_waitcnt vmcnt(48)
    v_perm_b32 v80, v137, v136, s58
    v_perm_b32 v81, v139, v138, s58
    v_perm_b32 v82, v141, v140, s58
    v_perm_b32 v83, v143, v142, s58
    v_perm_b32 v84, v137, v136, s59
    v_perm_b32 v85, v139, v138, s59
    v_perm_b32 v86, v141, v140, s59
    v_perm_b32 v87, v143, v142, s59
    v_accvgpr_write_b32 a152, v80
    v_accvgpr_write_b32 a153, v81
    v_accvgpr_write_b32 a154, v82
    v_accvgpr_write_b32 a155, v83
    v_accvgpr_write_b32 a156, v84
    v_accvgpr_write_b32 a157, v85
    v_accvgpr_write_b32 a158, v86
    v_accvgpr_write_b32 a159, v87
    buffer_load_dword v136, v6, s[60:63], s50 offen
    buffer_load_dword v137, v6, s[60:63], s51 offen
    buffer_load_dword v138, v6, s[60:63], s52 offen
    buffer_load_dword v139, v6, s[60:63], s53 offen
    buffer_load_dword v140, v6, s[60:63], s54 offen
    buffer_load_dword v141, v6, s[60:63], s55 offen
    buffer_load_dword v142, v6, s[60:63], s56 offen
    buffer_load_dword v143, v6, s[60:63], s57 offen
    v_add_u32 v6, 131072, v6
    s_waitcnt vmcnt(48)
    v_perm_b32 v80, v145, v144, s58
    v_perm_b32 v81, v147, v146, s58
    v_perm_b32 v82, v149, v148, s58
    v_perm_b32 v83, v151, v150, s58
    v_perm_b32 v84, v145, v144, s59
    v_perm_b32 v85, v147, v146, s59
    v_perm_b32 v86, v149, v148, s59
    v_perm_b32 v87, v151, v150, s59
    v_accvgpr_write_b32 a160, v80
    v_accvgpr_write_b32 a161, v81
    v_accvgpr_write_b32 a162, v82
    v_accvgpr_write_b32 a163, v83
    v_accvgpr_write_b32 a164, v84
    v_accvgpr_write_b32 a165, v85
    v_accvgpr_write_b32 a166, v86
    v_accvgpr_write_b32 a167, v87
    buffer_load_dword v144, v6, s[60:63], s50 offen
    buffer_load_dword v145, v6, s[60:63], s51 offen
    buffer_load_dword v146, v6, s[60:63], s52 offen
    buffer_load_dword v147, v6, s[60:63], s53 offen
    buffer_load_dword v148, v6, s[60:63], s54 offen
    buffer_load_dword v149, v6, s[60:63], s55 offen
    buffer_load_dword v150, v6, s[60:63], s56 offen
    buffer_load_dword v151, v6, s[60:63], s57 offen
    v_add_u32 v6, 131072, v6
    s_waitcnt vmcnt(48)
    v_perm_b32 v80, v97, v96, s58
    v_perm_b32 v81, v99, v98, s58
    v_perm_b32 v82, v101, v100, s58
    v_perm_b32 v83, v103, v102, s58
    v_perm_b32 v84, v97, v96, s59
    v_perm_b32 v85, v99, v98, s59
    v_perm_b32 v86, v101, v100, s59
    v_perm_b32 v87, v103, v102, s59
    v_accvgpr_write_b32 a168, v80
    v_accvgpr_write_b32 a169, v81
    v_accvgpr_write_b32 a170, v82
    v_accvgpr_write_b32 a171, v83
    v_accvgpr_write_b32 a172, v84
    v_accvgpr_write_b32 a173, v85
    v_accvgpr_write_b32 a174, v86
    v_accvgpr_write_b32 a175, v87
    buffer_load_dword v96, v6, s[60:63], s50 offen
    buffer_load_dword v97, v6, s[60:63], s51 offen
    buffer_load_dword v98, v6, s[60:63], s52 offen
    buffer_load_dword v99, v6, s[60:63], s53 offen
    buffer_load_dword v100, v6, s[60:63], s54 offen
    buffer_load_dword v101, v6, s[60:63], s55 offen
    buffer_load_dword v102, v6, s[60:63], s56 offen
    buffer_load_dword v103, v6, s[60:63], s57 offen
    v_add_u32 v6, 131072, v6
    s_waitcnt vmcnt(48)
    v_perm_b32 v80, v105, v104, s58
    v_perm_b32 v81, v107, v106, s58
    v_perm_b32 v82, v109, v108, s58
    v_perm_b32 v83, v111, v110, s58
    v_perm_b32 v84, v105, v104, s59
    v_perm_b32 v85, v107, v106, s59
    v_perm_b32 v86, v109, v108, s59
    v_perm_b32 v87, v111, v110, s59
    v_accvgpr_write_b32 a176, v80
    v_accvgpr_write_b32 a177, v81
    v_accvgpr_write_b32 a178, v82
    v_accvgpr_write_b32 a179, v83
    v_accvgpr_write_b32 a180, v84
    v_accvgpr_write_b32 a181, v85
    v_accvgpr_write_b32 a182, v86
    v_accvgpr_write_b32 a183, v87
    buffer_load_dword v104, v6, s[60:63], s50 offen
    buffer_load_dword v105, v6, s[60:63], s51 offen
    buffer_load_dword v106, v6, s[60:63], s52 offen
    buffer_load_dword v107, v6, s[60:63], s53 offen
    buffer_load_dword v108, v6, s[60:63], s54 offen
    buffer_load_dword v109, v6, s[60:63], s55 offen
    buffer_load_dword v110, v6, s[60:63], s56 offen
    buffer_load_dword v111, v6, s[60:63], s57 offen
    v_add_u32 v6, 131072, v6
    s_waitcnt vmcnt(48)
    v_perm_b32 v80, v113, v112, s58
    v_perm_b32 v81, v115, v114, s58
    v_perm_b32 v82, v117, v116, s58
    v_perm_b32 v83, v119, v118, s58
    v_perm_b32 v84, v113, v112, s59
    v_perm_b32 v85, v115, v114, s59
    v_perm_b32 v86, v117, v116, s59
    v_perm_b32 v87, v119, v118, s59
    v_accvgpr_write_b32 a184, v80
    v_accvgpr_write_b32 a185, v81
    v_accvgpr_write_b32 a186, v82
    v_accvgpr_write_b32 a187, v83
    v_accvgpr_write_b32 a188, v84
    v_accvgpr_write_b32 a189, v85
    v_accvgpr_write_b32 a190, v86
    v_accvgpr_write_b32 a191, v87
    buffer_load_dword v112, v6, s[60:63], s50 offen
    buffer_load_dword v113, v6, s[60:63], s51 offen
    buffer_load_dword v114, v6, s[60:63], s52 offen
    buffer_load_dword v115, v6, s[60:63], s53 offen
    buffer_load_dword v116, v6, s[60:63], s54 offen
    buffer_load_dword v117, v6, s[60:63], s55 offen
    buffer_load_dword v118, v6, s[60:63], s56 offen
    buffer_load_dword v119, v6, s[60:63], s57 offen
    v_add_u32 v6, 131072, v6
    s_waitcnt vmcnt(48)
    v_perm_b32 v80, v121, v120, s58
    v_perm_b32 v81, v123, v122, s58
    v_perm_b32 v82, v125, v124, s58
    v_perm_b32 v83, v127, v126, s58
    v_perm_b32 v84, v121, v120, s59
    v_perm_b32 v85, v123, v122, s59
    v_perm_b32 v86, v125, v124, s59
    v_perm_b32 v87, v127, v126, s59
    v_accvgpr_write_b32 a192, v80
    v_accvgpr_write_b32 a193, v81
    v_accvgpr_write_b32 a194, v82
    v_accvgpr_write_b32 a195, v83
    v_accvgpr_write_b32 a196, v84
    v_accvgpr_write_b32 a197, v85
    v_accvgpr_write_b32 a198, v86
    v_accvgpr_write_b32 a199, v87
    buffer_load_dword v120, v6, s[60:63], s50 offen
    buffer_load_dword v121, v6, s[60:63], s51 offen
    buffer_load_dword v122, v6, s[60:63], s52 offen
    buffer_load_dword v123, v6, s[60:63], s53 offen
    buffer_load_dword v124, v6, s[60:63], s54 offen
    buffer_load_dword v125, v6, s[60:63], s55 offen
    buffer_load_dword v126, v6, s[60:63], s56 offen
    buffer_load_dword v127, v6, s[60:63], s57 offen
    s_waitcnt vmcnt(48)
    v_perm_b32 v80, v129, v128, s58
    v_perm_b32 v81, v131, v130, s58
    v_perm_b32 v82, v133, v132, s58
    v_perm_b32 v83, v135, v134, s58
    v_perm_b32 v84, v129, v128, s59
    v_perm_b32 v85, v131, v130, s59
    v_perm_b32 v86, v133, v132, s59
    v_perm_b32 v87, v135, v134, s59
    v_accvgpr_write_b32 a200, v80
    v_accvgpr_write_b32 a201, v81
    v_accvgpr_write_b32 a202, v82
    v_accvgpr_write_b32 a203, v83
    v_accvgpr_write_b32 a204, v84
    v_accvgpr_write_b32 a205, v85
    v_accvgpr_write_b32 a206, v86
    v_accvgpr_write_b32 a207, v87
    s_waitcnt vmcnt(40)
    v_perm_b32 v80, v137, v136, s58
    v_perm_b32 v81, v139, v138, s58
    v_perm_b32 v82, v141, v140, s58
    v_perm_b32 v83, v143, v142, s58
    v_perm_b32 v84, v137, v136, s59
    v_perm_b32 v85, v139, v138, s59
    v_perm_b32 v86, v141, v140, s59
    v_perm_b32 v87, v143, v142, s59
    v_accvgpr_write_b32 a208, v80
    v_accvgpr_write_b32 a209, v81
    v_accvgpr_write_b32 a210, v82
    v_accvgpr_write_b32 a211, v83
    v_accvgpr_write_b32 a212, v84
    v_accvgpr_write_b32 a213, v85
    v_accvgpr_write_b32 a214, v86
    v_accvgpr_write_b32 a215, v87
    s_waitcnt vmcnt(32)
    v_perm_b32 v80, v145, v144, s58
    v_perm_b32 v81, v147, v146, s58
    v_perm_b32 v82, v149, v148, s58
    v_perm_b32 v83, v151, v150, s58
    v_perm_b32 v84, v145, v144, s59
    v_perm_b32 v85, v147, v146, s59
    v_perm_b32 v86, v149, v148, s59
    v_perm_b32 v87, v151, v150, s59
    v_accvgpr_write_b32 a216, v80
    v_accvgpr_write_b32 a217, v81
    v_accvgpr_write_b32 a218, v82
    v_accvgpr_write_b32 a219, v83
    v_accvgpr_write_b32 a220, v84
    v_accvgpr_write_b32 a221, v85
    v_accvgpr_write_b32 a222, v86
    v_accvgpr_write_b32 a223, v87
    s_waitcnt vmcnt(24)
    v_perm_b32 v80, v97, v96, s58
    v_perm_b32 v81, v99, v98, s58
    v_perm_b32 v82, v101, v100, s58
    v_perm_b32 v83, v103, v102, s58
    v_perm_b32 v84, v97, v96, s59
    v_perm_b32 v85, v99, v98, s59
    v_perm_b32 v86, v101, v100, s59
    v_perm_b32 v87, v103, v102, s59
    v_accvgpr_write_b32 a224, v80
    v_accvgpr_write_b32 a225, v81
    v_accvgpr_write_b32 a226, v82
    v_accvgpr_write_b32 a227, v83
    v_accvgpr_write_b32 a228, v84
    v_accvgpr_write_b32 a229, v85
    v_accvgpr_write_b32 a230, v86
    v_accvgpr_write_b32 a231, v87
    s_waitcnt vmcnt(16)
    v_perm_b32 v80, v105, v104, s58
    v_perm_b32 v81, v107, v106, s58
    v_perm_b32 v82, v109, v108, s58
    v_perm_b32 v83, v111, v110, s58
    v_perm_b32 v84, v105, v104, s59
    v_perm_b32 v85, v107, v106, s59
    v_perm_b32 v86, v109, v108, s59
    v_perm_b32 v87, v111, v110, s59
    v_accvgpr_write_b32 a232, v80
    v_accvgpr_write_b32 a233, v81
    v_accvgpr_write_b32 a234, v82
    v_accvgpr_write_b32 a235, v83
    v_accvgpr_write_b32 a236, v84
    v_accvgpr_write_b32 a237, v85
    v_accvgpr_write_b32 a238, v86
    v_accvgpr_write_b32 a239, v87
    s_waitcnt vmcnt(8)
    v_perm_b32 v80, v113, v112, s58
    v_perm_b32 v81, v115, v114, s58
    v_perm_b32 v82, v117, v116, s58
    v_perm_b32 v83, v119, v118, s58
    v_perm_b32 v84, v113, v112, s59
    v_perm_b32 v85, v115, v114, s59
    v_perm_b32 v86, v117, v116, s59
    v_perm_b32 v87, v119, v118, s59
    v_accvgpr_write_b32 a240, v80
    v_accvgpr_write_b32 a241, v81
    v_accvgpr_write_b32 a242, v82
    v_accvgpr_write_b32 a243, v83
    v_accvgpr_write_b32 a244, v84
    v_accvgpr_write_b32 a245, v85
    v_accvgpr_write_b32 a246, v86
    v_accvgpr_write_b32 a247, v87
    s_waitcnt vmcnt(0)
    v_perm_b32 v80, v121, v120, s58
    v_perm_b32 v81, v123, v122, s58
    v_perm_b32 v82, v125, v124, s58
    v_perm_b32 v83, v127, v126, s58
    v_perm_b32 v84, v121, v120, s59
    v_perm_b32 v85, v123, v122, s59
    v_perm_b32 v86, v125, v124, s59
    v_perm_b32 v87, v127, v126, s59
    v_accvgpr_write_b32 a248, v80
    v_accvgpr_write_b32 a249, v81
    v_accvgpr_write_b32 a250, v82
    v_accvgpr_write_b32 a251, v83
    v_accvgpr_write_b32 a252, v84
    v_accvgpr_write_b32 a253, v85
    v_accvgpr_write_b32 a254, v86
    v_accvgpr_write_b32 a255, v87
L_wl_done:
    s_cmp_lg_u32 s46, 0
    s_cbranch_scc1 L_w_nowait
    v_and_b32 v17, 7, v16
    v_lshlrev_b32 v17, 3, v17
    s_mov_b32 s49, 0
L_w_wi:
    global_load_dwordx2 v[18:19], v17, s[36:37] offset:128 sc1
    s_add_u32 s49, s49, 1
    s_cmp_gt_u32 s49, 400000
    s_cbranch_scc1 L_end
    s_waitcnt vmcnt(0)
    v_or_b32 v19, v18, v19
    v_cmp_ne_u32 vcc, -1, v19
    s_cbranch_vccnz L_w_wi
L_w_nowait:
    s_lshl_b32 s70, s43, 15
    s_lshl_b32 s69, s41, 13
    s_add_u32 s70, s70, s69
    s_add_u32 s70, s70, 2097152
    s_add_u32 m0, s69, 0
    s_nop 0
    buffer_load_dwordx4 v0, s[8:11], s70 offen offset:0 sc1 lds
    buffer_load_dwordx4 v0, s[8:11], s70 offen offset:1024 sc1 lds
    buffer_load_dwordx4 v0, s[8:11], s70 offen offset:2048 sc1 lds
    buffer_load_dwordx4 v0, s[8:11], s70 offen offset:3072 sc1 lds
    s_add_u32 m0, s69, 4096
    s_add_u32 s48, s70, 4096
    buffer_load_dwordx4 v0, s[8:11], s48 offen offset:0 sc1 lds
    buffer_load_dwordx4 v0, s[8:11], s48 offen offset:1024 sc1 lds
    buffer_load_dwordx4 v0, s[8:11], s48 offen offset:2048 sc1 lds
    buffer_load_dwordx4 v0, s[8:11], s48 offen offset:3072 sc1 lds
    s_add_u32 s70, s70, 229376
    s_add_u32 s69, s69, 32768
    s_add_u32 m0, s69, 0
    s_nop 0
    buffer_load_dwordx4 v0, s[8:11], s70 offen offset:0 sc1 lds
    buffer_load_dwordx4 v0, s[8:11], s70 offen offset:1024 sc1 lds
    buffer_load_dwordx4 v0, s[8:11], s70 offen offset:2048 sc1 lds
    buffer_load_dwordx4 v0, s[8:11], s70 offen offset:3072 sc1 lds
    s_add_u32 m0, s69, 4096
    s_add_u32 s48, s70, 4096
    buffer_load_dwordx4 v0, s[8:11], s48 offen offset:0 sc1 lds
    buffer_load_dwordx4 v0, s[8:11], s48 offen offset:1024 sc1 lds
    buffer_load_dwordx4 v0, s[8:11], s48 offen offset:2048 sc1 lds
    buffer_load_dwordx4 v0, s[8:11], s48 offen offset:3072 sc1 lds
    s_add_u32 s70, s70, 229376
    s_add_u32 s69, s69, 32768
    s_mov_b32 s68, 0
    s_mov_b32 s45, 0
    s_lshl_b32 s47, s43, 5
    s_add_u32 s47, s47, s40
    s_lshl_b32 s71, s47, 14
    s_lshl_b32 s76, s47, 12
    s_lshl_b32 s48, s77, 11
    s_add_u32 s76, s76, s48
    s_add_u32 s76, s76, 8388608
    s_add_u32 s48, s71, 50343936
    s_cmp_lg_u32 s46, 0
    s_cselect_b32 s73, s73, s48
    s_cselect_b32 s74, s48, s74
    s_cselect_b32 s47, 33554432, 0
    s_add_u32 s71, s71, s47
    s_add_u32 s71, s71, 16777216
    s_lshl_b32 s47, s41, 12
    s_waitcnt vmcnt(8)
    s_barrier
    s_cmp_lt_u32 s41, 2
    s_cbranch_scc1 L_go_k
    s_cmp_lg_u32 s46, 0
    s_cbranch_scc1 L_go_f
    s_add_u32 s71, s71, s47
L_p1_v:
    v_add_u32 v4, s68, v0
    ds_read_b128 v[64:67], v4 offset:0
    ds_read_b128 v[68:71], v4 offset:1024
    ds_read_b128 v[72:75], v4 offset:2048
    ds_read_b128 v[76:79], v4 offset:3072
    ds_read_b128 v[80:83], v4 offset:4096
    s_waitcnt lgkmcnt(4)
    v_mfma_f32_32x32x16_bf16 v[32:47], v[64:67], a[0:3], 0
    ds_read_b128 v[84:87], v4 offset:5120
    v_mfma_f32_32x32x16_bf16 v[48:63], v[64:67], a[4:7], 0
    s_waitcnt lgkmcnt(4)
    v_mfma_f32_32x32x16_bf16 v[32:47], v[68:71], a[8:11], v[32:47]
    ds_read_b128 v[64:67], v4 offset:6144
    v_mfma_f32_32x32x16_bf16 v[48:63], v[68:71], a[12:15], v[48:63]
    s_waitcnt lgkmcnt(4)
    v_mfma_f32_32x32x16_bf16 v[32:47], v[72:75], a[16:19], v[32:47]
    ds_read_b128 v[68:71], v4 offset:7168
    v_mfma_f32_32x32x16_bf16 v[48:63], v[72:75], a[20:23], v[48:63]
    s_waitcnt lgkmcnt(4)
    v_mfma_f32_32x32x16_bf16 v[32:47], v[76:79], a[24:27], v[32:47]
    ds_read_b128 v[72:75], v4 offset:8192
    v_mfma_f32_32x32x16_bf16 v[48:63], v[76:79], a[28:31], v[48:63]
    s_waitcnt lgkmcnt(4)
    v_mfma_f32_32x32x16_bf16 v[32:47], v[80:83], a[32:35], v[32:47]
    ds_read_b128 v[76:79], v4 offset:9216
    v_mfma_f32_32x32x16_bf16 v[48:63], v[80:83], a[36:39], v[48:63]
    s_waitcnt lgkmcnt(4)
    v_mfma_f32_32x32x16_bf16 v[32:47], v[84:87], a[40:43], v[32:47]
    ds_read_b128 v[80:83], v4 offset:10240
    v_mfma_f32_32x32x16_bf16 v[48:63], v[84:87], a[44:47], v[48:63]
    s_waitcnt lgkmcnt(4)
    v_mfma_f32_32x32x16_bf16 v[32:47], v[64:67], a[48:51], v[32:47]
    ds_read_b128 v[84:87], v4 offset:11264
    v_mfma_f32_32x32x16_bf16 v[48:63], v[64:67], a[52:55], v[48:63]
    s_waitcnt lgkmcnt(4)
    v_mfma_f32_32x32x16_bf16 v[32:47], v[68:71], a[56:59], v[32:47]
    ds_read_b128 v[64:67], v4 offset:12288
    v_mfma_f32_32x32x16_bf16 v[48:63], v[68:71], a[60:63], v[48:63]
    s_waitcnt lgkmcnt(4)
    v_mfma_f32_32x32x16_bf16 v[32:47], v[72:75], a[64:67], v[32:47]
    ds_read_b128 v[68:71], v4 offset:13312
    v_mfma_f32_32x32x16_bf16 v[48:63], v[72:75], a[68:71], v[48:63]
    s_waitcnt lgkmcnt(4)
    v_mfma_f32_32x32x16_bf16 v[32:47], v[76:79], a[72:75], v[32:47]
    ds_read_b128 v[72:75], v4 offset:14336
    v_mfma_f32_32x32x16_bf16 v[48:63], v[76:79], a[76:79], v[48:63]
    s_waitcnt lgkmcnt(4)
    v_mfma_f32_32x32x16_bf16 v[32:47], v[80:83], a[80:83], v[32:47]
    ds_read_b128 v[76:79], v4 offset:15360
    v_mfma_f32_32x32x16_bf16 v[48:63], v[80:83], a[84:87], v[48:63]
    s_waitcnt lgkmcnt(4)
    v_mfma_f32_32x32x16_bf16 v[32:47], v[84:87], a[88:91], v[32:47]
    ds_read_b128 v[80:83], v4 offset:16384
    v_mfma_f32_32x32x16_bf16 v[48:63], v[84:87], a[92:95], v[48:63]
    s_waitcnt lgkmcnt(4)
    v_mfma_f32_32x32x16_bf16 v[32:47], v[64:67], a[96:99], v[32:47]
    ds_read_b128 v[84:87], v4 offset:17408
    v_mfma_f32_32x32x16_bf16 v[48:63], v[64:67], a[100:103], v[48:63]
    s_waitcnt lgkmcnt(4)
    v_mfma_f32_32x32x16_bf16 v[32:47], v[68:71], a[104:107], v[32:47]
    ds_read_b128 v[64:67], v4 offset:18432
    v_mfma_f32_32x32x16_bf16 v[48:63], v[68:71], a[108:111], v[48:63]
    s_waitcnt lgkmcnt(4)
    v_mfma_f32_32x32x16_bf16 v[32:47], v[72:75], a[112:115], v[32:47]
    ds_read_b128 v[68:71], v4 offset:19456
    v_mfma_f32_32x32x16_bf16 v[48:63], v[72:75], a[116:119], v[48:63]
    s_waitcnt lgkmcnt(4)
    v_mfma_f32_32x32x16_bf16 v[32:47], v[76:79], a[120:123], v[32:47]
    ds_read_b128 v[72:75], v4 offset:20480
    v_mfma_f32_32x32x16_bf16 v[48:63], v[76:79], a[124:127], v[48:63]
    s_waitcnt lgkmcnt(4)
    v_mfma_f32_32x32x16_bf16 v[32:47], v[80:83], a[128:131], v[32:47]
    ds_read_b128 v[76:79], v4 offset:21504
    v_mfma_f32_32x32x16_bf16 v[48:63], v[80:83], a[132:135], v[48:63]
    s_waitcnt vmcnt(0)
    s_barrier
    s_mov_b64 exec, s[64:65]
    buffer_store_dword v5, off, s[8:11], s73 sc1
    s_mov_b64 exec, -1
    s_waitcnt lgkmcnt(4)
    v_mfma_f32_32x32x16_bf16 v[32:47], v[84:87], a[136:139], v[32:47]
    ds_read_b128 v[80:83], v4 offset:22528
    v_mfma_f32_32x32x16_bf16 v[48:63], v[84:87], a[140:143], v[48:63]
    s_add_u32 m0, s69, 0
    s_nop 0
    buffer_load_dwordx4 v0, s[8:11], s70 offen offset:0 sc1 lds
    buffer_load_dwordx4 v0, s[8:11], s70 offen offset:1024 sc1 lds
    s_waitcnt lgkmcnt(4)
    v_mfma_f32_32x32x16_bf16 v[32:47], v[64:67], a[144:147], v[32:47]
    ds_read_b128 v[84:87], v4 offset:23552
    v_mfma_f32_32x32x16_bf16 v[48:63], v[64:67], a[148:151], v[48:63]
    buffer_load_dwordx4 v0, s[8:11], s70 offen offset:2048 sc1 lds
    buffer_load_dwordx4 v0, s[8:11], s70 offen offset:3072 sc1 lds
    s_waitcnt lgkmcnt(4)
    v_mfma_f32_32x32x16_bf16 v[32:47], v[68:71], a[152:155], v[32:47]
    ds_read_b128 v[64:67], v4 offset:24576
    v_mfma_f32_32x32x16_bf16 v[48:63], v[68:71], a[156:159], v[48:63]
    s_add_u32 m0, s69, 4096
    s_add_u32 s48, s70, 4096
    buffer_load_dwordx4 v0, s[8:11], s48 offen offset:0 sc1 lds
    buffer_load_dwordx4 v0, s[8:11], s48 offen offset:1024 sc1 lds
    s_waitcnt lgkmcnt(4)
    v_mfma_f32_32x32x16_bf16 v[32:47], v[72:75], a[160:163], v[32:47]
    ds_read_b128 v[68:71], v4 offset:25600
    v_mfma_f32_32x32x16_bf16 v[48:63], v[72:75], a[164:167], v[48:63]
    buffer_load_dwordx4 v0, s[8:11], s48 offen offset:2048 sc1 lds
    buffer_load_dwordx4 v0, s[8:11], s48 offen offset:3072 sc1 lds
    s_waitcnt lgkmcnt(4)
    v_mfma_f32_32x32x16_bf16 v[32:47], v[76:79], a[168:171], v[32:47]
    ds_read_b128 v[72:75], v4 offset:26624
    v_mfma_f32_32x32x16_bf16 v[48:63], v[76:79], a[172:175], v[48:63]
    s_waitcnt lgkmcnt(4)
    v_mfma_f32_32x32x16_bf16 v[32:47], v[80:83], a[176:179], v[32:47]
    ds_read_b128 v[76:79], v4 offset:27648
    v_mfma_f32_32x32x16_bf16 v[48:63], v[80:83], a[180:183], v[48:63]
    s_mov_b32 s73, s74
    s_add_u32 s74, s74, s75
    s_add_u32 s70, s70, 229376
    s_lshl_b32 s47, s41, 13
    s_add_u32 s69, s68, s47
    s_waitcnt lgkmcnt(4)
    v_mfma_f32_32x32x16_bf16 v[32:47], v[84:87], a[184:187], v[32:47]
    ds_read_b128 v[80:83], v4 offset:28672
    v_mfma_f32_32x32x16_bf16 v[48:63], v[84:87], a[188:191], v[48:63]
    s_add_u32 s68, s68, 32768
    s_cmp_eq_u32 s68, 98304
    s_cselect_b32 s68, 0, s68
    s_add_u32 s45, s45, 1
    s_waitcnt lgkmcnt(4)
    v_mfma_f32_32x32x16_bf16 v[32:47], v[64:67], a[192:195], v[32:47]
    ds_read_b128 v[84:87], v4 offset:29696
    v_mfma_f32_32x32x16_bf16 v[48:63], v[64:67], a[196:199], v[48:63]
    v_mov_b64 v[88:89], -1
    v_mov_b64 v[90:91], -1
    buffer_store_dwordx4 v[88:91], v0, s[8:11], s76 offen sc1
    s_waitcnt lgkmcnt(4)
    v_mfma_f32_32x32x16_bf16 v[32:47], v[68:71], a[200:203], v[32:47]
    ds_read_b128 v[64:67], v4 offset:30720
    v_mfma_f32_32x32x16_bf16 v[48:63], v[68:71], a[204:207], v[48:63]
    s_waitcnt lgkmcnt(4)
    v_mfma_f32_32x32x16_bf16 v[32:47], v[72:75], a[208:211], v[32:47]
    ds_read_b128 v[68:71], v4 offset:31744
    v_mfma_f32_32x32x16_bf16 v[48:63], v[72:75], a[212:215], v[48:63]
    buffer_store_dwordx4 v[88:91], v0, s[8:11], s76 offen offset:1024 sc1
    s_add_u32 s76, s76, 917504
    s_waitcnt lgkmcnt(4)
    v_mfma_f32_32x32x16_bf16 v[32:47], v[76:79], a[216:219], v[32:47]
    v_mfma_f32_32x32x16_bf16 v[48:63], v[76:79], a[220:223], v[48:63]
    s_waitcnt lgkmcnt(3)
    v_mfma_f32_32x32x16_bf16 v[32:47], v[80:83], a[224:227], v[32:47]
    v_mfma_f32_32x32x16_bf16 v[48:63], v[80:83], a[228:231], v[48:63]
    s_waitcnt lgkmcnt(2)
    v_mfma_f32_32x32x16_bf16 v[32:47], v[84:87], a[232:235], v[32:47]
    v_mfma_f32_32x32x16_bf16 v[48:63], v[84:87], a[236:239], v[48:63]
    s_waitcnt lgkmcnt(1)
    v_mfma_f32_32x32x16_bf16 v[32:47], v[64:67], a[240:243], v[32:47]
    v_mfma_f32_32x32x16_bf16 v[48:63], v[64:67], a[244:247], v[48:63]
    s_waitcnt lgkmcnt(0)
    v_mfma_f32_32x32x16_bf16 v[32:47], v[68:71], a[248:251], v[32:47]
    v_mfma_f32_32x32x16_bf16 v[48:63], v[68:71], a[252:255], v[48:63]
    s_nop 3
    v_cvt_pk_bf16_f32 v92, v32, v33
    v_cvt_pk_bf16_f32 v93, v34, v35
    v_cvt_pk_bf16_f32 v94, v40, v41
    v_cvt_pk_bf16_f32 v95, v42, v43
    buffer_store_dwordx4 v[92:95], v2, s[8:11], s71 offen offset:0 sc1
    v_cvt_pk_bf16_f32 v96, v36, v37
    v_cvt_pk_bf16_f32 v97, v38, v39
    v_cvt_pk_bf16_f32 v98, v44, v45
    v_cvt_pk_bf16_f32 v99, v46, v47
    buffer_store_dwordx4 v[96:99], v2, s[8:11], s71 offen offset:512 sc1
    v_cvt_pk_bf16_f32 v100, v48, v49
    v_cvt_pk_bf16_f32 v101, v50, v51
    v_cvt_pk_bf16_f32 v102, v56, v57
    v_cvt_pk_bf16_f32 v103, v58, v59
    buffer_store_dwordx4 v[100:103], v2, s[8:11], s71 offen offset:1024 sc1
    v_cvt_pk_bf16_f32 v104, v52, v53
    v_cvt_pk_bf16_f32 v105, v54, v55
    v_cvt_pk_bf16_f32 v106, v60, v61
    v_cvt_pk_bf16_f32 v107, v62, v63
    buffer_store_dwordx4 v[104:107], v2, s[8:11], s71 offen offset:1536 sc1
    s_add_u32 s71, s71, 3670016
    s_cmp_lt_u32 s45, s44
    s_cbranch_scc1 L_p1_v
    s_branch L_p1_done
L_go_k:
    s_add_u32 s71, s71, s47
L_p1_k:
    v_add_u32 v4, s68, v0
    ds_read_b128 v[64:67], v4 offset:0
    ds_read_b128 v[68:71], v4 offset:1024
    ds_read_b128 v[72:75], v4 offset:2048
    ds_read_b128 v[76:79], v4 offset:3072
    ds_read_b128 v[80:83], v4 offset:4096
    s_waitcnt lgkmcnt(4)
    v_mfma_f32_32x32x16_bf16 v[32:47], a[0:3], v[64:67], 0
    ds_read_b128 v[84:87], v4 offset:5120
    v_mfma_f32_32x32x16_bf16 v[48:63], a[4:7], v[64:67], 0
    s_waitcnt lgkmcnt(4)
    v_mfma_f32_32x32x16_bf16 v[32:47], a[8:11], v[68:71], v[32:47]
    ds_read_b128 v[64:67], v4 offset:6144
    v_mfma_f32_32x32x16_bf16 v[48:63], a[12:15], v[68:71], v[48:63]
    s_waitcnt lgkmcnt(4)
    v_mfma_f32_32x32x16_bf16 v[32:47], a[16:19], v[72:75], v[32:47]
    ds_read_b128 v[68:71], v4 offset:7168
    v_mfma_f32_32x32x16_bf16 v[48:63], a[20:23], v[72:75], v[48:63]
    s_waitcnt lgkmcnt(4)
    v_mfma_f32_32x32x16_bf16 v[32:47], a[24:27], v[76:79], v[32:47]
    ds_read_b128 v[72:75], v4 offset:8192
    v_mfma_f32_32x32x16_bf16 v[48:63], a[28:31], v[76:79], v[48:63]
    s_waitcnt lgkmcnt(4)
    v_mfma_f32_32x32x16_bf16 v[32:47], a[32:35], v[80:83], v[32:47]
    ds_read_b128 v[76:79], v4 offset:9216
    v_mfma_f32_32x32x16_bf16 v[48:63], a[36:39], v[80:83], v[48:63]
    s_waitcnt lgkmcnt(4)
    v_mfma_f32_32x32x16_bf16 v[32:47], a[40:43], v[84:87], v[32:47]
    ds_read_b128 v[80:83], v4 offset:10240
    v_mfma_f32_32x32x16_bf16 v[48:63], a[44:47], v[84:87], v[48:63]
    s_waitcnt lgkmcnt(4)
    v_mfma_f32_32x32x16_bf16 v[32:47], a[48:51], v[64:67], v[32:47]
    ds_read_b128 v[84:87], v4 offset:11264
    v_mfma_f32_32x32x16_bf16 v[48:63], a[52:55], v[64:67], v[48:63]
    s_waitcnt lgkmcnt(4)
    v_mfma_f32_32x32x16_bf16 v[32:47], a[56:59], v[68:71], v[32:47]
    ds_read_b128 v[64:67], v4 offset:12288
    v_mfma_f32_32x32x16_bf16 v[48:63], a[60:63], v[68:71], v[48:63]
    s_waitcnt lgkmcnt(4)
    v_mfma_f32_32x32x16_bf16 v[32:47], a[64:67], v[72:75], v[32:47]
    ds_read_b128 v[68:71], v4 offset:13312
    v_mfma_f32_32x32x16_bf16 v[48:63], a[68:71], v[72:75], v[48:63]
    s_waitcnt lgkmcnt(4)
    v_mfma_f32_32x32x16_bf16 v[32:47], a[72:75], v[76:79], v[32:47]
    ds_read_b128 v[72:75], v4 offset:14336
    v_mfma_f32_32x32x16_bf16 v[48:63], a[76:79], v[76:79], v[48:63]
    s_waitcnt lgkmcnt(4)
    v_mfma_f32_32x32x16_bf16 v[32:47], a[80:83], v[80:83], v[32:47]
    ds_read_b128 v[76:79], v4 offset:15360
    v_mfma_f32_32x32x16_bf16 v[48:63], a[84:87], v[80:83], v[48:63]
    s_waitcnt lgkmcnt(4)
    v_mfma_f32_32x32x16_bf16 v[32:47], a[88:91], v[84:87], v[32:47]
    ds_read_b128 v[80:83], v4 offset:16384
    v_mfma_f32_32x32x16_bf16 v[48:63], a[92:95], v[84:87], v[48:63]
    s_waitcnt lgkmcnt(4)
    v_mfma_f32_32x32x16_bf16 v[32:47], a[96:99], v[64:67], v[32:47]
    ds_read_b128 v[84:87], v4 offset:17408
    v_mfma_f32_32x32x16_bf16 v[48:63], a[100:103], v[64:67], v[48:63]
    s_waitcnt lgkmcnt(4)
    v_mfma_f32_32x32x16_bf16 v[32:47], a[104:107], v[68:71], v[32:47]
    ds_read_b128 v[64:67], v4 offset:18432
    v_mfma_f32_32x32x16_bf16 v[48:63], a[108:111], v[68:71], v[48:63]
    s_waitcnt lgkmcnt(4)
    v_mfma_f32_32x32x16_bf16 v[32:47], a[112:115], v[72:75], v[32:47]
    ds_read_b128 v[68:71], v4 offset:19456
    v_mfma_f32_32x32x16_bf16 v[48:63], a[116:119], v[72:75], v[48:63]
    s_waitcnt lgkmcnt(4)
    v_mfma_f32_32x32x16_bf16 v[32:47], a[120:123], v[76:79], v[32:47]
    ds_read_b128 v[72:75], v4 offset:20480
    v_mfma_f32_32x32x16_bf16 v[48:63], a[124:127], v[76:79], v[48:63]
    s_waitcnt lgkmcnt(4)
    v_mfma_f32_32x32x16_bf16 v[32:47], a[128:131], v[80:83], v[32:47]
    ds_read_b128 v[76:79], v4 offset:21504
    v_mfma_f32_32x32x16_bf16 v[48:63], a[132:135], v[80:83], v[48:63]
    s_waitcnt vmcnt(0)
    s_barrier
    s_waitcnt lgkmcnt(4)
    v_mfma_f32_32x32x16_bf16 v[32:47], a[136:139], v[84:87], v[32:47]
    ds_read_b128 v[80:83], v4 offset:22528
    v_mfma_f32_32x32x16_bf16 v[48:63], a[140:143], v[84:87], v[48:63]
    s_add_u32 m0, s69, 0
    s_nop 0
    buffer_load_dwordx4 v0, s[8:11], s70 offen offset:0 sc1 lds
    buffer_load_dwordx4 v0, s[8:11], s70 offen offset:1024 sc1 lds
    s_waitcnt lgkmcnt(4)
    v_mfma_f32_32x32x16_bf16 v[32:47], a[144:147], v[64:67], v[32:47]
    ds_read_b128 v[84:87], v4 offset:23552
    v_mfma_f32_32x32x16_bf16 v[48:63], a[148:151], v[64:67], v[48:63]
    buffer_load_dwordx4 v0, s[8:11], s70 offen offset:2048 sc1 lds
    buffer_load_dwordx4 v0, s[8:11], s70 offen offset:3072 sc1 lds
    s_waitcnt lgkmcnt(4)
    v_mfma_f32_32x32x16_bf16 v[32:47], a[152:155], v[68:71], v[32:47]
    ds_read_b128 v[64:67], v4 offset:24576
    v_mfma_f32_32x32x16_bf16 v[48:63], a[156:159], v[68:71], v[48:63]
    s_add_u32 m0, s69, 4096
    s_add_u32 s48, s70, 4096
    buffer_load_dwordx4 v0, s[8:11], s48 offen offset:0 sc1 lds
    buffer_load_dwordx4 v0, s[8:11], s48 offen offset:1024 sc1 lds
    s_waitcnt lgkmcnt(4)
    v_mfma_f32_32x32x16_bf16 v[32:47], a[160:163], v[72:75], v[32:47]
    ds_read_b128 v[68:71], v4 offset:25600
    v_mfma_f32_32x32x16_bf16 v[48:63], a[164:167], v[72:75], v[48:63]
    buffer_load_dwordx4 v0, s[8:11], s48 offen offset:2048 sc1 lds
    buffer_load_dwordx4 v0, s[8:11], s48 offen offset:3072 sc1 lds
    s_waitcnt lgkmcnt(4)
    v_mfma_f32_32x32x16_bf16 v[32:47], a[168:171], v[76:79], v[32:47]
    ds_read_b128 v[72:75], v4 offset:26624
    v_mfma_f32_32x32x16_bf16 v[48:63], a[172:175], v[76:79], v[48:63]
    s_waitcnt lgkmcnt(4)
    v_mfma_f32_32x32x16_bf16 v[32:47], a[176:179], v[80:83], v[32:47]
    ds_read_b128 v[76:79], v4 offset:27648
    v_mfma_f32_32x32x16_bf16 v[48:63], a[180:183], v[80:83], v[48:63]
    s_mov_b32 s73, s74
    s_add_u32 s74, s74, s75
    s_add_u32 s70, s70, 229376
    s_lshl_b32 s47, s41, 13
    s_add_u32 s69, s68, s47
    s_waitcnt lgkmcnt(4)
    v_mfma_f32_32x32x16_bf16 v[32:47], a[184:187], v[84:87], v[32:47]
    ds_read_b128 v[80:83], v4 offset:28672
    v_mfma_f32_32x32x16_bf16 v[48:63], a[188:191], v[84:87], v[48:63]
    s_add_u32 s68, s68, 32768
    s_cmp_eq_u32 s68, 98304
    s_cselect_b32 s68, 0, s68
    s_add_u32 s45, s45, 1
    s_waitcnt lgkmcnt(4)
    v_mfma_f32_32x32x16_bf16 v[32:47], a[192:195], v[64:67], v[32:47]
    ds_read_b128 v[84:87], v4 offset:29696
    v_mfma_f32_32x32x16_bf16 v[48:63], a[196:199], v[64:67], v[48:63]
    s_waitcnt lgkmcnt(4)
    v_mfma_f32_32x32x16_bf16 v[32:47], a[200:203], v[68:71], v[32:47]
    ds_read_b128 v[64:67], v4 offset:30720
    v_mfma_f32_32x32x16_bf16 v[48:63], a[204:207], v[68:71], v[48:63]
    s_waitcnt lgkmcnt(4)
    v_mfma_f32_32x32x16_bf16 v[32:47], a[208:211], v[72:75], v[32:47]
    ds_read_b128 v[68:71], v4 offset:31744
    v_mfma_f32_32x32x16_bf16 v[48:63], a[212:215], v[72:75], v[48:63]
    s_waitcnt lgkmcnt(4)
    v_mfma_f32_32x32x16_bf16 v[32:47], a[216:219], v[76:79], v[32:47]
    v_mfma_f32_32x32x16_bf16 v[48:63], a[220:223], v[76:79], v[48:63]
    s_waitcnt lgkmcnt(3)
    v_mfma_f32_32x32x16_bf16 v[32:47], a[224:227], v[80:83], v[32:47]
    v_mfma_f32_32x32x16_bf16 v[48:63], a[228:231], v[80:83], v[48:63]
    s_waitcnt lgkmcnt(2)
    v_mfma_f32_32x32x16_bf16 v[32:47], a[232:235], v[84:87], v[32:47]
    v_mfma_f32_32x32x16_bf16 v[48:63], a[236:239], v[84:87], v[48:63]
    s_waitcnt lgkmcnt(1)
    v_mfma_f32_32x32x16_bf16 v[32:47], a[240:243], v[64:67], v[32:47]
    v_mfma_f32_32x32x16_bf16 v[48:63], a[244:247], v[64:67], v[48:63]
    s_waitcnt lgkmcnt(0)
    v_mfma_f32_32x32x16_bf16 v[32:47], a[248:251], v[68:71], v[32:47]
    v_mfma_f32_32x32x16_bf16 v[48:63], a[252:255], v[68:71], v[48:63]
    s_nop 11
    v_cvt_pk_bf16_f32 v92, v32, v48
    v_cvt_pk_bf16_f32 v93, v33, v49
    v_cvt_pk_bf16_f32 v94, v34, v50
    v_cvt_pk_bf16_f32 v95, v35, v51
    buffer_store_dwordx4 v[92:95], v1, s[8:11], s71 offen offset:0 sc1
    v_cvt_pk_bf16_f32 v96, v36, v52
    v_cvt_pk_bf16_f32 v97, v37, v53
    v_cvt_pk_bf16_f32 v98, v38, v54
    v_cvt_pk_bf16_f32 v99, v39, v55
    buffer_store_dwordx4 v[96:99], v1, s[8:11], s71 offen offset:512 sc1
    v_cvt_pk_bf16_f32 v100, v40, v56
    v_cvt_pk_bf16_f32 v101, v41, v57
    v_cvt_pk_bf16_f32 v102, v42, v58
    v_cvt_pk_bf16_f32 v103, v43, v59
    buffer_store_dwordx4 v[100:103], v1, s[8:11], s71 offen offset:2048 sc1
    v_cvt_pk_bf16_f32 v104, v44, v60
    v_cvt_pk_bf16_f32 v105, v45, v61
    v_cvt_pk_bf16_f32 v106, v46, v62
    v_cvt_pk_bf16_f32 v107, v47, v63
    buffer_store_dwordx4 v[104:107], v1, s[8:11], s71 offen offset:2560 sc1
    s_add_u32 s71, s71, 3670016
    s_cmp_lt_u32 s45, s44
    s_cbranch_scc1 L_p1_k
    s_branch L_p1_done
L_go_f:
    s_lshl_b32 s47, s77, 11
    s_add_u32 s71, s71, s47
    s_add_u32 s71, s71, 8192
    s_mov_b32 s98, 0xbdd2d3e8
    s_mov_b32 s99, 0xc0135761
L_p1_f:
    v_add_u32 v4, s68, v0
    ds_read_b128 v[64:67], v4 offset:0
    ds_read_b128 v[68:71], v4 offset:1024
    ds_read_b128 v[72:75], v4 offset:2048
    ds_read_b128 v[76:79], v4 offset:3072
    ds_read_b128 v[80:83], v4 offset:4096
    s_waitcnt lgkmcnt(4)
    v_mfma_f32_32x32x16_bf16 v[32:47], a[0:3], v[64:67], 0
    ds_read_b128 v[84:87], v4 offset:5120
    v_mfma_f32_32x32x16_bf16 v[48:63], a[4:7], v[64:67], 0
    s_waitcnt lgkmcnt(4)
    v_mfma_f32_32x32x16_bf16 v[32:47], a[8:11], v[68:71], v[32:47]
    ds_read_b128 v[64:67], v4 offset:6144
    v_mfma_f32_32x32x16_bf16 v[48:63], a[12:15], v[68:71], v[48:63]
    s_waitcnt lgkmcnt(4)
    v_mfma_f32_32x32x16_bf16 v[32:47], a[16:19], v[72:75], v[32:47]
    ds_read_b128 v[68:71], v4 offset:7168
    v_mfma_f32_32x32x16_bf16 v[48:63], a[20:23], v[72:75], v[48:63]
    s_waitcnt lgkmcnt(4)
    v_mfma_f32_32x32x16_bf16 v[32:47], a[24:27], v[76:79], v[32:47]
    ds_read_b128 v[72:75], v4 offset:8192
    v_mfma_f32_32x32x16_bf16 v[48:63], a[28:31], v[76:79], v[48:63]
    s_waitcnt lgkmcnt(4)
    v_mfma_f32_32x32x16_bf16 v[32:47], a[32:35], v[80:83], v[32:47]
    ds_read_b128 v[76:79], v4 offset:9216
    v_mfma_f32_32x32x16_bf16 v[48:63], a[36:39], v[80:83], v[48:63]
    s_waitcnt lgkmcnt(4)
    v_mfma_f32_32x32x16_bf16 v[32:47], a[40:43], v[84:87], v[32:47]
    ds_read_b128 v[80:83], v4 offset:10240
    v_mfma_f32_32x32x16_bf16 v[48:63], a[44:47], v[84:87], v[48:63]
    s_waitcnt lgkmcnt(4)
    v_mfma_f32_32x32x16_bf16 v[32:47], a[48:51], v[64:67], v[32:47]
    ds_read_b128 v[84:87], v4 offset:11264
    v_mfma_f32_32x32x16_bf16 v[48:63], a[52:55], v[64:67], v[48:63]
    s_waitcnt lgkmcnt(4)
    v_mfma_f32_32x32x16_bf16 v[32:47], a[56:59], v[68:71], v[32:47]
    ds_read_b128 v[64:67], v4 offset:12288
    v_mfma_f32_32x32x16_bf16 v[48:63], a[60:63], v[68:71], v[48:63]
    s_waitcnt lgkmcnt(4)
    v_mfma_f32_32x32x16_bf16 v[32:47], a[64:67], v[72:75], v[32:47]
    ds_read_b128 v[68:71], v4 offset:13312
    v_mfma_f32_32x32x16_bf16 v[48:63], a[68:71], v[72:75], v[48:63]
    s_waitcnt lgkmcnt(4)
    v_mfma_f32_32x32x16_bf16 v[32:47], a[72:75], v[76:79], v[32:47]
    ds_read_b128 v[72:75], v4 offset:14336
    v_mfma_f32_32x32x16_bf16 v[48:63], a[76:79], v[76:79], v[48:63]
    s_waitcnt lgkmcnt(4)
    v_mfma_f32_32x32x16_bf16 v[32:47], a[80:83], v[80:83], v[32:47]
    ds_read_b128 v[76:79], v4 offset:15360
    v_mfma_f32_32x32x16_bf16 v[48:63], a[84:87], v[80:83], v[48:63]
    s_waitcnt lgkmcnt(4)
    v_mfma_f32_32x32x16_bf16 v[32:47], a[88:91], v[84:87], v[32:47]
    ds_read_b128 v[80:83], v4 offset:16384
    v_mfma_f32_32x32x16_bf16 v[48:63], a[92:95], v[84:87], v[48:63]
    s_waitcnt lgkmcnt(4)
    v_mfma_f32_32x32x16_bf16 v[32:47], a[96:99], v[64:67], v[32:47]
    ds_read_b128 v[84:87], v4 offset:17408
    v_mfma_f32_32x32x16_bf16 v[48:63], a[100:103], v[64:67], v[48:63]
    s_waitcnt lgkmcnt(4)
    v_mfma_f32_32x32x16_bf16 v[32:47], a[104:107], v[68:71], v[32:47]
    ds_read_b128 v[64:67], v4 offset:18432
    v_mfma_f32_32x32x16_bf16 v[48:63], a[108:111], v[68:71], v[48:63]
    s_waitcnt lgkmcnt(4)
    v_mfma_f32_32x32x16_bf16 v[32:47], a[112:115], v[72:75], v[32:47]
    ds_read_b128 v[68:71], v4 offset:19456
    v_mfma_f32_32x32x16_bf16 v[48:63], a[116:119], v[72:75], v[48:63]
    s_waitcnt lgkmcnt(4)
    v_mfma_f32_32x32x16_bf16 v[32:47], a[120:123], v[76:79], v[32:47]
    ds_read_b128 v[72:75], v4 offset:20480
    v_mfma_f32_32x32x16_bf16 v[48:63], a[124:127], v[76:79], v[48:63]
    s_waitcnt lgkmcnt(4)
    v_mfma_f32_32x32x16_bf16 v[32:47], a[128:131], v[80:83], v[32:47]
    ds_read_b128 v[76:79], v4 offset:21504
    v_mfma_f32_32x32x16_bf16 v[48:63], a[132:135], v[80:83], v[48:63]
    s_waitcnt vmcnt(0)
    s_barrier
    s_mov_b64 exec, s[64:65]
    buffer_store_dword v5, off, s[8:11], s73 sc1
    s_mov_b64 exec, -1
    s_waitcnt lgkmcnt(4)
    v_mfma_f32_32x32x16_bf16 v[32:47], a[136:139], v[84:87], v[32:47]
    ds_read_b128 v[80:83], v4 offset:22528
    v_mfma_f32_32x32x16_bf16 v[48:63], a[140:143], v[84:87], v[48:63]
    s_add_u32 m0, s69, 0
    s_nop 0
    buffer_load_dwordx4 v0, s[8:11], s70 offen offset:0 sc1 lds
    buffer_load_dwordx4 v0, s[8:11], s70 offen offset:1024 sc1 lds
    s_waitcnt lgkmcnt(4)
    v_mfma_f32_32x32x16_bf16 v[32:47], a[144:147], v[64:67], v[32:47]
    ds_read_b128 v[84:87], v4 offset:23552
    v_mfma_f32_32x32x16_bf16 v[48:63], a[148:151], v[64:67], v[48:63]
    buffer_load_dwordx4 v0, s[8:11], s70 offen offset:2048 sc1 lds
    buffer_load_dwordx4 v0, s[8:11], s70 offen offset:3072 sc1 lds
    s_waitcnt lgkmcnt(4)
    v_mfma_f32_32x32x16_bf16 v[32:47], a[152:155], v[68:71], v[32:47]
    ds_read_b128 v[64:67], v4 offset:24576
    v_mfma_f32_32x32x16_bf16 v[48:63], a[156:159], v[68:71], v[48:63]
    s_add_u32 m0, s69, 4096
    s_add_u32 s48, s70, 4096
    buffer_load_dwordx4 v0, s[8:11], s48 offen offset:0 sc1 lds
    buffer_load_dwordx4 v0, s[8:11], s48 offen offset:1024 sc1 lds
    s_waitcnt lgkmcnt(4)
    v_mfma_f32_32x32x16_bf16 v[32:47], a[160:163], v[72:75], v[32:47]
    ds_read_b128 v[68:71], v4 offset:25600
    v_mfma_f32_32x32x16_bf16 v[48:63], a[164:167], v[72:75], v[48:63]
    buffer_load_dwordx4 v0, s[8:11], s48 offen offset:2048 sc1 lds
    buffer_load_dwordx4 v0, s[8:11], s48 offen offset:3072 sc1 lds
    s_waitcnt lgkmcnt(4)
    v_mfma_f32_32x32x16_bf16 v[32:47], a[168:171], v[76:79], v[32:47]
    ds_read_b128 v[72:75], v4 offset:26624
    v_mfma_f32_32x32x16_bf16 v[48:63], a[172:175], v[76:79], v[48:63]
    s_waitcnt lgkmcnt(4)
    v_mfma_f32_32x32x16_bf16 v[32:47], a[176:179], v[80:83], v[32:47]
    ds_read_b128 v[76:79], v4 offset:27648
    v_mfma_f32_32x32x16_bf16 v[48:63], a[180:183], v[80:83], v[48:63]
    s_mov_b32 s73, s74
    s_add_u32 s74, s74, s75
    s_add_u32 s70, s70, 229376
    s_lshl_b32 s47, s41, 13
    s_add_u32 s69, s68, s47
    s_waitcnt lgkmcnt(4)
    v_mfma_f32_32x32x16_bf16 v[32:47], a[184:187], v[84:87], v[32:47]
    ds_read_b128 v[80:83], v4 offset:28672
    v_mfma_f32_32x32x16_bf16 v[48:63], a[188:191], v[84:87], v[48:63]
    s_add_u32 s68, s68, 32768
    s_cmp_eq_u32 s68, 98304
    s_cselect_b32 s68, 0, s68
    s_add_u32 s45, s45, 1
    s_waitcnt lgkmcnt(4)
    v_mfma_f32_32x32x16_bf16 v[32:47], a[192:195], v[64:67], v[32:47]
    ds_read_b128 v[84:87], v4 offset:29696
    v_mfma_f32_32x32x16_bf16 v[48:63], a[196:199], v[64:67], v[48:63]
    s_waitcnt lgkmcnt(4)
    v_mfma_f32_32x32x16_bf16 v[32:47], a[200:203], v[68:71], v[32:47]
    ds_read_b128 v[64:67], v4 offset:30720
    v_mfma_f32_32x32x16_bf16 v[48:63], a[204:207], v[68:71], v[48:63]
    s_waitcnt lgkmcnt(4)
    v_mfma_f32_32x32x16_bf16 v[32:47], a[208:211], v[72:75], v[32:47]
    ds_read_b128 v[68:71], v4 offset:31744
    v_mfma_f32_32x32x16_bf16 v[48:63], a[212:215], v[72:75], v[48:63]
    s_waitcnt lgkmcnt(4)
    v_mfma_f32_32x32x16_bf16 v[32:47], a[216:219], v[76:79], v[32:47]
    v_mfma_f32_32x32x16_bf16 v[48:63], a[220:223], v[76:79], v[48:63]
    s_waitcnt lgkmcnt(3)
    v_mfma_f32_32x32x16_bf16 v[32:47], a[224:227], v[80:83], v[32:47]
    v_mfma_f32_32x32x16_bf16 v[48:63], a[228:231], v[80:83], v[48:63]
    s_waitcnt lgkmcnt(2)
    v_mfma_f32_32x32x16_bf16 v[32:47], a[232:235], v[84:87], v[32:47]
    v_mfma_f32_32x32x16_bf16 v[48:63], a[236:239], v[84:87], v[48:63]
    s_waitcnt lgkmcnt(1)
    v_mfma_f32_32x32x16_bf16 v[32:47], a[240:243], v[64:67], v[32:47]
    v_mfma_f32_32x32x16_bf16 v[48:63], a[244:247], v[64:67], v[48:63]
    s_waitcnt lgkmcnt(0)
    v_mfma_f32_32x32x16_bf16 v[32:47], a[248:251], v[68:71], v[32:47]
    v_mfma_f32_32x32x16_bf16 v[48:63], a[252:255], v[68:71], v[48:63]
    s_nop 3
    v_pk_mul_f32 v[64:65], v[32:33], v[32:33]
    v_pk_mul_f32 v[66:67], v[34:35], v[34:35]
    v_pk_mul_f32 v[68:69], v[36:37], v[36:37]
    v_pk_mul_f32 v[70:71], v[38:39], v[38:39]
    s_nop 3
    v_pk_mul_f32 v[72:73], v[48:49], v[48:49]
    v_pk_mul_f32 v[74:75], v[50:51], v[50:51]
    v_pk_mul_f32 v[76:77], v[52:53], v[52:53]
    v_pk_mul_f32 v[78:79], v[54:55], v[54:55]
    v_pk_fma_f32 v[64:65], v[64:65], s[98:99], s[98:99] op_sel:[0,0,1] op_sel_hi:[1,0,1]
    v_pk_fma_f32 v[66:67], v[66:67], s[98:99], s[98:99] op_sel:[0,0,1] op_sel_hi:[1,0,1]
    v_pk_fma_f32 v[68:69], v[68:69], s[98:99], s[98:99] op_sel:[0,0,1] op_sel_hi:[1,0,1]
    v_pk_fma_f32 v[70:71], v[70:71], s[98:99], s[98:99] op_sel:[0,0,1] op_sel_hi:[1,0,1]
    v_pk_fma_f32 v[72:73], v[72:73], s[98:99], s[98:99] op_sel:[0,0,1] op_sel_hi:[1,0,1]
    v_pk_fma_f32 v[74:75], v[74:75], s[98:99], s[98:99] op_sel:[0,0,1] op_sel_hi:[1,0,1]
    v_pk_fma_f32 v[76:77], v[76:77], s[98:99], s[98:99] op_sel:[0,0,1] op_sel_hi:[1,0,1]
    v_pk_fma_f32 v[78:79], v[78:79], s[98:99], s[98:99] op_sel:[0,0,1] op_sel_hi:[1,0,1]
    v_pk_mul_f32 v[64:65], v[64:65], v[32:33]
    v_pk_mul_f32 v[66:67], v[66:67], v[34:35]
    v_pk_mul_f32 v[68:69], v[68:69], v[36:37]
    v_pk_mul_f32 v[70:71], v[70:71], v[38:39]
    v_pk_mul_f32 v[72:73], v[72:73], v[48:49]
    v_pk_mul_f32 v[74:75], v[74:75], v[50:51]
    v_pk_mul_f32 v[76:77], v[76:77], v[52:53]
    v_pk_mul_f32 v[78:79], v[78:79], v[54:55]
    v_exp_f32 v64, v64
    v_exp_f32 v65, v65
    v_exp_f32 v66, v66
    v_exp_f32 v67, v67
    v_exp_f32 v68, v68
    v_exp_f32 v69, v69
    v_exp_f32 v70, v70
    v_exp_f32 v71, v71
    v_exp_f32 v72, v72
    v_exp_f32 v73, v73
    v_exp_f32 v74, v74
    v_exp_f32 v75, v75
    v_exp_f32 v76, v76
    v_exp_f32 v77, v77
    v_exp_f32 v78, v78
    v_exp_f32 v79, v79
    v_pk_mul_f32 v[32:33], v[32:33], v[40:41]
    v_pk_mul_f32 v[34:35], v[34:35], v[42:43]
    v_pk_mul_f32 v[36:37], v[36:37], v[44:45]
    v_pk_mul_f32 v[38:39], v[38:39], v[46:47]
    v_pk_mul_f32 v[48:49], v[48:49], v[56:57]
    v_pk_mul_f32 v[50:51], v[50:51], v[58:59]
    v_pk_mul_f32 v[52:53], v[52:53], v[60:61]
    v_pk_mul_f32 v[54:55], v[54:55], v[62:63]
    v_pk_add_f32 v[64:65], v[64:65], 1.0 op_sel_hi:[1,0]
    v_pk_add_f32 v[66:67], v[66:67], 1.0 op_sel_hi:[1,0]
    v_pk_add_f32 v[68:69], v[68:69], 1.0 op_sel_hi:[1,0]
    v_pk_add_f32 v[70:71], v[70:71], 1.0 op_sel_hi:[1,0]
    v_pk_add_f32 v[72:73], v[72:73], 1.0 op_sel_hi:[1,0]
    v_pk_add_f32 v[74:75], v[74:75], 1.0 op_sel_hi:[1,0]
    v_pk_add_f32 v[76:77], v[76:77], 1.0 op_sel_hi:[1,0]
    v_pk_add_f32 v[78:79], v[78:79], 1.0 op_sel_hi:[1,0]
    v_rcp_f32 v64, v64
    v_rcp_f32 v65, v65
    v_rcp_f32 v66, v66
    v_rcp_f32 v67, v67
    v_rcp_f32 v68, v68
    v_rcp_f32 v69, v69
    v_rcp_f32 v70, v70
    v_rcp_f32 v71, v71
    v_rcp_f32 v72, v72
    v_rcp_f32 v73, v73
    v_rcp_f32 v74, v74
    v_rcp_f32 v75, v75
    v_rcp_f32 v76, v76
    v_rcp_f32 v77, v77
    v_rcp_f32 v78, v78
    v_rcp_f32 v79, v79
    v_pk_mul_f32 v[32:33], v[32:33], v[64:65]
    v_pk_mul_f32 v[34:35], v[34:35], v[66:67]
    v_pk_mul_f32 v[36:37], v[36:37], v[68:69]
    v_pk_mul_f32 v[38:39], v[38:39], v[70:71]
    v_pk_mul_f32 v[48:49], v[48:49], v[72:73]
    v_pk_mul_f32 v[50:51], v[50:51], v[74:75]
    v_pk_mul_f32 v[52:53], v[52:53], v[76:77]
    v_pk_mul_f32 v[54:55], v[54:55], v[78:79]
    v_cvt_pk_bf16_f32 v92, v32, v48
    v_cvt_pk_bf16_f32 v93, v33, v49
    v_cvt_pk_bf16_f32 v94, v34, v50
    v_cvt_pk_bf16_f32 v95, v35, v51
    buffer_store_dwordx4 v[92:95], v0, s[8:11], s71 offen offset:0 sc1
    v_cvt_pk_bf16_f32 v96, v36, v52
    v_cvt_pk_bf16_f32 v97, v37, v53
    v_cvt_pk_bf16_f32 v98, v38, v54
    v_cvt_pk_bf16_f32 v99, v39, v55
    buffer_store_dwordx4 v[96:99], v0, s[8:11], s71 offen offset:1024 sc1
    s_add_u32 s71, s71, 3670016
    s_cmp_lt_u32 s45, s44
    s_cbranch_scc1 L_p1_f
    s_branch L_p1_done
L_wl_f:
    s_mov_b32 s50, 0
    s_mov_b32 s51, 3584
    s_mov_b32 s52, 7168
    s_mov_b32 s53, 10752
    s_mov_b32 s54, 14336
    s_mov_b32 s55, 17920
    s_mov_b32 s56, 21504
    s_mov_b32 s57, 25088
    v_mul_u32_u24 v6, 28672, v20
    v_lshl_add_u32 v6, v22, 2, v6
    s_lshl_b32 s47, s40, 7
    s_lshl_b32 s48, s77, 6
    s_add_u32 s47, s47, s48
    v_add_u32 v6, s47, v6
    s_mov_b32 s96, 0xffff
    s_mov_b32 s97, 0xffff
    s_mov_b64 exec, s[96:97]
    buffer_load_dword v96, v6, s[80:83], s50 offen
    buffer_load_dword v97, v6, s[80:83], s51 offen
    buffer_load_dword v98, v6, s[80:83], s52 offen
    buffer_load_dword v99, v6, s[80:83], s53 offen
    buffer_load_dword v100, v6, s[80:83], s54 offen
    buffer_load_dword v101, v6, s[80:83], s55 offen
    buffer_load_dword v102, v6, s[80:83], s56 offen
    buffer_load_dword v103, v6, s[80:83], s57 offen
    s_not_b64 exec, exec
    buffer_load_dword v96, v6, s[84:87], s50 offen
    buffer_load_dword v97, v6, s[84:87], s51 offen
    buffer_load_dword v98, v6, s[84:87], s52 offen
    buffer_load_dword v99, v6, s[84:87], s53 offen
    buffer_load_dword v100, v6, s[84:87], s54 offen
    buffer_load_dword v101, v6, s[84:87], s55 offen
    buffer_load_dword v102, v6, s[84:87], s56 offen
    buffer_load_dword v103, v6, s[84:87], s57 offen
    s_mov_b64 exec, -1
    v_add_u32 v6, 57344, v6
    s_mov_b64 exec, s[96:97]
    buffer_load_dword v104, v6, s[80:83], s50 offen
    buffer_load_dword v105, v6, s[80:83], s51 offen
    buffer_load_dword v106, v6, s[80:83], s52 offen
    buffer_load_dword v107, v6, s[80:83], s53 offen
    buffer_load_dword v108, v6, s[80:83], s54 offen
    buffer_load_dword v109, v6, s[80:83], s55 offen
    buffer_load_dword v110, v6, s[80:83], s56 offen
    buffer_load_dword v111, v6, s[80:83], s57 offen
    s_not_b64 exec, exec
    buffer_load_dword v104, v6, s[84:87], s50 offen
    buffer_load_dword v105, v6, s[84:87], s51 offen
    buffer_load_dword v106, v6, s[84:87], s52 offen
    buffer_load_dword v107, v6, s[84:87], s53 offen
    buffer_load_dword v108, v6, s[84:87], s54 offen
    buffer_load_dword v109, v6, s[84:87], s55 offen
    buffer_load_dword v110, v6, s[84:87], s56 offen
    buffer_load_dword v111, v6, s[84:87], s57 offen
    s_mov_b64 exec, -1
    v_add_u32 v6, 57344, v6
    s_mov_b64 exec, s[96:97]
    buffer_load_dword v112, v6, s[80:83], s50 offen
    buffer_load_dword v113, v6, s[80:83], s51 offen
    buffer_load_dword v114, v6, s[80:83], s52 offen
    buffer_load_dword v115, v6, s[80:83], s53 offen
    buffer_load_dword v116, v6, s[80:83], s54 offen
    buffer_load_dword v117, v6, s[80:83], s55 offen
    buffer_load_dword v118, v6, s[80:83], s56 offen
    buffer_load_dword v119, v6, s[80:83], s57 offen
    s_not_b64 exec, exec
    buffer_load_dword v112, v6, s[84:87], s50 offen
    buffer_load_dword v113, v6, s[84:87], s51 offen
    buffer_load_dword v114, v6, s[84:87], s52 offen
    buffer_load_dword v115, v6, s[84:87], s53 offen
    buffer_load_dword v116, v6, s[84:87], s54 offen
    buffer_load_dword v117, v6, s[84:87], s55 offen
    buffer_load_dword v118, v6, s[84:87], s56 offen
    buffer_load_dword v119, v6, s[84:87], s57 offen
    s_mov_b64 exec, -1
    v_add_u32 v6, 57344, v6
    s_waitcnt vmcnt(32)
    v_perm_b32 v80, v97, v96, s58
    v_perm_b32 v81, v99, v98, s58
    v_perm_b32 v82, v101, v100, s58
    v_perm_b32 v83, v103, v102, s58
    v_perm_b32 v84, v97, v96, s59
    v_perm_b32 v85, v99, v98, s59
    v_perm_b32 v86, v101, v100, s59
    v_perm_b32 v87, v103, v102, s59
    v_accvgpr_write_b32 a0, v80
    v_accvgpr_write_b32 a1, v81
    v_accvgpr_write_b32 a2, v82
    v_accvgpr_write_b32 a3, v83
    v_accvgpr_write_b32 a4, v84
    v_accvgpr_write_b32 a5, v85
    v_accvgpr_write_b32 a6, v86
    v_accvgpr_write_b32 a7, v87
    s_mov_b64 exec, s[96:97]
    buffer_load_dword v96, v6, s[80:83], s50 offen
    buffer_load_dword v97, v6, s[80:83], s51 offen
    buffer_load_dword v98, v6, s[80:83], s52 offen
    buffer_load_dword v99, v6, s[80:83], s53 offen
    buffer_load_dword v100, v6, s[80:83], s54 offen
    buffer_load_dword v101, v6, s[80:83], s55 offen
    buffer_load_dword v102, v6, s[80:83], s56 offen
    buffer_load_dword v103, v6, s[80:83], s57 offen
    s_not_b64 exec, exec
    buffer_load_dword v96, v6, s[84:87], s50 offen
    buffer_load_dword v97, v6, s[84:87], s51 offen
    buffer_load_dword v98, v6, s[84:87], s52 offen
    buffer_load_dword v99, v6, s[84:87], s53 offen
    buffer_load_dword v100, v6, s[84:87], s54 offen
    buffer_load_dword v101, v6, s[84:87], s55 offen
    buffer_load_dword v102, v6, s[84:87], s56 offen
    buffer_load_dword v103, v6, s[84:87], s57 offen
    s_mov_b64 exec, -1
    v_add_u32 v6, 57344, v6
    s_waitcnt vmcnt(32)
    v_perm_b32 v80, v105, v104, s58
    v_perm_b32 v81, v107, v106, s58
    v_perm_b32 v82, v109, v108, s58
    v_perm_b32 v83, v111, v110, s58
    v_perm_b32 v84, v105, v104, s59
    v_perm_b32 v85, v107, v106, s59
    v_perm_b32 v86, v109, v108, s59
    v_perm_b32 v87, v111, v110, s59
    v_accvgpr_write_b32 a8, v80
    v_accvgpr_write_b32 a9, v81
    v_accvgpr_write_b32 a10, v82
    v_accvgpr_write_b32 a11, v83
    v_accvgpr_write_b32 a12, v84
    v_accvgpr_write_b32 a13, v85
    v_accvgpr_write_b32 a14, v86
    v_accvgpr_write_b32 a15, v87
    s_mov_b64 exec, s[96:97]
    buffer_load_dword v104, v6, s[80:83], s50 offen
    buffer_load_dword v105, v6, s[80:83], s51 offen
    buffer_load_dword v106, v6, s[80:83], s52 offen
    buffer_load_dword v107, v6, s[80:83], s53 offen
    buffer_load_dword v108, v6, s[80:83], s54 offen
    buffer_load_dword v109, v6, s[80:83], s55 offen
    buffer_load_dword v110, v6, s[80:83], s56 offen
    buffer_load_dword v111, v6, s[80:83], s57 offen
    s_not_b64 exec, exec
    buffer_load_dword v104, v6, s[84:87], s50 offen
    buffer_load_dword v105, v6, s[84:87], s51 offen
    buffer_load_dword v106, v6, s[84:87], s52 offen
    buffer_load_dword v107, v6, s[84:87], s53 offen
    buffer_load_dword v108, v6, s[84:87], s54 offen
    buffer_load_dword v109, v6, s[84:87], s55 offen
    buffer_load_dword v110, v6, s[84:87], s56 offen
    buffer_load_dword v111, v6, s[84:87], s57 offen
    s_mov_b64 exec, -1
    v_add_u32 v6, 57344, v6
    s_waitcnt vmcnt(32)
    v_perm_b32 v80, v113, v112, s58
    v_perm_b32 v81, v115, v114, s58
    v_perm_b32 v82, v117, v116, s58
    v_perm_b32 v83, v119, v118, s58
    v_perm_b32 v84, v113, v112, s59
    v_perm_b32 v85, v115, v114, s59
    v_perm_b32 v86, v117, v116, s59
    v_perm_b32 v87, v119, v118, s59
    v_accvgpr_write_b32 a16, v80
    v_accvgpr_write_b32 a17, v81
    v_accvgpr_write_b32 a18, v82
    v_accvgpr_write_b32 a19, v83
    v_accvgpr_write_b32 a20, v84
    v_accvgpr_write_b32 a21, v85
    v_accvgpr_write_b32 a22, v86
    v_accvgpr_write_b32 a23, v87
    s_mov_b64 exec, s[96:97]
    buffer_load_dword v112, v6, s[80:83], s50 offen
    buffer_load_dword v113, v6, s[80:83], s51 offen
    buffer_load_dword v114, v6, s[80:83], s52 offen
    buffer_load_dword v115, v6, s[80:83], s53 offen
    buffer_load_dword v116, v6, s[80:83], s54 offen
    buffer_load_dword v117, v6, s[80:83], s55 offen
    buffer_load_dword v118, v6, s[80:83], s56 offen
    buffer_load_dword v119, v6, s[80:83], s57 offen
    s_not_b64 exec, exec
    buffer_load_dword v112, v6, s[84:87], s50 offen
    buffer_load_dword v113, v6, s[84:87], s51 offen
    buffer_load_dword v114, v6, s[84:87], s52 offen
    buffer_load_dword v115, v6, s[84:87], s53 offen
    buffer_load_dword v116, v6, s[84:87], s54 offen
    buffer_load_dword v117, v6, s[84:87], s55 offen
    buffer_load_dword v118, v6, s[84:87], s56 offen
    buffer_load_dword v119, v6, s[84:87], s57 offen
    s_mov_b64 exec, -1
    v_add_u32 v6, 57344, v6
    s_waitcnt vmcnt(32)
    v_perm_b32 v80, v97, v96, s58
    v_perm_b32 v81, v99, v98, s58
    v_perm_b32 v82, v101, v100, s58
    v_perm_b32 v83, v103, v102, s58
    v_perm_b32 v84, v97, v96, s59
    v_perm_b32 v85, v99, v98, s59
    v_perm_b32 v86, v101, v100, s59
    v_perm_b32 v87, v103, v102, s59
    v_accvgpr_write_b32 a24, v80
    v_accvgpr_write_b32 a25, v81
    v_accvgpr_write_b32 a26, v82
    v_accvgpr_write_b32 a27, v83
    v_accvgpr_write_b32 a28, v84
    v_accvgpr_write_b32 a29, v85
    v_accvgpr_write_b32 a30, v86
    v_accvgpr_write_b32 a31, v87
    s_mov_b64 exec, s[96:97]
    buffer_load_dword v96, v6, s[80:83], s50 offen
    buffer_load_dword v97, v6, s[80:83], s51 offen
    buffer_load_dword v98, v6, s[80:83], s52 offen
    buffer_load_dword v99, v6, s[80:83], s53 offen
    buffer_load_dword v100, v6, s[80:83], s54 offen
    buffer_load_dword v101, v6, s[80:83], s55 offen
    buffer_load_dword v102, v6, s[80:83], s56 offen
    buffer_load_dword v103, v6, s[80:83], s57 offen
    s_not_b64 exec, exec
    buffer_load_dword v96, v6, s[84:87], s50 offen
    buffer_load_dword v97, v6, s[84:87], s51 offen
    buffer_load_dword v98, v6, s[84:87], s52 offen
    buffer_load_dword v99, v6, s[84:87], s53 offen
    buffer_load_dword v100, v6, s[84:87], s54 offen
    buffer_load_dword v101, v6, s[84:87], s55 offen
    buffer_load_dword v102, v6, s[84:87], s56 offen
    buffer_load_dword v103, v6, s[84:87], s57 offen
    s_mov_b64 exec, -1
    v_add_u32 v6, 57344, v6
    s_waitcnt vmcnt(32)
    v_perm_b32 v80, v105, v104, s58
    v_perm_b32 v81, v107, v106, s58
    v_perm_b32 v82, v109, v108, s58
    v_perm_b32 v83, v111, v110, s58
    v_perm_b32 v84, v105, v104, s59
    v_perm_b32 v85, v107, v106, s59
    v_perm_b32 v86, v109, v108, s59
    v_perm_b32 v87, v111, v110, s59
    v_accvgpr_write_b32 a32, v80
    v_accvgpr_write_b32 a33, v81
    v_accvgpr_write_b32 a34, v82
    v_accvgpr_write_b32 a35, v83
    v_accvgpr_write_b32 a36, v84
    v_accvgpr_write_b32 a37, v85
    v_accvgpr_write_b32 a38, v86
    v_accvgpr_write_b32 a39, v87
    s_mov_b64 exec, s[96:97]
    buffer_load_dword v104, v6, s[80:83], s50 offen
    buffer_load_dword v105, v6, s[80:83], s51 offen
    buffer_load_dword v106, v6, s[80:83], s52 offen
    buffer_load_dword v107, v6, s[80:83], s53 offen
    buffer_load_dword v108, v6, s[80:83], s54 offen
    buffer_load_dword v109, v6, s[80:83], s55 offen
    buffer_load_dword v110, v6, s[80:83], s56 offen
    buffer_load_dword v111, v6, s[80:83], s57 offen
    s_not_b64 exec, exec
    buffer_load_dword v104, v6, s[84:87], s50 offen
    buffer_load_dword v105, v6, s[84:87], s51 offen
    buffer_load_dword v106, v6, s[84:87], s52 offen
    buffer_load_dword v107, v6, s[84:87], s53 offen
    buffer_load_dword v108, v6, s[84:87], s54 offen
    buffer_load_dword v109, v6, s[84:87], s55 offen
    buffer_load_dword v110, v6, s[84:87], s56 offen
    buffer_load_dword v111, v6, s[84:87], s57 offen
    s_mov_b64 exec, -1
    v_add_u32 v6, 57344, v6
    s_waitcnt vmcnt(32)
    v_perm_b32 v80, v113, v112, s58
    v_perm_b32 v81, v115, v114, s58
    v_perm_b32 v82, v117, v116, s58
    v_perm_b32 v83, v119, v118, s58
    v_perm_b32 v84, v113, v112, s59
    v_perm_b32 v85, v115, v114, s59
    v_perm_b32 v86, v117, v116, s59
    v_perm_b32 v87, v119, v118, s59
    v_accvgpr_write_b32 a40, v80
    v_accvgpr_write_b32 a41, v81
    v_accvgpr_write_b32 a42, v82
    v_accvgpr_write_b32 a43, v83
    v_accvgpr_write_b32 a44, v84
    v_accvgpr_write_b32 a45, v85
    v_accvgpr_write_b32 a46, v86
    v_accvgpr_write_b32 a47, v87
    s_mov_b64 exec, s[96:97]
    buffer_load_dword v112, v6, s[80:83], s50 offen
    buffer_load_dword v113, v6, s[80:83], s51 offen
    buffer_load_dword v114, v6, s[80:83], s52 offen
    buffer_load_dword v115, v6, s[80:83], s53 offen
    buffer_load_dword v116, v6, s[80:83], s54 offen
    buffer_load_dword v117, v6, s[80:83], s55 offen
    buffer_load_dword v118, v6, s[80:83], s56 offen
    buffer_load_dword v119, v6, s[80:83], s57 offen
    s_not_b64 exec, exec
    buffer_load_dword v112, v6, s[84:87], s50 offen
    buffer_load_dword v113, v6, s[84:87], s51 offen
    buffer_load_dword v114, v6, s[84:87], s52 offen
    buffer_load_dword v115, v6, s[84:87], s53 offen
    buffer_load_dword v116, v6, s[84:87], s54 offen
    buffer_load_dword v117, v6, s[84:87], s55 offen
    buffer_load_dword v118, v6, s[84:87], s56 offen
    buffer_load_dword v119, v6, s[84:87], s57 offen
    s_mov_b64 exec, -1
    v_add_u32 v6, 57344, v6
    s_waitcnt vmcnt(32)
    v_perm_b32 v80, v97, v96, s58
    v_perm_b32 v81, v99, v98, s58
    v_perm_b32 v82, v101, v100, s58
    v_perm_b32 v83, v103, v102, s58
    v_perm_b32 v84, v97, v96, s59
    v_perm_b32 v85, v99, v98, s59
    v_perm_b32 v86, v101, v100, s59
    v_perm_b32 v87, v103, v102, s59
    v_accvgpr_write_b32 a48, v80
    v_accvgpr_write_b32 a49, v81
    v_accvgpr_write_b32 a50, v82
    v_accvgpr_write_b32 a51, v83
    v_accvgpr_write_b32 a52, v84
    v_accvgpr_write_b32 a53, v85
    v_accvgpr_write_b32 a54, v86
    v_accvgpr_write_b32 a55, v87
    s_mov_b64 exec, s[96:97]
    buffer_load_dword v96, v6, s[80:83], s50 offen
    buffer_load_dword v97, v6, s[80:83], s51 offen
    buffer_load_dword v98, v6, s[80:83], s52 offen
    buffer_load_dword v99, v6, s[80:83], s53 offen
    buffer_load_dword v100, v6, s[80:83], s54 offen
    buffer_load_dword v101, v6, s[80:83], s55 offen
    buffer_load_dword v102, v6, s[80:83], s56 offen
    buffer_load_dword v103, v6, s[80:83], s57 offen
    s_not_b64 exec, exec
    buffer_load_dword v96, v6, s[84:87], s50 offen
    buffer_load_dword v97, v6, s[84:87], s51 offen
    buffer_load_dword v98, v6, s[84:87], s52 offen
    buffer_load_dword v99, v6, s[84:87], s53 offen
    buffer_load_dword v100, v6, s[84:87], s54 offen
    buffer_load_dword v101, v6, s[84:87], s55 offen
    buffer_load_dword v102, v6, s[84:87], s56 offen
    buffer_load_dword v103, v6, s[84:87], s57 offen
    s_mov_b64 exec, -1
    v_add_u32 v6, 57344, v6
    s_waitcnt vmcnt(32)
    v_perm_b32 v80, v105, v104, s58
    v_perm_b32 v81, v107, v106, s58
    v_perm_b32 v82, v109, v108, s58
    v_perm_b32 v83, v111, v110, s58
    v_perm_b32 v84, v105, v104, s59
    v_perm_b32 v85, v107, v106, s59
    v_perm_b32 v86, v109, v108, s59
    v_perm_b32 v87, v111, v110, s59
    v_accvgpr_write_b32 a56, v80
    v_accvgpr_write_b32 a57, v81
    v_accvgpr_write_b32 a58, v82
    v_accvgpr_write_b32 a59, v83
    v_accvgpr_write_b32 a60, v84
    v_accvgpr_write_b32 a61, v85
    v_accvgpr_write_b32 a62, v86
    v_accvgpr_write_b32 a63, v87
    s_mov_b64 exec, s[96:97]
    buffer_load_dword v104, v6, s[80:83], s50 offen
    buffer_load_dword v105, v6, s[80:83], s51 offen
    buffer_load_dword v106, v6, s[80:83], s52 offen
    buffer_load_dword v107, v6, s[80:83], s53 offen
    buffer_load_dword v108, v6, s[80:83], s54 offen
    buffer_load_dword v109, v6, s[80:83], s55 offen
    buffer_load_dword v110, v6, s[80:83], s56 offen
    buffer_load_dword v111, v6, s[80:83], s57 offen
    s_not_b64 exec, exec
    buffer_load_dword v104, v6, s[84:87], s50 offen
    buffer_load_dword v105, v6, s[84:87], s51 offen
    buffer_load_dword v106, v6, s[84:87], s52 offen
    buffer_load_dword v107, v6, s[84:87], s53 offen
    buffer_load_dword v108, v6, s[84:87], s54 offen
    buffer_load_dword v109, v6, s[84:87], s55 offen
    buffer_load_dword v110, v6, s[84:87], s56 offen
    buffer_load_dword v111, v6, s[84:87], s57 offen
    s_mov_b64 exec, -1
    v_add_u32 v6, 57344, v6
    s_waitcnt vmcnt(32)
    v_perm_b32 v80, v113, v112, s58
    v_perm_b32 v81, v115, v114, s58
    v_perm_b32 v82, v117, v116, s58
    v_perm_b32 v83, v119, v118, s58
    v_perm_b32 v84, v113, v112, s59
    v_perm_b32 v85, v115, v114, s59
    v_perm_b32 v86, v117, v116, s59
    v_perm_b32 v87, v119, v118, s59
    v_accvgpr_write_b32 a64, v80
    v_accvgpr_write_b32 a65, v81
    v_accvgpr_write_b32 a66, v82
    v_accvgpr_write_b32 a67, v83
    v_accvgpr_write_b32 a68, v84
    v_accvgpr_write_b32 a69, v85
    v_accvgpr_write_b32 a70, v86
    v_accvgpr_write_b32 a71, v87
    s_mov_b64 exec, s[96:97]
    buffer_load_dword v112, v6, s[80:83], s50 offen
    buffer_load_dword v113, v6, s[80:83], s51 offen
    buffer_load_dword v114, v6, s[80:83], s52 offen
    buffer_load_dword v115, v6, s[80:83], s53 offen
    buffer_load_dword v116, v6, s[80:83], s54 offen
    buffer_load_dword v117, v6, s[80:83], s55 offen
    buffer_load_dword v118, v6, s[80:83], s56 offen
    buffer_load_dword v119, v6, s[80:83], s57 offen
    s_not_b64 exec, exec
    buffer_load_dword v112, v6, s[84:87], s50 offen
    buffer_load_dword v113, v6, s[84:87], s51 offen
    buffer_load_dword v114, v6, s[84:87], s52 offen
    buffer_load_dword v115, v6, s[84:87], s53 offen
    buffer_load_dword v116, v6, s[84:87], s54 offen
    buffer_load_dword v117, v6, s[84:87], s55 offen
    buffer_load_dword v118, v6, s[84:87], s56 offen
    buffer_load_dword v119, v6, s[84:87], s57 offen
    s_mov_b64 exec, -1
    v_add_u32 v6, 57344, v6
    s_waitcnt vmcnt(32)
    v_perm_b32 v80, v97, v96, s58
    v_perm_b32 v81, v99, v98, s58
    v_perm_b32 v82, v101, v100, s58
    v_perm_b32 v83, v103, v102, s58
    v_perm_b32 v84, v97, v96, s59
    v_perm_b32 v85, v99, v98, s59
    v_perm_b32 v86, v101, v100, s59
    v_perm_b32 v87, v103, v102, s59
    v_accvgpr_write_b32 a72, v80
    v_accvgpr_write_b32 a73, v81
    v_accvgpr_write_b32 a74, v82
    v_accvgpr_write_b32 a75, v83
    v_accvgpr_write_b32 a76, v84
    v_accvgpr_write_b32 a77, v85
    v_accvgpr_write_b32 a78, v86
    v_accvgpr_write_b32 a79, v87
    s_mov_b64 exec, s[96:97]
    buffer_load_dword v96, v6, s[80:83], s50 offen
    buffer_load_dword v97, v6, s[80:83], s51 offen
    buffer_load_dword v98, v6, s[80:83], s52 offen
    buffer_load_dword v99, v6, s[80:83], s53 offen
    buffer_load_dword v100, v6, s[80:83], s54 offen
    buffer_load_dword v101, v6, s[80:83], s55 offen
    buffer_load_dword v102, v6, s[80:83], s56 offen
    buffer_load_dword v103, v6, s[80:83], s57 offen
    s_not_b64 exec, exec
    buffer_load_dword v96, v6, s[84:87], s50 offen
    buffer_load_dword v97, v6, s[84:87], s51 offen
    buffer_load_dword v98, v6, s[84:87], s52 offen
    buffer_load_dword v99, v6, s[84:87], s53 offen
    buffer_load_dword v100, v6, s[84:87], s54 offen
    buffer_load_dword v101, v6, s[84:87], s55 offen
    buffer_load_dword v102, v6, s[84:87], s56 offen
    buffer_load_dword v103, v6, s[84:87], s57 offen
    s_mov_b64 exec, -1
    v_add_u32 v6, 57344, v6
    s_waitcnt vmcnt(32)
    v_perm_b32 v80, v105, v104, s58
    v_perm_b32 v81, v107, v106, s58
    v_perm_b32 v82, v109, v108, s58
    v_perm_b32 v83, v111, v110, s58
    v_perm_b32 v84, v105, v104, s59
    v_perm_b32 v85, v107, v106, s59
    v_perm_b32 v86, v109, v108, s59
    v_perm_b32 v87, v111, v110, s59
    v_accvgpr_write_b32 a80, v80
    v_accvgpr_write_b32 a81, v81
    v_accvgpr_write_b32 a82, v82
    v_accvgpr_write_b32 a83, v83
    v_accvgpr_write_b32 a84, v84
    v_accvgpr_write_b32 a85, v85
    v_accvgpr_write_b32 a86, v86
    v_accvgpr_write_b32 a87, v87
    s_mov_b64 exec, s[96:97]
    buffer_load_dword v104, v6, s[80:83], s50 offen
    buffer_load_dword v105, v6, s[80:83], s51 offen
    buffer_load_dword v106, v6, s[80:83], s52 offen
    buffer_load_dword v107, v6, s[80:83], s53 offen
    buffer_load_dword v108, v6, s[80:83], s54 offen
    buffer_load_dword v109, v6, s[80:83], s55 offen
    buffer_load_dword v110, v6, s[80:83], s56 offen
    buffer_load_dword v111, v6, s[80:83], s57 offen
    s_not_b64 exec, exec
    buffer_load_dword v104, v6, s[84:87], s50 offen
    buffer_load_dword v105, v6, s[84:87], s51 offen
    buffer_load_dword v106, v6, s[84:87], s52 offen
    buffer_load_dword v107, v6, s[84:87], s53 offen
    buffer_load_dword v108, v6, s[84:87], s54 offen
    buffer_load_dword v109, v6, s[84:87], s55 offen
    buffer_load_dword v110, v6, s[84:87], s56 offen
    buffer_load_dword v111, v6, s[84:87], s57 offen
    s_mov_b64 exec, -1
    v_add_u32 v6, 57344, v6
    s_waitcnt vmcnt(32)
    v_perm_b32 v80, v113, v112, s58
    v_perm_b32 v81, v115, v114, s58
    v_perm_b32 v82, v117, v116, s58
    v_perm_b32 v83, v119, v118, s58
    v_perm_b32 v84, v113, v112, s59
    v_perm_b32 v85, v115, v114, s59
    v_perm_b32 v86, v117, v116, s59
    v_perm_b32 v87, v119, v118, s59
    v_accvgpr_write_b32 a88, v80
    v_accvgpr_write_b32 a89, v81
    v_accvgpr_write_b32 a90, v82
    v_accvgpr_write_b32 a91, v83
    v_accvgpr_write_b32 a92, v84
    v_accvgpr_write_b32 a93, v85
    v_accvgpr_write_b32 a94, v86
    v_accvgpr_write_b32 a95, v87
    s_mov_b64 exec, s[96:97]
    buffer_load_dword v112, v6, s[80:83], s50 offen
    buffer_load_dword v113, v6, s[80:83], s51 offen
    buffer_load_dword v114, v6, s[80:83], s52 offen
    buffer_load_dword v115, v6, s[80:83], s53 offen
    buffer_load_dword v116, v6, s[80:83], s54 offen
    buffer_load_dword v117, v6, s[80:83], s55 offen
    buffer_load_dword v118, v6, s[80:83], s56 offen
    buffer_load_dword v119, v6, s[80:83], s57 offen
    s_not_b64 exec, exec
    buffer_load_dword v112, v6, s[84:87], s50 offen
    buffer_load_dword v113, v6, s[84:87], s51 offen
    buffer_load_dword v114, v6, s[84:87], s52 offen
    buffer_load_dword v115, v6, s[84:87], s53 offen
    buffer_load_dword v116, v6, s[84:87], s54 offen
    buffer_load_dword v117, v6, s[84:87], s55 offen
    buffer_load_dword v118, v6, s[84:87], s56 offen
    buffer_load_dword v119, v6, s[84:87], s57 offen
    s_mov_b64 exec, -1
    v_add_u32 v6, 57344, v6
    s_waitcnt vmcnt(32)
    v_perm_b32 v80, v97, v96, s58
    v_perm_b32 v81, v99, v98, s58
    v_perm_b32 v82, v101, v100, s58
    v_perm_b32 v83, v103, v102, s58
    v_perm_b32 v84, v97, v96, s59
    v_perm_b32 v85, v99, v98, s59
    v_perm_b32 v86, v101, v100, s59
    v_perm_b32 v87, v103, v102, s59
    v_accvgpr_write_b32 a96, v80
    v_accvgpr_write_b32 a97, v81
    v_accvgpr_write_b32 a98, v82
    v_accvgpr_write_b32 a99, v83
    v_accvgpr_write_b32 a100, v84
    v_accvgpr_write_b32 a101, v85
    v_accvgpr_write_b32 a102, v86
    v_accvgpr_write_b32 a103, v87
    s_mov_b64 exec, s[96:97]
    buffer_load_dword v96, v6, s[80:83], s50 offen
    buffer_load_dword v97, v6, s[80:83], s51 offen
    buffer_load_dword v98, v6, s[80:83], s52 offen
    buffer_load_dword v99, v6, s[80:83], s53 offen
    buffer_load_dword v100, v6, s[80:83], s54 offen
    buffer_load_dword v101, v6, s[80:83], s55 offen
    buffer_load_dword v102, v6, s[80:83], s56 offen
    buffer_load_dword v103, v6, s[80:83], s57 offen
    s_not_b64 exec, exec
    buffer_load_dword v96, v6, s[84:87], s50 offen
    buffer_load_dword v97, v6, s[84:87], s51 offen
    buffer_load_dword v98, v6, s[84:87], s52 offen
    buffer_load_dword v99, v6, s[84:87], s53 offen
    buffer_load_dword v100, v6, s[84:87], s54 offen
    buffer_load_dword v101, v6, s[84:87], s55 offen
    buffer_load_dword v102, v6, s[84:87], s56 offen
    buffer_load_dword v103, v6, s[84:87], s57 offen
    s_mov_b64 exec, -1
    v_add_u32 v6, 57344, v6
    s_waitcnt vmcnt(32)
    v_perm_b32 v80, v105, v104, s58
    v_perm_b32 v81, v107, v106, s58
    v_perm_b32 v82, v109, v108, s58
    v_perm_b32 v83, v111, v110, s58
    v_perm_b32 v84, v105, v104, s59
    v_perm_b32 v85, v107, v106, s59
    v_perm_b32 v86, v109, v108, s59
    v_perm_b32 v87, v111, v110, s59
    v_accvgpr_write_b32 a104, v80
    v_accvgpr_write_b32 a105, v81
    v_accvgpr_write_b32 a106, v82
    v_accvgpr_write_b32 a107, v83
    v_accvgpr_write_b32 a108, v84
    v_accvgpr_write_b32 a109, v85
    v_accvgpr_write_b32 a110, v86
    v_accvgpr_write_b32 a111, v87
    s_mov_b64 exec, s[96:97]
    buffer_load_dword v104, v6, s[80:83], s50 offen
    buffer_load_dword v105, v6, s[80:83], s51 offen
    buffer_load_dword v106, v6, s[80:83], s52 offen
    buffer_load_dword v107, v6, s[80:83], s53 offen
    buffer_load_dword v108, v6, s[80:83], s54 offen
    buffer_load_dword v109, v6, s[80:83], s55 offen
    buffer_load_dword v110, v6, s[80:83], s56 offen
    buffer_load_dword v111, v6, s[80:83], s57 offen
    s_not_b64 exec, exec
    buffer_load_dword v104, v6, s[84:87], s50 offen
    buffer_load_dword v105, v6, s[84:87], s51 offen
    buffer_load_dword v106, v6, s[84:87], s52 offen
    buffer_load_dword v107, v6, s[84:87], s53 offen
    buffer_load_dword v108, v6, s[84:87], s54 offen
    buffer_load_dword v109, v6, s[84:87], s55 offen
    buffer_load_dword v110, v6, s[84:87], s56 offen
    buffer_load_dword v111, v6, s[84:87], s57 offen
    s_mov_b64 exec, -1
    v_add_u32 v6, 57344, v6
    s_waitcnt vmcnt(32)
    v_perm_b32 v80, v113, v112, s58
    v_perm_b32 v81, v115, v114, s58
    v_perm_b32 v82, v117, v116, s58
    v_perm_b32 v83, v119, v118, s58
    v_perm_b32 v84, v113, v112, s59
    v_perm_b32 v85, v115, v114, s59
    v_perm_b32 v86, v117, v116, s59
    v_perm_b32 v87, v119, v118, s59
    v_accvgpr_write_b32 a112, v80
    v_accvgpr_write_b32 a113, v81
    v_accvgpr_write_b32 a114, v82
    v_accvgpr_write_b32 a115, v83
    v_accvgpr_write_b32 a116, v84
    v_accvgpr_write_b32 a117, v85
    v_accvgpr_write_b32 a118, v86
    v_accvgpr_write_b32 a119, v87
    s_mov_b64 exec, s[96:97]
    buffer_load_dword v112, v6, s[80:83], s50 offen
    buffer_load_dword v113, v6, s[80:83], s51 offen
    buffer_load_dword v114, v6, s[80:83], s52 offen
    buffer_load_dword v115, v6, s[80:83], s53 offen
    buffer_load_dword v116, v6, s[80:83], s54 offen
    buffer_load_dword v117, v6, s[80:83], s55 offen
    buffer_load_dword v118, v6, s[80:83], s56 offen
    buffer_load_dword v119, v6, s[80:83], s57 offen
    s_not_b64 exec, exec
    buffer_load_dword v112, v6, s[84:87], s50 offen
    buffer_load_dword v113, v6, s[84:87], s51 offen
    buffer_load_dword v114, v6, s[84:87], s52 offen
    buffer_load_dword v115, v6, s[84:87], s53 offen
    buffer_load_dword v116, v6, s[84:87], s54 offen
    buffer_load_dword v117, v6, s[84:87], s55 offen
    buffer_load_dword v118, v6, s[84:87], s56 offen
    buffer_load_dword v119, v6, s[84:87], s57 offen
    s_mov_b64 exec, -1
    v_add_u32 v6, 57344, v6
    s_waitcnt vmcnt(32)
    v_perm_b32 v80, v97, v96, s58
    v_perm_b32 v81, v99, v98, s58
    v_perm_b32 v82, v101, v100, s58
    v_perm_b32 v83, v103, v102, s58
    v_perm_b32 v84, v97, v96, s59
    v_perm_b32 v85, v99, v98, s59
    v_perm_b32 v86, v101, v100, s59
    v_perm_b32 v87, v103, v102, s59
    v_accvgpr_write_b32 a120, v80
    v_accvgpr_write_b32 a121, v81
    v_accvgpr_write_b32 a122, v82
    v_accvgpr_write_b32 a123, v83
    v_accvgpr_write_b32 a124, v84
    v_accvgpr_write_b32 a125, v85
    v_accvgpr_write_b32 a126, v86
    v_accvgpr_write_b32 a127, v87
    s_mov_b64 exec, s[96:97]
    buffer_load_dword v96, v6, s[80:83], s50 offen
    buffer_load_dword v97, v6, s[80:83], s51 offen
    buffer_load_dword v98, v6, s[80:83], s52 offen
    buffer_load_dword v99, v6, s[80:83], s53 offen
    buffer_load_dword v100, v6, s[80:83], s54 offen
    buffer_load_dword v101, v6, s[80:83], s55 offen
    buffer_load_dword v102, v6, s[80:83], s56 offen
    buffer_load_dword v103, v6, s[80:83], s57 offen
    s_not_b64 exec, exec
    buffer_load_dword v96, v6, s[84:87], s50 offen
    buffer_load_dword v97, v6, s[84:87], s51 offen
    buffer_load_dword v98, v6, s[84:87], s52 offen
    buffer_load_dword v99, v6, s[84:87], s53 offen
    buffer_load_dword v100, v6, s[84:87], s54 offen
    buffer_load_dword v101, v6, s[84:87], s55 offen
    buffer_load_dword v102, v6, s[84:87], s56 offen
    buffer_load_dword v103, v6, s[84:87], s57 offen
    s_mov_b64 exec, -1
    v_add_u32 v6, 57344, v6
    s_waitcnt vmcnt(32)
    v_perm_b32 v80, v105, v104, s58
    v_perm_b32 v81, v107, v106, s58
    v_perm_b32 v82, v109, v108, s58
    v_perm_b32 v83, v111, v110, s58
    v_perm_b32 v84, v105, v104, s59
    v_perm_b32 v85, v107, v106, s59
    v_perm_b32 v86, v109, v108, s59
    v_perm_b32 v87, v111, v110, s59
    v_accvgpr_write_b32 a128, v80
    v_accvgpr_write_b32 a129, v81
    v_accvgpr_write_b32 a130, v82
    v_accvgpr_write_b32 a131, v83
    v_accvgpr_write_b32 a132, v84
    v_accvgpr_write_b32 a133, v85
    v_accvgpr_write_b32 a134, v86
    v_accvgpr_write_b32 a135, v87
    s_mov_b64 exec, s[96:97]
    buffer_load_dword v104, v6, s[80:83], s50 offen
    buffer_load_dword v105, v6, s[80:83], s51 offen
    buffer_load_dword v106, v6, s[80:83], s52 offen
    buffer_load_dword v107, v6, s[80:83], s53 offen
    buffer_load_dword v108, v6, s[80:83], s54 offen
    buffer_load_dword v109, v6, s[80:83], s55 offen
    buffer_load_dword v110, v6, s[80:83], s56 offen
    buffer_load_dword v111, v6, s[80:83], s57 offen
    s_not_b64 exec, exec
    buffer_load_dword v104, v6, s[84:87], s50 offen
    buffer_load_dword v105, v6, s[84:87], s51 offen
    buffer_load_dword v106, v6, s[84:87], s52 offen
    buffer_load_dword v107, v6, s[84:87], s53 offen
    buffer_load_dword v108, v6, s[84:87], s54 offen
    buffer_load_dword v109, v6, s[84:87], s55 offen
    buffer_load_dword v110, v6, s[84:87], s56 offen
    buffer_load_dword v111, v6, s[84:87], s57 offen
    s_mov_b64 exec, -1
    v_add_u32 v6, 57344, v6
    s_waitcnt vmcnt(32)
    v_perm_b32 v80, v113, v112, s58
    v_perm_b32 v81, v115, v114, s58
    v_perm_b32 v82, v117, v116, s58
    v_perm_b32 v83, v119, v118, s58
    v_perm_b32 v84, v113, v112, s59
    v_perm_b32 v85, v115, v114, s59
    v_perm_b32 v86, v117, v116, s59
    v_perm_b32 v87, v119, v118, s59
    v_accvgpr_write_b32 a136, v80
    v_accvgpr_write_b32 a137, v81
    v_accvgpr_write_b32 a138, v82
    v_accvgpr_write_b32 a139, v83
    v_accvgpr_write_b32 a140, v84
    v_accvgpr_write_b32 a141, v85
    v_accvgpr_write_b32 a142, v86
    v_accvgpr_write_b32 a143, v87
    s_mov_b64 exec, s[96:97]
    buffer_load_dword v112, v6, s[80:83], s50 offen
    buffer_load_dword v113, v6, s[80:83], s51 offen
    buffer_load_dword v114, v6, s[80:83], s52 offen
    buffer_load_dword v115, v6, s[80:83], s53 offen
    buffer_load_dword v116, v6, s[80:83], s54 offen
    buffer_load_dword v117, v6, s[80:83], s55 offen
    buffer_load_dword v118, v6, s[80:83], s56 offen
    buffer_load_dword v119, v6, s[80:83], s57 offen
    s_not_b64 exec, exec
    buffer_load_dword v112, v6, s[84:87], s50 offen
    buffer_load_dword v113, v6, s[84:87], s51 offen
    buffer_load_dword v114, v6, s[84:87], s52 offen
    buffer_load_dword v115, v6, s[84:87], s53 offen
    buffer_load_dword v116, v6, s[84:87], s54 offen
    buffer_load_dword v117, v6, s[84:87], s55 offen
    buffer_load_dword v118, v6, s[84:87], s56 offen
    buffer_load_dword v119, v6, s[84:87], s57 offen
    s_mov_b64 exec, -1
    v_add_u32 v6, 57344, v6
    s_waitcnt vmcnt(32)
    v_perm_b32 v80, v97, v96, s58
    v_perm_b32 v81, v99, v98, s58
    v_perm_b32 v82, v101, v100, s58
    v_perm_b32 v83, v103, v102, s58
    v_perm_b32 v84, v97, v96, s59
    v_perm_b32 v85, v99, v98, s59
    v_perm_b32 v86, v101, v100, s59
    v_perm_b32 v87, v103, v102, s59
    v_accvgpr_write_b32 a144, v80
    v_accvgpr_write_b32 a145, v81
    v_accvgpr_write_b32 a146, v82
    v_accvgpr_write_b32 a147, v83
    v_accvgpr_write_b32 a148, v84
    v_accvgpr_write_b32 a149, v85
    v_accvgpr_write_b32 a150, v86
    v_accvgpr_write_b32 a151, v87
    s_mov_b64 exec, s[96:97]
    buffer_load_dword v96, v6, s[80:83], s50 offen
    buffer_load_dword v97, v6, s[80:83], s51 offen
    buffer_load_dword v98, v6, s[80:83], s52 offen
    buffer_load_dword v99, v6, s[80:83], s53 offen
    buffer_load_dword v100, v6, s[80:83], s54 offen
    buffer_load_dword v101, v6, s[80:83], s55 offen
    buffer_load_dword v102, v6, s[80:83], s56 offen
    buffer_load_dword v103, v6, s[80:83], s57 offen
    s_not_b64 exec, exec
    buffer_load_dword v96, v6, s[84:87], s50 offen
    buffer_load_dword v97, v6, s[84:87], s51 offen
    buffer_load_dword v98, v6, s[84:87], s52 offen
    buffer_load_dword v99, v6, s[84:87], s53 offen
    buffer_load_dword v100, v6, s[84:87], s54 offen
    buffer_load_dword v101, v6, s[84:87], s55 offen
    buffer_load_dword v102, v6, s[84:87], s56 offen
    buffer_load_dword v103, v6, s[84:87], s57 offen
    s_mov_b64 exec, -1
    v_add_u32 v6, 57344, v6
    s_waitcnt vmcnt(32)
    v_perm_b32 v80, v105, v104, s58
    v_perm_b32 v81, v107, v106, s58
    v_perm_b32 v82, v109, v108, s58
    v_perm_b32 v83, v111, v110, s58
    v_perm_b32 v84, v105, v104, s59
    v_perm_b32 v85, v107, v106, s59
    v_perm_b32 v86, v109, v108, s59
    v_perm_b32 v87, v111, v110, s59
    v_accvgpr_write_b32 a152, v80
    v_accvgpr_write_b32 a153, v81
    v_accvgpr_write_b32 a154, v82
    v_accvgpr_write_b32 a155, v83
    v_accvgpr_write_b32 a156, v84
    v_accvgpr_write_b32 a157, v85
    v_accvgpr_write_b32 a158, v86
    v_accvgpr_write_b32 a159, v87
    s_mov_b64 exec, s[96:97]
    buffer_load_dword v104, v6, s[80:83], s50 offen
    buffer_load_dword v105, v6, s[80:83], s51 offen
    buffer_load_dword v106, v6, s[80:83], s52 offen
    buffer_load_dword v107, v6, s[80:83], s53 offen
    buffer_load_dword v108, v6, s[80:83], s54 offen
    buffer_load_dword v109, v6, s[80:83], s55 offen
    buffer_load_dword v110, v6, s[80:83], s56 offen
    buffer_load_dword v111, v6, s[80:83], s57 offen
    s_not_b64 exec, exec
    buffer_load_dword v104, v6, s[84:87], s50 offen
    buffer_load_dword v105, v6, s[84:87], s51 offen
    buffer_load_dword v106, v6, s[84:87], s52 offen
    buffer_load_dword v107, v6, s[84:87], s53 offen
    buffer_load_dword v108, v6, s[84:87], s54 offen
    buffer_load_dword v109, v6, s[84:87], s55 offen
    buffer_load_dword v110, v6, s[84:87], s56 offen
    buffer_load_dword v111, v6, s[84:87], s57 offen
    s_mov_b64 exec, -1
    v_add_u32 v6, 57344, v6
    s_waitcnt vmcnt(32)
    v_perm_b32 v80, v113, v112, s58
    v_perm_b32 v81, v115, v114, s58
    v_perm_b32 v82, v117, v116, s58
    v_perm_b32 v83, v119, v118, s58
    v_perm_b32 v84, v113, v112, s59
    v_perm_b32 v85, v115, v114, s59
    v_perm_b32 v86, v117, v116, s59
    v_perm_b32 v87, v119, v118, s59
    v_accvgpr_write_b32 a160, v80
    v_accvgpr_write_b32 a161, v81
    v_accvgpr_write_b32 a162, v82
    v_accvgpr_write_b32 a163, v83
    v_accvgpr_write_b32 a164, v84
    v_accvgpr_write_b32 a165, v85
    v_accvgpr_write_b32 a166, v86
    v_accvgpr_write_b32 a167, v87
    s_mov_b64 exec, s[96:97]
    buffer_load_dword v112, v6, s[80:83], s50 offen
    buffer_load_dword v113, v6, s[80:83], s51 offen
    buffer_load_dword v114, v6, s[80:83], s52 offen
    buffer_load_dword v115, v6, s[80:83], s53 offen
    buffer_load_dword v116, v6, s[80:83], s54 offen
    buffer_load_dword v117, v6, s[80:83], s55 offen
    buffer_load_dword v118, v6, s[80:83], s56 offen
    buffer_load_dword v119, v6, s[80:83], s57 offen
    s_not_b64 exec, exec
    buffer_load_dword v112, v6, s[84:87], s50 offen
    buffer_load_dword v113, v6, s[84:87], s51 offen
    buffer_load_dword v114, v6, s[84:87], s52 offen
    buffer_load_dword v115, v6, s[84:87], s53 offen
    buffer_load_dword v116, v6, s[84:87], s54 offen
    buffer_load_dword v117, v6, s[84:87], s55 offen
    buffer_load_dword v118, v6, s[84:87], s56 offen
    buffer_load_dword v119, v6, s[84:87], s57 offen
    s_mov_b64 exec, -1
    v_add_u32 v6, 57344, v6
    s_waitcnt vmcnt(32)
    v_perm_b32 v80, v97, v96, s58
    v_perm_b32 v81, v99, v98, s58
    v_perm_b32 v82, v101, v100, s58
    v_perm_b32 v83, v103, v102, s58
    v_perm_b32 v84, v97, v96, s59
    v_perm_b32 v85, v99, v98, s59
    v_perm_b32 v86, v101, v100, s59
    v_perm_b32 v87, v103, v102, s59
    v_accvgpr_write_b32 a168, v80
    v_accvgpr_write_b32 a169, v81
    v_accvgpr_write_b32 a170, v82
    v_accvgpr_write_b32 a171, v83
    v_accvgpr_write_b32 a172, v84
    v_accvgpr_write_b32 a173, v85
    v_accvgpr_write_b32 a174, v86
    v_accvgpr_write_b32 a175, v87
    s_mov_b64 exec, s[96:97]
    buffer_load_dword v96, v6, s[80:83], s50 offen
    buffer_load_dword v97, v6, s[80:83], s51 offen
    buffer_load_dword v98, v6, s[80:83], s52 offen
    buffer_load_dword v99, v6, s[80:83], s53 offen
    buffer_load_dword v100, v6, s[80:83], s54 offen
    buffer_load_dword v101, v6, s[80:83], s55 offen
    buffer_load_dword v102, v6, s[80:83], s56 offen
    buffer_load_dword v103, v6, s[80:83], s57 offen
    s_not_b64 exec, exec
    buffer_load_dword v96, v6, s[84:87], s50 offen
    buffer_load_dword v97, v6, s[84:87], s51 offen
    buffer_load_dword v98, v6, s[84:87], s52 offen
    buffer_load_dword v99, v6, s[84:87], s53 offen
    buffer_load_dword v100, v6, s[84:87], s54 offen
    buffer_load_dword v101, v6, s[84:87], s55 offen
    buffer_load_dword v102, v6, s[84:87], s56 offen
    buffer_load_dword v103, v6, s[84:87], s57 offen
    s_mov_b64 exec, -1
    v_add_u32 v6, 57344, v6
    s_waitcnt vmcnt(32)
    v_perm_b32 v80, v105, v104, s58
    v_perm_b32 v81, v107, v106, s58
    v_perm_b32 v82, v109, v108, s58
    v_perm_b32 v83, v111, v110, s58
    v_perm_b32 v84, v105, v104, s59
    v_perm_b32 v85, v107, v106, s59
    v_perm_b32 v86, v109, v108, s59
    v_perm_b32 v87, v111, v110, s59
    v_accvgpr_write_b32 a176, v80
    v_accvgpr_write_b32 a177, v81
    v_accvgpr_write_b32 a178, v82
    v_accvgpr_write_b32 a179, v83
    v_accvgpr_write_b32 a180, v84
    v_accvgpr_write_b32 a181, v85
    v_accvgpr_write_b32 a182, v86
    v_accvgpr_write_b32 a183, v87
    s_mov_b64 exec, s[96:97]
    buffer_load_dword v104, v6, s[80:83], s50 offen
    buffer_load_dword v105, v6, s[80:83], s51 offen
    buffer_load_dword v106, v6, s[80:83], s52 offen
    buffer_load_dword v107, v6, s[80:83], s53 offen
    buffer_load_dword v108, v6, s[80:83], s54 offen
    buffer_load_dword v109, v6, s[80:83], s55 offen
    buffer_load_dword v110, v6, s[80:83], s56 offen
    buffer_load_dword v111, v6, s[80:83], s57 offen
    s_not_b64 exec, exec
    buffer_load_dword v104, v6, s[84:87], s50 offen
    buffer_load_dword v105, v6, s[84:87], s51 offen
    buffer_load_dword v106, v6, s[84:87], s52 offen
    buffer_load_dword v107, v6, s[84:87], s53 offen
    buffer_load_dword v108, v6, s[84:87], s54 offen
    buffer_load_dword v109, v6, s[84:87], s55 offen
    buffer_load_dword v110, v6, s[84:87], s56 offen
    buffer_load_dword v111, v6, s[84:87], s57 offen
    s_mov_b64 exec, -1
    v_add_u32 v6, 57344, v6
    s_waitcnt vmcnt(32)
    v_perm_b32 v80, v113, v112, s58
    v_perm_b32 v81, v115, v114, s58
    v_perm_b32 v82, v117, v116, s58
    v_perm_b32 v83, v119, v118, s58
    v_perm_b32 v84, v113, v112, s59
    v_perm_b32 v85, v115, v114, s59
    v_perm_b32 v86, v117, v116, s59
    v_perm_b32 v87, v119, v118, s59
    v_accvgpr_write_b32 a184, v80
    v_accvgpr_write_b32 a185, v81
    v_accvgpr_write_b32 a186, v82
    v_accvgpr_write_b32 a187, v83
    v_accvgpr_write_b32 a188, v84
    v_accvgpr_write_b32 a189, v85
    v_accvgpr_write_b32 a190, v86
    v_accvgpr_write_b32 a191, v87
    s_mov_b64 exec, s[96:97]
    buffer_load_dword v112, v6, s[80:83], s50 offen
    buffer_load_dword v113, v6, s[80:83], s51 offen
    buffer_load_dword v114, v6, s[80:83], s52 offen
    buffer_load_dword v115, v6, s[80:83], s53 offen
    buffer_load_dword v116, v6, s[80:83], s54 offen
    buffer_load_dword v117, v6, s[80:83], s55 offen
    buffer_load_dword v118, v6, s[80:83], s56 offen
    buffer_load_dword v119, v6, s[80:83], s57 offen
    s_not_b64 exec, exec
    buffer_load_dword v112, v6, s[84:87], s50 offen
    buffer_load_dword v113, v6, s[84:87], s51 offen
    buffer_load_dword v114, v6, s[84:87], s52 offen
    buffer_load_dword v115, v6, s[84:87], s53 offen
    buffer_load_dword v116, v6, s[84:87], s54 offen
    buffer_load_dword v117, v6, s[84:87], s55 offen
    buffer_load_dword v118, v6, s[84:87], s56 offen
    buffer_load_dword v119, v6, s[84:87], s57 offen
    s_mov_b64 exec, -1
    v_add_u32 v6, 57344, v6
    s_waitcnt vmcnt(32)
    v_perm_b32 v80, v97, v96, s58
    v_perm_b32 v81, v99, v98, s58
    v_perm_b32 v82, v101, v100, s58
    v_perm_b32 v83, v103, v102, s58
    v_perm_b32 v84, v97, v96, s59
    v_perm_b32 v85, v99, v98, s59
    v_perm_b32 v86, v101, v100, s59
    v_perm_b32 v87, v103, v102, s59
    v_accvgpr_write_b32 a192, v80
    v_accvgpr_write_b32 a193, v81
    v_accvgpr_write_b32 a194, v82
    v_accvgpr_write_b32 a195, v83
    v_accvgpr_write_b32 a196, v84
    v_accvgpr_write_b32 a197, v85
    v_accvgpr_write_b32 a198, v86
    v_accvgpr_write_b32 a199, v87
    s_mov_b64 exec, s[96:97]
    buffer_load_dword v96, v6, s[80:83], s50 offen
    buffer_load_dword v97, v6, s[80:83], s51 offen
    buffer_load_dword v98, v6, s[80:83], s52 offen
    buffer_load_dword v99, v6, s[80:83], s53 offen
    buffer_load_dword v100, v6, s[80:83], s54 offen
    buffer_load_dword v101, v6, s[80:83], s55 offen
    buffer_load_dword v102, v6, s[80:83], s56 offen
    buffer_load_dword v103, v6, s[80:83], s57 offen
    s_not_b64 exec, exec
    buffer_load_dword v96, v6, s[84:87], s50 offen
    buffer_load_dword v97, v6, s[84:87], s51 offen
    buffer_load_dword v98, v6, s[84:87], s52 offen
    buffer_load_dword v99, v6, s[84:87], s53 offen
    buffer_load_dword v100, v6, s[84:87], s54 offen
    buffer_load_dword v101, v6, s[84:87], s55 offen
    buffer_load_dword v102, v6, s[84:87], s56 offen
    buffer_load_dword v103, v6, s[84:87], s57 offen
    s_mov_b64 exec, -1
    v_add_u32 v6, 57344, v6
    s_waitcnt vmcnt(32)
    v_perm_b32 v80, v105, v104, s58
    v_perm_b32 v81, v107, v106, s58
    v_perm_b32 v82, v109, v108, s58
    v_perm_b32 v83, v111, v110, s58
    v_perm_b32 v84, v105, v104, s59
    v_perm_b32 v85, v107, v106, s59
    v_perm_b32 v86, v109, v108, s59
    v_perm_b32 v87, v111, v110, s59
    v_accvgpr_write_b32 a200, v80
    v_accvgpr_write_b32 a201, v81
    v_accvgpr_write_b32 a202, v82
    v_accvgpr_write_b32 a203, v83
    v_accvgpr_write_b32 a204, v84
    v_accvgpr_write_b32 a205, v85
    v_accvgpr_write_b32 a206, v86
    v_accvgpr_write_b32 a207, v87
    s_mov_b64 exec, s[96:97]
    buffer_load_dword v104, v6, s[80:83], s50 offen
    buffer_load_dword v105, v6, s[80:83], s51 offen
    buffer_load_dword v106, v6, s[80:83], s52 offen
    buffer_load_dword v107, v6, s[80:83], s53 offen
    buffer_load_dword v108, v6, s[80:83], s54 offen
    buffer_load_dword v109, v6, s[80:83], s55 offen
    buffer_load_dword v110, v6, s[80:83], s56 offen
    buffer_load_dword v111, v6, s[80:83], s57 offen
    s_not_b64 exec, exec
    buffer_load_dword v104, v6, s[84:87], s50 offen
    buffer_load_dword v105, v6, s[84:87], s51 offen
    buffer_load_dword v106, v6, s[84:87], s52 offen
    buffer_load_dword v107, v6, s[84:87], s53 offen
    buffer_load_dword v108, v6, s[84:87], s54 offen
    buffer_load_dword v109, v6, s[84:87], s55 offen
    buffer_load_dword v110, v6, s[84:87], s56 offen
    buffer_load_dword v111, v6, s[84:87], s57 offen
    s_mov_b64 exec, -1
    v_add_u32 v6, 57344, v6
    s_waitcnt vmcnt(32)
    v_perm_b32 v80, v113, v112, s58
    v_perm_b32 v81, v115, v114, s58
    v_perm_b32 v82, v117, v116, s58
    v_perm_b32 v83, v119, v118, s58
    v_perm_b32 v84, v113, v112, s59
    v_perm_b32 v85, v115, v114, s59
    v_perm_b32 v86, v117, v116, s59
    v_perm_b32 v87, v119, v118, s59
    v_accvgpr_write_b32 a208, v80
    v_accvgpr_write_b32 a209, v81
    v_accvgpr_write_b32 a210, v82
    v_accvgpr_write_b32 a211, v83
    v_accvgpr_write_b32 a212, v84
    v_accvgpr_write_b32 a213, v85
    v_accvgpr_write_b32 a214, v86
    v_accvgpr_write_b32 a215, v87
    s_mov_b64 exec, s[96:97]
    buffer_load_dword v112, v6, s[80:83], s50 offen
    buffer_load_dword v113, v6, s[80:83], s51 offen
    buffer_load_dword v114, v6, s[80:83], s52 offen
    buffer_load_dword v115, v6, s[80:83], s53 offen
    buffer_load_dword v116, v6, s[80:83], s54 offen
    buffer_load_dword v117, v6, s[80:83], s55 offen
    buffer_load_dword v118, v6, s[80:83], s56 offen
    buffer_load_dword v119, v6, s[80:83], s57 offen
    s_not_b64 exec, exec
    buffer_load_dword v112, v6, s[84:87], s50 offen
    buffer_load_dword v113, v6, s[84:87], s51 offen
    buffer_load_dword v114, v6, s[84:87], s52 offen
    buffer_load_dword v115, v6, s[84:87], s53 offen
    buffer_load_dword v116, v6, s[84:87], s54 offen
    buffer_load_dword v117, v6, s[84:87], s55 offen
    buffer_load_dword v118, v6, s[84:87], s56 offen
    buffer_load_dword v119, v6, s[84:87], s57 offen
    s_mov_b64 exec, -1
    v_add_u32 v6, 57344, v6
    s_waitcnt vmcnt(32)
    v_perm_b32 v80, v97, v96, s58
    v_perm_b32 v81, v99, v98, s58
    v_perm_b32 v82, v101, v100, s58
    v_perm_b32 v83, v103, v102, s58
    v_perm_b32 v84, v97, v96, s59
    v_perm_b32 v85, v99, v98, s59
    v_perm_b32 v86, v101, v100, s59
    v_perm_b32 v87, v103, v102, s59
    v_accvgpr_write_b32 a216, v80
    v_accvgpr_write_b32 a217, v81
    v_accvgpr_write_b32 a218, v82
    v_accvgpr_write_b32 a219, v83
    v_accvgpr_write_b32 a220, v84
    v_accvgpr_write_b32 a221, v85
    v_accvgpr_write_b32 a222, v86
    v_accvgpr_write_b32 a223, v87
    s_mov_b64 exec, s[96:97]
    buffer_load_dword v96, v6, s[80:83], s50 offen
    buffer_load_dword v97, v6, s[80:83], s51 offen
    buffer_load_dword v98, v6, s[80:83], s52 offen
    buffer_load_dword v99, v6, s[80:83], s53 offen
    buffer_load_dword v100, v6, s[80:83], s54 offen
    buffer_load_dword v101, v6, s[80:83], s55 offen
    buffer_load_dword v102, v6, s[80:83], s56 offen
    buffer_load_dword v103, v6, s[80:83], s57 offen
    s_not_b64 exec, exec
    buffer_load_dword v96, v6, s[84:87], s50 offen
    buffer_load_dword v97, v6, s[84:87], s51 offen
    buffer_load_dword v98, v6, s[84:87], s52 offen
    buffer_load_dword v99, v6, s[84:87], s53 offen
    buffer_load_dword v100, v6, s[84:87], s54 offen
    buffer_load_dword v101, v6, s[84:87], s55 offen
    buffer_load_dword v102, v6, s[84:87], s56 offen
    buffer_load_dword v103, v6, s[84:87], s57 offen
    s_mov_b64 exec, -1
    v_add_u32 v6, 57344, v6
    s_waitcnt vmcnt(32)
    v_perm_b32 v80, v105, v104, s58
    v_perm_b32 v81, v107, v106, s58
    v_perm_b32 v82, v109, v108, s58
    v_perm_b32 v83, v111, v110, s58
    v_perm_b32 v84, v105, v104, s59
    v_perm_b32 v85, v107, v106, s59
    v_perm_b32 v86, v109, v108, s59
    v_perm_b32 v87, v111, v110, s59
    v_accvgpr_write_b32 a224, v80
    v_accvgpr_write_b32 a225, v81
    v_accvgpr_write_b32 a226, v82
    v_accvgpr_write_b32 a227, v83
    v_accvgpr_write_b32 a228, v84
    v_accvgpr_write_b32 a229, v85
    v_accvgpr_write_b32 a230, v86
    v_accvgpr_write_b32 a231, v87
    s_mov_b64 exec, s[96:97]
    buffer_load_dword v104, v6, s[80:83], s50 offen
    buffer_load_dword v105, v6, s[80:83], s51 offen
    buffer_load_dword v106, v6, s[80:83], s52 offen
    buffer_load_dword v107, v6, s[80:83], s53 offen
    buffer_load_dword v108, v6, s[80:83], s54 offen
    buffer_load_dword v109, v6, s[80:83], s55 offen
    buffer_load_dword v110, v6, s[80:83], s56 offen
    buffer_load_dword v111, v6, s[80:83], s57 offen
    s_not_b64 exec, exec
    buffer_load_dword v104, v6, s[84:87], s50 offen
    buffer_load_dword v105, v6, s[84:87], s51 offen
    buffer_load_dword v106, v6, s[84:87], s52 offen
    buffer_load_dword v107, v6, s[84:87], s53 offen
    buffer_load_dword v108, v6, s[84:87], s54 offen
    buffer_load_dword v109, v6, s[84:87], s55 offen
    buffer_load_dword v110, v6, s[84:87], s56 offen
    buffer_load_dword v111, v6, s[84:87], s57 offen
    s_mov_b64 exec, -1
    s_waitcnt vmcnt(32)
    v_perm_b32 v80, v113, v112, s58
    v_perm_b32 v81, v115, v114, s58
    v_perm_b32 v82, v117, v116, s58
    v_perm_b32 v83, v119, v118, s58
    v_perm_b32 v84, v113, v112, s59
    v_perm_b32 v85, v115, v114, s59
    v_perm_b32 v86, v117, v116, s59
    v_perm_b32 v87, v119, v118, s59
    v_accvgpr_write_b32 a232, v80
    v_accvgpr_write_b32 a233, v81
    v_accvgpr_write_b32 a234, v82
    v_accvgpr_write_b32 a235, v83
    v_accvgpr_write_b32 a236, v84
    v_accvgpr_write_b32 a237, v85
    v_accvgpr_write_b32 a238, v86
    v_accvgpr_write_b32 a239, v87
    s_waitcnt vmcnt(16)
    v_perm_b32 v80, v97, v96, s58
    v_perm_b32 v81, v99, v98, s58
    v_perm_b32 v82, v101, v100, s58
    v_perm_b32 v83, v103, v102, s58
    v_perm_b32 v84, v97, v96, s59
    v_perm_b32 v85, v99, v98, s59
    v_perm_b32 v86, v101, v100, s59
    v_perm_b32 v87, v103, v102, s59
    v_accvgpr_write_b32 a240, v80
    v_accvgpr_write_b32 a241, v81
    v_accvgpr_write_b32 a242, v82
    v_accvgpr_write_b32 a243, v83
    v_accvgpr_write_b32 a244, v84
    v_accvgpr_write_b32 a245, v85
    v_accvgpr_write_b32 a246, v86
    v_accvgpr_write_b32 a247, v87
    s_waitcnt vmcnt(0)
    v_perm_b32 v80, v105, v104, s58
    v_perm_b32 v81, v107, v106, s58
    v_perm_b32 v82, v109, v108, s58
    v_perm_b32 v83, v111, v110, s58
    v_perm_b32 v84, v105, v104, s59
    v_perm_b32 v85, v107, v106, s59
    v_perm_b32 v86, v109, v108, s59
    v_perm_b32 v87, v111, v110, s59
    v_accvgpr_write_b32 a248, v80
    v_accvgpr_write_b32 a249, v81
    v_accvgpr_write_b32 a250, v82
    v_accvgpr_write_b32 a251, v83
    v_accvgpr_write_b32 a252, v84
    v_accvgpr_write_b32 a253, v85
    v_accvgpr_write_b32 a254, v86
    v_accvgpr_write_b32 a255, v87
    s_branch L_wl_done
L_p1_done:
    s_waitcnt vmcnt(0)
    s_barrier
    s_mov_b64 exec, s[64:65]
    buffer_store_dword v5, off, s[8:11], s73 sc1
    s_mov_b64 exec, -1
    s_cmp_lg_u32 s46, 0
    s_cbranch_scc1 L_p2
    s_mov_b32 s46, 1
    s_mov_b32 s60, s12
    s_mov_b32 s61, s13
    s_add_u32 s47, s43, 64
    s_lshl_b32 s47, s47, 5
    s_add_u32 s47, s47, s40
    s_lshl_b32 s47, s47, 6
    s_add_u32 s73, s47, 655360
    s_mov_b32 s75, 0
    v_mov_b64 v[88:89], 0
    v_mov_b64 v[90:91], 0
    s_lshl_b32 s47, s43, 21
    s_lshl_b32 s48, s40, 15
    s_add_u32 s47, s47, s48
    s_lshl_b32 s48, s41, 13
    s_add_u32 s47, s47, s48
    s_add_u32 s47, s47, 83886080
    buffer_store_dwordx4 v[88:91], v0, s[8:11], s47 offen offset:0 sc1
    buffer_store_dwordx4 v[88:91], v0, s[8:11], s47 offen offset:1024 sc1
    buffer_store_dwordx4 v[88:91], v0, s[8:11], s47 offen offset:2048 sc1
    buffer_store_dwordx4 v[88:91], v0, s[8:11], s47 offen offset:3072 sc1
    s_add_u32 s47, s47, 4096
    buffer_store_dwordx4 v[88:91], v0, s[8:11], s47 offen offset:0 sc1
    buffer_store_dwordx4 v[88:91], v0, s[8:11], s47 offen offset:1024 sc1
    buffer_store_dwordx4 v[88:91], v0, s[8:11], s47 offen offset:2048 sc1
    buffer_store_dwordx4 v[88:91], v0, s[8:11], s47 offen offset:3072 sc1
    s_add_u32 s47, s47, 1044480
    buffer_store_dwordx4 v[88:91], v0, s[8:11], s47 offen offset:0 sc1
    buffer_store_dwordx4 v[88:91], v0, s[8:11], s47 offen offset:1024 sc1
    buffer_store_dwordx4 v[88:91], v0, s[8:11], s47 offen offset:2048 sc1
    buffer_store_dwordx4 v[88:91], v0, s[8:11], s47 offen offset:3072 sc1
    s_add_u32 s47, s47, 4096
    buffer_store_dwordx4 v[88:91], v0, s[8:11], s47 offen offset:0 sc1
    buffer_store_dwordx4 v[88:91], v0, s[8:11], s47 offen offset:1024 sc1
    buffer_store_dwordx4 v[88:91], v0, s[8:11], s47 offen offset:2048 sc1
    buffer_store_dwordx4 v[88:91], v0, s[8:11], s47 offen offset:3072 sc1
    s_branch L_pass
L_p2:
    v_lshlrev_b32 v6, 13, v20
    v_lshl_add_u32 v6, v23, 3, v6
    s_lshl_b32 s47, s41, 8
    v_add_u32 v6, s47, v6
    s_lshl_b32 s47, s40, 17
    s_mov_b32 s48, 0x05040100
    buffer_load_dwordx2 v[96:97], v6, s[24:27], s47 offen offset:0
    buffer_load_dwordx2 v[98:99], v6, s[24:27], s47 offen offset:1024
    buffer_load_dwordx2 v[100:101], v6, s[24:27], s47 offen offset:2048
    buffer_load_dwordx2 v[102:103], v6, s[24:27], s47 offen offset:3072
    s_add_u32 s47, s47, 4096
    buffer_load_dwordx2 v[104:105], v6, s[24:27], s47 offen offset:0
    buffer_load_dwordx2 v[106:107], v6, s[24:27], s47 offen offset:1024
    buffer_load_dwordx2 v[108:109], v6, s[24:27], s47 offen offset:2048
    buffer_load_dwordx2 v[110:111], v6, s[24:27], s47 offen offset:3072
    s_add_u32 s47, s47, 12288
    buffer_load_dwordx2 v[112:113], v6, s[24:27], s47 offen offset:0
    buffer_load_dwordx2 v[114:115], v6, s[24:27], s47 offen offset:1024
    buffer_load_dwordx2 v[116:117], v6, s[24:27], s47 offen offset:2048
    buffer_load_dwordx2 v[118:119], v6, s[24:27], s47 offen offset:3072
    s_add_u32 s47, s47, 4096
    buffer_load_dwordx2 v[120:121], v6, s[24:27], s47 offen offset:0
    buffer_load_dwordx2 v[122:123], v6, s[24:27], s47 offen offset:1024
    buffer_load_dwordx2 v[124:125], v6, s[24:27], s47 offen offset:2048
    buffer_load_dwordx2 v[126:127], v6, s[24:27], s47 offen offset:3072
    s_add_u32 s47, s47, 12288
    buffer_load_dwordx2 v[128:129], v6, s[24:27], s47 offen offset:0
    buffer_load_dwordx2 v[130:131], v6, s[24:27], s47 offen offset:1024
    buffer_load_dwordx2 v[132:133], v6, s[24:27], s47 offen offset:2048
    buffer_load_dwordx2 v[134:135], v6, s[24:27], s47 offen offset:3072
    s_add_u32 s47, s47, 4096
    buffer_load_dwordx2 v[136:137], v6, s[24:27], s47 offen offset:0
    buffer_load_dwordx2 v[138:139], v6, s[24:27], s47 offen offset:1024
    buffer_load_dwordx2 v[140:141], v6, s[24:27], s47 offen offset:2048
    buffer_load_dwordx2 v[142:143], v6, s[24:27], s47 offen offset:3072
    s_add_u32 s47, s47, 12288
    buffer_load_dwordx2 v[144:145], v6, s[24:27], s47 offen offset:0
    buffer_load_dwordx2 v[146:147], v6, s[24:27], s47 offen offset:1024
    buffer_load_dwordx2 v[148:149], v6, s[24:27], s47 offen offset:2048
    buffer_load_dwordx2 v[150:151], v6, s[24:27], s47 offen offset:3072
    s_add_u32 s47, s47, 4096
    buffer_load_dwordx2 v[152:153], v6, s[24:27], s47 offen offset:0
    buffer_load_dwordx2 v[154:155], v6, s[24:27], s47 offen offset:1024
    buffer_load_dwordx2 v[156:157], v6, s[24:27], s47 offen offset:2048
    buffer_load_dwordx2 v[158:159], v6, s[24:27], s47 offen offset:3072
    s_add_u32 s47, s47, 12288
    buffer_load_dwordx2 v[160:161], v6, s[24:27], s47 offen offset:0
    buffer_load_dwordx2 v[162:163], v6, s[24:27], s47 offen offset:1024
    buffer_load_dwordx2 v[164:165], v6, s[24:27], s47 offen offset:2048
    buffer_load_dwordx2 v[166:167], v6, s[24:27], s47 offen offset:3072
    s_add_u32 s47, s47, 4096
    buffer_load_dwordx2 v[168:169], v6, s[24:27], s47 offen offset:0
    buffer_load_dwordx2 v[170:171], v6, s[24:27], s47 offen offset:1024
    buffer_load_dwordx2 v[172:173], v6, s[24:27], s47 offen offset:2048
    buffer_load_dwordx2 v[174:175], v6, s[24:27], s47 offen offset:3072
    s_add_u32 s47, s47, 12288
    buffer_load_dwordx2 v[176:177], v6, s[24:27], s47 offen offset:0
    buffer_load_dwordx2 v[178:179], v6, s[24:27], s47 offen offset:1024
    buffer_load_dwordx2 v[180:181], v6, s[24:27], s47 offen offset:2048
    buffer_load_dwordx2 v[182:183], v6, s[24:27], s47 offen offset:3072
    s_add_u32 s47, s47, 4096
    buffer_load_dwordx2 v[184:185], v6, s[24:27], s47 offen offset:0
    buffer_load_dwordx2 v[186:187], v6, s[24:27], s47 offen offset:1024
    buffer_load_dwordx2 v[188:189], v6, s[24:27], s47 offen offset:2048
    buffer_load_dwordx2 v[190:191], v6, s[24:27], s47 offen offset:3072
    s_add_u32 s47, s47, 12288
    buffer_load_dwordx2 v[192:193], v6, s[24:27], s47 offen offset:0
    buffer_load_dwordx2 v[194:195], v6, s[24:27], s47 offen offset:1024
    buffer_load_dwordx2 v[196:197], v6, s[24:27], s47 offen offset:2048
    buffer_load_dwordx2 v[198:199], v6, s[24:27], s47 offen offset:3072
    s_add_u32 s47, s47, 4096
    buffer_load_dwordx2 v[200:201], v6, s[24:27], s47 offen offset:0
    buffer_load_dwordx2 v[202:203], v6, s[24:27], s47 offen offset:1024
    buffer_load_dwordx2 v[204:205], v6, s[24:27], s47 offen offset:2048
    buffer_load_dwordx2 v[206:207], v6, s[24:27], s47 offen offset:3072
    s_add_u32 s47, s47, 12288
    s_waitcnt vmcnt(48)
    v_perm_b32 v80, v98, v96, s58
    v_perm_b32 v81, v102, v100, s58
    v_perm_b32 v82, v106, v104, s58
    v_perm_b32 v83, v110, v108, s58
    v_perm_b32 v84, v98, v96, s59
    v_perm_b32 v85, v102, v100, s59
    v_perm_b32 v86, v106, v104, s59
    v_perm_b32 v87, v110, v108, s59
    v_perm_b32 v88, v99, v97, s58
    v_perm_b32 v89, v103, v101, s58
    v_perm_b32 v90, v107, v105, s58
    v_perm_b32 v91, v111, v109, s58
    v_perm_b32 v92, v99, v97, s59
    v_perm_b32 v93, v103, v101, s59
    v_perm_b32 v94, v107, v105, s59
    v_perm_b32 v95, v111, v109, s59
    v_accvgpr_write_b32 a0, v80
    v_accvgpr_write_b32 a1, v81
    v_accvgpr_write_b32 a2, v82
    v_accvgpr_write_b32 a3, v83
    v_accvgpr_write_b32 a4, v84
    v_accvgpr_write_b32 a5, v85
    v_accvgpr_write_b32 a6, v86
    v_accvgpr_write_b32 a7, v87
    v_accvgpr_write_b32 a8, v88
    v_accvgpr_write_b32 a9, v89
    v_accvgpr_write_b32 a10, v90
    v_accvgpr_write_b32 a11, v91
    v_accvgpr_write_b32 a12, v92
    v_accvgpr_write_b32 a13, v93
    v_accvgpr_write_b32 a14, v94
    v_accvgpr_write_b32 a15, v95
    buffer_load_dwordx2 v[96:97], v6, s[24:27], s47 offen offset:0
    buffer_load_dwordx2 v[98:99], v6, s[24:27], s47 offen offset:1024
    buffer_load_dwordx2 v[100:101], v6, s[24:27], s47 offen offset:2048
    buffer_load_dwordx2 v[102:103], v6, s[24:27], s47 offen offset:3072
    s_add_u32 s47, s47, 4096
    buffer_load_dwordx2 v[104:105], v6, s[24:27], s47 offen offset:0
    buffer_load_dwordx2 v[106:107], v6, s[24:27], s47 offen offset:1024
    buffer_load_dwordx2 v[108:109], v6, s[24:27], s47 offen offset:2048
    buffer_load_dwordx2 v[110:111], v6, s[24:27], s47 offen offset:3072
    s_add_u32 s47, s47, 12288
    s_waitcnt vmcnt(48)
    v_perm_b32 v80, v114, v112, s58
    v_perm_b32 v81, v118, v116, s58
    v_perm_b32 v82, v122, v120, s58
    v_perm_b32 v83, v126, v124, s58
    v_perm_b32 v84, v114, v112, s59
    v_perm_b32 v85, v118, v116, s59
    v_perm_b32 v86, v122, v120, s59
    v_perm_b32 v87, v126, v124, s59
    v_perm_b32 v88, v115, v113, s58
    v_perm_b32 v89, v119, v117, s58
    v_perm_b32 v90, v123, v121, s58
    v_perm_b32 v91, v127, v125, s58
    v_perm_b32 v92, v115, v113, s59
    v_perm_b32 v93, v119, v117, s59
    v_perm_b32 v94, v123, v121, s59
    v_perm_b32 v95, v127, v125, s59
    v_accvgpr_write_b32 a16, v80
    v_accvgpr_write_b32 a17, v81
    v_accvgpr_write_b32 a18, v82
    v_accvgpr_write_b32 a19, v83
    v_accvgpr_write_b32 a20, v84
    v_accvgpr_write_b32 a21, v85
    v_accvgpr_write_b32 a22, v86
    v_accvgpr_write_b32 a23, v87
    v_accvgpr_write_b32 a24, v88
    v_accvgpr_write_b32 a25, v89
    v_accvgpr_write_b32 a26, v90
    v_accvgpr_write_b32 a27, v91
    v_accvgpr_write_b32 a28, v92
    v_accvgpr_write_b32 a29, v93
    v_accvgpr_write_b32 a30, v94
    v_accvgpr_write_b32 a31, v95
    s_lshl_b32 s47, s40, 16
    buffer_load_dwordx2 v[112:113], v6, s[88:91], s47 offen offset:0
    buffer_load_dwordx2 v[114:115], v6, s[88:91], s47 offen offset:1024
    buffer_load_dwordx2 v[116:117], v6, s[88:91], s47 offen offset:2048
    buffer_load_dwordx2 v[118:119], v6, s[88:91], s47 offen offset:3072
    s_add_u32 s47, s47, 4096
    buffer_load_dwordx2 v[120:121], v6, s[88:91], s47 offen offset:0
    buffer_load_dwordx2 v[122:123], v6, s[88:91], s47 offen offset:1024
    buffer_load_dwordx2 v[124:125], v6, s[88:91], s47 offen offset:2048
    buffer_load_dwordx2 v[126:127], v6, s[88:91], s47 offen offset:3072
    s_add_u32 s47, s47, 12288
    s_waitcnt vmcnt(48)
    v_perm_b32 v80, v130, v128, s58
    v_perm_b32 v81, v134, v132, s58
    v_perm_b32 v82, v138, v136, s58
    v_perm_b32 v83, v142, v140, s58
    v_perm_b32 v84, v130, v128, s59
    v_perm_b32 v85, v134, v132, s59
    v_perm_b32 v86, v138, v136, s59
    v_perm_b32 v87, v142, v140, s59
    v_perm_b32 v88, v131, v129, s58
    v_perm_b32 v89, v135, v133, s58
    v_perm_b32 v90, v139, v137, s58
    v_perm_b32 v91, v143, v141, s58
    v_perm_b32 v92, v131, v129, s59
    v_perm_b32 v93, v135, v133, s59
    v_perm_b32 v94, v139, v137, s59
    v_perm_b32 v95, v143, v141, s59
    v_accvgpr_write_b32 a32, v80
    v_accvgpr_write_b32 a33, v81
    v_accvgpr_write_b32 a34, v82
    v_accvgpr_write_b32 a35, v83
    v_accvgpr_write_b32 a36, v84
    v_accvgpr_write_b32 a37, v85
    v_accvgpr_write_b32 a38, v86
    v_accvgpr_write_b32 a39, v87
    v_accvgpr_write_b32 a40, v88
    v_accvgpr_write_b32 a41, v89
    v_accvgpr_write_b32 a42, v90
    v_accvgpr_write_b32 a43, v91
    v_accvgpr_write_b32 a44, v92
    v_accvgpr_write_b32 a45, v93
    v_accvgpr_write_b32 a46, v94
    v_accvgpr_write_b32 a47, v95
    buffer_load_dwordx2 v[128:129], v6, s[88:91], s47 offen offset:0
    buffer_load_dwordx2 v[130:131], v6, s[88:91], s47 offen offset:1024
    buffer_load_dwordx2 v[132:133], v6, s[88:91], s47 offen offset:2048
    buffer_load_dwordx2 v[134:135], v6, s[88:91], s47 offen offset:3072
    s_add_u32 s47, s47, 4096
    buffer_load_dwordx2 v[136:137], v6, s[88:91], s47 offen offset:0
    buffer_load_dwordx2 v[138:139], v6, s[88:91], s47 offen offset:1024
    buffer_load_dwordx2 v[140:141], v6, s[88:91], s47 offen offset:2048
    buffer_load_dwordx2 v[142:143], v6, s[88:91], s47 offen offset:3072
    s_add_u32 s47, s47, 12288
    s_waitcnt vmcnt(48)
    v_perm_b32 v80, v146, v144, s58
    v_perm_b32 v81, v150, v148, s58
    v_perm_b32 v82, v154, v152, s58
    v_perm_b32 v83, v158, v156, s58
    v_perm_b32 v84, v146, v144, s59
    v_perm_b32 v85, v150, v148, s59
    v_perm_b32 v86, v154, v152, s59
    v_perm_b32 v87, v158, v156, s59
    v_perm_b32 v88, v147, v145, s58
    v_perm_b32 v89, v151, v149, s58
    v_perm_b32 v90, v155, v153, s58
    v_perm_b32 v91, v159, v157, s58
    v_perm_b32 v92, v147, v145, s59
    v_perm_b32 v93, v151, v149, s59
    v_perm_b32 v94, v155, v153, s59
    v_perm_b32 v95, v159, v157, s59
    v_accvgpr_write_b32 a48, v80
    v_accvgpr_write_b32 a49, v81
    v_accvgpr_write_b32 a50, v82
    v_accvgpr_write_b32 a51, v83
    v_accvgpr_write_b32 a52, v84
    v_accvgpr_write_b32 a53, v85
    v_accvgpr_write_b32 a54, v86
    v_accvgpr_write_b32 a55, v87
    v_accvgpr_write_b32 a56, v88
    v_accvgpr_write_b32 a57, v89
    v_accvgpr_write_b32 a58, v90
    v_accvgpr_write_b32 a59, v91
    v_accvgpr_write_b32 a60, v92
    v_accvgpr_write_b32 a61, v93
    v_accvgpr_write_b32 a62, v94
    v_accvgpr_write_b32 a63, v95
    buffer_load_dwordx2 v[144:145], v6, s[88:91], s47 offen offset:0
    buffer_load_dwordx2 v[146:147], v6, s[88:91], s47 offen offset:1024
    buffer_load_dwordx2 v[148:149], v6, s[88:91], s47 offen offset:2048
    buffer_load_dwordx2 v[150:151], v6, s[88:91], s47 offen offset:3072
    s_add_u32 s47, s47, 4096
    buffer_load_dwordx2 v[152:153], v6, s[88:91], s47 offen offset:0
    buffer_load_dwordx2 v[154:155], v6, s[88:91], s47 offen offset:1024
    buffer_load_dwordx2 v[156:157], v6, s[88:91], s47 offen offset:2048
    buffer_load_dwordx2 v[158:159], v6, s[88:91], s47 offen offset:3072
    s_add_u32 s47, s47, 12288
    s_waitcnt vmcnt(48)
    v_perm_b32 v80, v162, v160, s58
    v_perm_b32 v81, v166, v164, s58
    v_perm_b32 v82, v170, v168, s58
    v_perm_b32 v83, v174, v172, s58
    v_perm_b32 v84, v162, v160, s59
    v_perm_b32 v85, v166, v164, s59
    v_perm_b32 v86, v170, v168, s59
    v_perm_b32 v87, v174, v172, s59
    v_perm_b32 v88, v163, v161, s58
    v_perm_b32 v89, v167, v165, s58
    v_perm_b32 v90, v171, v169, s58
    v_perm_b32 v91, v175, v173, s58
    v_perm_b32 v92, v163, v161, s59
    v_perm_b32 v93, v167, v165, s59
    v_perm_b32 v94, v171, v169, s59
    v_perm_b32 v95, v175, v173, s59
    v_accvgpr_write_b32 a64, v80
    v_accvgpr_write_b32 a65, v81
    v_accvgpr_write_b32 a66, v82
    v_accvgpr_write_b32 a67, v83
    v_accvgpr_write_b32 a68, v84
    v_accvgpr_write_b32 a69, v85
    v_accvgpr_write_b32 a70, v86
    v_accvgpr_write_b32 a71, v87
    v_accvgpr_write_b32 a72, v88
    v_accvgpr_write_b32 a73, v89
    v_accvgpr_write_b32 a74, v90
    v_accvgpr_write_b32 a75, v91
    v_accvgpr_write_b32 a76, v92
    v_accvgpr_write_b32 a77, v93
    v_accvgpr_write_b32 a78, v94
    v_accvgpr_write_b32 a79, v95
    buffer_load_dwordx2 v[160:161], v6, s[88:91], s47 offen offset:0
    buffer_load_dwordx2 v[162:163], v6, s[88:91], s47 offen offset:1024
    buffer_load_dwordx2 v[164:165], v6, s[88:91], s47 offen offset:2048
    buffer_load_dwordx2 v[166:167], v6, s[88:91], s47 offen offset:3072
    s_add_u32 s47, s47, 4096
    buffer_load_dwordx2 v[168:169], v6, s[88:91], s47 offen offset:0
    buffer_load_dwordx2 v[170:171], v6, s[88:91], s47 offen offset:1024
    buffer_load_dwordx2 v[172:173], v6, s[88:91], s47 offen offset:2048
    buffer_load_dwordx2 v[174:175], v6, s[88:91], s47 offen offset:3072
    s_add_u32 s47, s47, 12288
    s_waitcnt vmcnt(48)
    v_perm_b32 v80, v178, v176, s58
    v_perm_b32 v81, v182, v180, s58
    v_perm_b32 v82, v186, v184, s58
    v_perm_b32 v83, v190, v188, s58
    v_perm_b32 v84, v178, v176, s59
    v_perm_b32 v85, v182, v180, s59
    v_perm_b32 v86, v186, v184, s59
    v_perm_b32 v87, v190, v188, s59
    v_perm_b32 v88, v179, v177, s58
    v_perm_b32 v89, v183, v181, s58
    v_perm_b32 v90, v187, v185, s58
    v_perm_b32 v91, v191, v189, s58
    v_perm_b32 v92, v179, v177, s59
    v_perm_b32 v93, v183, v181, s59
    v_perm_b32 v94, v187, v185, s59
    v_perm_b32 v95, v191, v189, s59
    v_accvgpr_write_b32 a80, v80
    v_accvgpr_write_b32 a81, v81
    v_accvgpr_write_b32 a82, v82
    v_accvgpr_write_b32 a83, v83
    v_accvgpr_write_b32 a84, v84
    v_accvgpr_write_b32 a85, v85
    v_accvgpr_write_b32 a86, v86
    v_accvgpr_write_b32 a87, v87
    v_accvgpr_write_b32 a88, v88
    v_accvgpr_write_b32 a89, v89
    v_accvgpr_write_b32 a90, v90
    v_accvgpr_write_b32 a91, v91
    v_accvgpr_write_b32 a92, v92
    v_accvgpr_write_b32 a93, v93
    v_accvgpr_write_b32 a94, v94
    v_accvgpr_write_b32 a95, v95
    s_waitcnt vmcnt(40)
    v_perm_b32 v80, v194, v192, s58
    v_perm_b32 v81, v198, v196, s58
    v_perm_b32 v82, v202, v200, s58
    v_perm_b32 v83, v206, v204, s58
    v_perm_b32 v84, v194, v192, s59
    v_perm_b32 v85, v198, v196, s59
    v_perm_b32 v86, v202, v200, s59
    v_perm_b32 v87, v206, v204, s59
    v_perm_b32 v88, v195, v193, s58
    v_perm_b32 v89, v199, v197, s58
    v_perm_b32 v90, v203, v201, s58
    v_perm_b32 v91, v207, v205, s58
    v_perm_b32 v92, v195, v193, s59
    v_perm_b32 v93, v199, v197, s59
    v_perm_b32 v94, v203, v201, s59
    v_perm_b32 v95, v207, v205, s59
    v_accvgpr_write_b32 a96, v80
    v_accvgpr_write_b32 a97, v81
    v_accvgpr_write_b32 a98, v82
    v_accvgpr_write_b32 a99, v83
    v_accvgpr_write_b32 a100, v84
    v_accvgpr_write_b32 a101, v85
    v_accvgpr_write_b32 a102, v86
    v_accvgpr_write_b32 a103, v87
    v_accvgpr_write_b32 a104, v88
    v_accvgpr_write_b32 a105, v89
    v_accvgpr_write_b32 a106, v90
    v_accvgpr_write_b32 a107, v91
    v_accvgpr_write_b32 a108, v92
    v_accvgpr_write_b32 a109, v93
    v_accvgpr_write_b32 a110, v94
    v_accvgpr_write_b32 a111, v95
    s_waitcnt vmcnt(32)
    v_perm_b32 v80, v98, v96, s58
    v_perm_b32 v81, v102, v100, s58
    v_perm_b32 v82, v106, v104, s58
    v_perm_b32 v83, v110, v108, s58
    v_perm_b32 v84, v98, v96, s59
    v_perm_b32 v85, v102, v100, s59
    v_perm_b32 v86, v106, v104, s59
    v_perm_b32 v87, v110, v108, s59
    v_perm_b32 v88, v99, v97, s58
    v_perm_b32 v89, v103, v101, s58
    v_perm_b32 v90, v107, v105, s58
    v_perm_b32 v91, v111, v109, s58
    v_perm_b32 v92, v99, v97, s59
    v_perm_b32 v93, v103, v101, s59
    v_perm_b32 v94, v107, v105, s59
    v_perm_b32 v95, v111, v109, s59
    v_accvgpr_write_b32 a112, v80
    v_accvgpr_write_b32 a113, v81
    v_accvgpr_write_b32 a114, v82
    v_accvgpr_write_b32 a115, v83
    v_accvgpr_write_b32 a116, v84
    v_accvgpr_write_b32 a117, v85
    v_accvgpr_write_b32 a118, v86
    v_accvgpr_write_b32 a119, v87
    v_accvgpr_write_b32 a120, v88
    v_accvgpr_write_b32 a121, v89
    v_accvgpr_write_b32 a122, v90
    v_accvgpr_write_b32 a123, v91
    v_accvgpr_write_b32 a124, v92
    v_accvgpr_write_b32 a125, v93
    v_accvgpr_write_b32 a126, v94
    v_accvgpr_write_b32 a127, v95
    s_waitcnt vmcnt(24)
    v_perm_b32 v80, v114, v112, s58
    v_perm_b32 v81, v118, v116, s58
    v_perm_b32 v82, v122, v120, s58
    v_perm_b32 v83, v126, v124, s58
    v_perm_b32 v84, v114, v112, s59
    v_perm_b32 v85, v118, v116, s59
    v_perm_b32 v86, v122, v120, s59
    v_perm_b32 v87, v126, v124, s59
    v_perm_b32 v88, v115, v113, s58
    v_perm_b32 v89, v119, v117, s58
    v_perm_b32 v90, v123, v121, s58
    v_perm_b32 v91, v127, v125, s58
    v_perm_b32 v92, v115, v113, s59
    v_perm_b32 v93, v119, v117, s59
    v_perm_b32 v94, v123, v121, s59
    v_perm_b32 v95, v127, v125, s59
    v_accvgpr_write_b32 a128, v80
    v_accvgpr_write_b32 a129, v81
    v_accvgpr_write_b32 a130, v82
    v_accvgpr_write_b32 a131, v83
    v_accvgpr_write_b32 a132, v84
    v_accvgpr_write_b32 a133, v85
    v_accvgpr_write_b32 a134, v86
    v_accvgpr_write_b32 a135, v87
    v_accvgpr_write_b32 a136, v88
    v_accvgpr_write_b32 a137, v89
    v_accvgpr_write_b32 a138, v90
    v_accvgpr_write_b32 a139, v91
    v_accvgpr_write_b32 a140, v92
    v_accvgpr_write_b32 a141, v93
    v_accvgpr_write_b32 a142, v94
    v_accvgpr_write_b32 a143, v95
    s_waitcnt vmcnt(16)
    v_perm_b32 v80, v130, v128, s58
    v_perm_b32 v81, v134, v132, s58
    v_perm_b32 v82, v138, v136, s58
    v_perm_b32 v83, v142, v140, s58
    v_perm_b32 v84, v130, v128, s59
    v_perm_b32 v85, v134, v132, s59
    v_perm_b32 v86, v138, v136, s59
    v_perm_b32 v87, v142, v140, s59
    v_perm_b32 v88, v131, v129, s58
    v_perm_b32 v89, v135, v133, s58
    v_perm_b32 v90, v139, v137, s58
    v_perm_b32 v91, v143, v141, s58
    v_perm_b32 v92, v131, v129, s59
    v_perm_b32 v93, v135, v133, s59
    v_perm_b32 v94, v139, v137, s59
    v_perm_b32 v95, v143, v141, s59
    v_accvgpr_write_b32 a144, v80
    v_accvgpr_write_b32 a145, v81
    v_accvgpr_write_b32 a146, v82
    v_accvgpr_write_b32 a147, v83
    v_accvgpr_write_b32 a148, v84
    v_accvgpr_write_b32 a149, v85
    v_accvgpr_write_b32 a150, v86
    v_accvgpr_write_b32 a151, v87
    v_accvgpr_write_b32 a152, v88
    v_accvgpr_write_b32 a153, v89
    v_accvgpr_write_b32 a154, v90
    v_accvgpr_write_b32 a155, v91
    v_accvgpr_write_b32 a156, v92
    v_accvgpr_write_b32 a157, v93
    v_accvgpr_write_b32 a158, v94
    v_accvgpr_write_b32 a159, v95
    s_waitcnt vmcnt(8)
    v_perm_b32 v80, v146, v144, s58
    v_perm_b32 v81, v150, v148, s58
    v_perm_b32 v82, v154, v152, s58
    v_perm_b32 v83, v158, v156, s58
    v_perm_b32 v84, v146, v144, s59
    v_perm_b32 v85, v150, v148, s59
    v_perm_b32 v86, v154, v152, s59
    v_perm_b32 v87, v158, v156, s59
    v_perm_b32 v88, v147, v145, s58
    v_perm_b32 v89, v151, v149, s58
    v_perm_b32 v90, v155, v153, s58
    v_perm_b32 v91, v159, v157, s58
    v_perm_b32 v92, v147, v145, s59
    v_perm_b32 v93, v151, v149, s59
    v_perm_b32 v94, v155, v153, s59
    v_perm_b32 v95, v159, v157, s59
    v_accvgpr_write_b32 a160, v80
    v_accvgpr_write_b32 a161, v81
    v_accvgpr_write_b32 a162, v82
    v_accvgpr_write_b32 a163, v83
    v_accvgpr_write_b32 a164, v84
    v_accvgpr_write_b32 a165, v85
    v_accvgpr_write_b32 a166, v86
    v_accvgpr_write_b32 a167, v87
    v_accvgpr_write_b32 a168, v88
    v_accvgpr_write_b32 a169, v89
    v_accvgpr_write_b32 a170, v90
    v_accvgpr_write_b32 a171, v91
    v_accvgpr_write_b32 a172, v92
    v_accvgpr_write_b32 a173, v93
    v_accvgpr_write_b32 a174, v94
    v_accvgpr_write_b32 a175, v95
    s_waitcnt vmcnt(0)
    v_perm_b32 v80, v162, v160, s58
    v_perm_b32 v81, v166, v164, s58
    v_perm_b32 v82, v170, v168, s58
    v_perm_b32 v83, v174, v172, s58
    v_perm_b32 v84, v162, v160, s59
    v_perm_b32 v85, v166, v164, s59
    v_perm_b32 v86, v170, v168, s59
    v_perm_b32 v87, v174, v172, s59
    v_perm_b32 v88, v163, v161, s58
    v_perm_b32 v89, v167, v165, s58
    v_perm_b32 v90, v171, v169, s58
    v_perm_b32 v91, v175, v173, s58
    v_perm_b32 v92, v163, v161, s59
    v_perm_b32 v93, v167, v165, s59
    v_perm_b32 v94, v171, v169, s59
    v_perm_b32 v95, v175, v173, s59
    v_accvgpr_write_b32 a176, v80
    v_accvgpr_write_b32 a177, v81
    v_accvgpr_write_b32 a178, v82
    v_accvgpr_write_b32 a179, v83
    v_accvgpr_write_b32 a180, v84
    v_accvgpr_write_b32 a181, v85
    v_accvgpr_write_b32 a182, v86
    v_accvgpr_write_b32 a183, v87
    v_accvgpr_write_b32 a184, v88
    v_accvgpr_write_b32 a185, v89
    v_accvgpr_write_b32 a186, v90
    v_accvgpr_write_b32 a187, v91
    v_accvgpr_write_b32 a188, v92
    v_accvgpr_write_b32 a189, v93
    v_accvgpr_write_b32 a190, v94
    v_accvgpr_write_b32 a191, v95
    v_lshlrev_b32 v17, 6, v23
    s_add_u32 s47, s43, 64
    s_lshl_b32 s47, s47, 11
    s_add_u32 s47, s47, 655360
    s_mov_b32 s49, 0
L_p2_rdy:
    buffer_load_dword v18, v17, s[8:11], s47 offen sc1
    s_add_u32 s49, s49, 1
    s_cmp_gt_u32 s49, 400000
    s_cbranch_scc1 L_end
    s_waitcnt vmcnt(0)
    v_cmp_eq_u32 vcc, 0, v18
    s_cbranch_vccnz L_p2_rdy
    s_lshl_b32 s47, s43, 5
    s_add_u32 s47, s47, s40
    s_lshl_b32 s50, s47, 14
    s_add_u32 s50, s50, 16777216
    s_lshl_b32 s54, s47, 12
    s_add_u32 s54, s54, 8388608
    s_mov_b32 s79, s43
    s_mov_b32 s45, 0
    s_mov_b32 s96, 0x3e0293ee
    s_mov_b32 s97, s96
    s_mov_b32 s98, 0x00003f80
    s_mov_b32 s99, 0x3f800000
    s_mul_i32 s47, s41, 2304
    v_mul_u32_u24 v13, 1088, v20
    v_lshl_add_u32 v13, v23, 2, v13
    v_add_u32 v13, s47, v13
    v_and_b32 v17, 7, v16
    v_mul_u32_u24 v14, 272, v17
    v_lshl_add_u32 v14, v20, 4, v14
    v_add_u32 v14, s47, v14
    v_lshrrev_b32 v17, 4, v16
    v_lshl_add_u32 v11, v17, 10, v24
    s_lshl_b32 s47, s41, 8
    v_add_u32 v11, s47, v11
    s_and_b32 s47, s40, 7
    s_lshr_b32 s48, s47, 1
    s_lshl_b32 s48, s48, 3
    s_and_b32 s47, s47, 1
    s_lshl_b32 s47, s47, 1
    s_add_u32 s47, s47, s48
    s_lshr_b32 s48, s41, 1
    s_lshl_b32 s48, s48, 2
    s_add_u32 s47, s47, s48
    s_lshl_b32 s47, s47, 10
    s_lshr_b32 s48, s40, 3
    s_lshl_b32 s48, s48, 8
    s_add_u32 s47, s47, s48
    s_lshl_b32 s48, s77, 7
    s_add_u32 s47, s47, s48
    v_lshlrev_b32 v12, 10, v20
    v_lshl_add_u32 v12, v22, 3, v12
    v_lshl_add_u32 v12, v21, 2, v12
    v_add_u32 v12, s47, v12
    v_lshlrev_b32 v17, 2, v20
    v_sub_u32 v17, v23, v17
    v_mov_b32 v18, 0xff800000
    v_cmp_gt_i32 vcc, 0, v17
    s_nop 1
    v_cndmask_b32 v32, 0, v18, vcc
    v_cmp_gt_i32 vcc, 1, v17
    s_nop 1
    v_cndmask_b32 v33, 0, v18, vcc
    v_cmp_gt_i32 vcc, 2, v17
    s_nop 1
    v_cndmask_b32 v34, 0, v18, vcc
    v_cmp_gt_i32 vcc, 3, v17
    s_nop 1
    v_cndmask_b32 v35, 0, v18, vcc
    v_cmp_gt_i32 vcc, 8, v17
    s_nop 1
    v_cndmask_b32 v36, 0, v18, vcc
    v_cmp_gt_i32 vcc, 9, v17
    s_nop 1
    v_cndmask_b32 v37, 0, v18, vcc
    v_cmp_gt_i32 vcc, 10, v17
    s_nop 1
    v_cndmask_b32 v38, 0, v18, vcc
    v_cmp_gt_i32 vcc, 11, v17
    s_nop 1
    v_cndmask_b32 v39, 0, v18, vcc
    v_cmp_gt_i32 vcc, 16, v17
    s_nop 1
    v_cndmask_b32 v40, 0, v18, vcc
    v_cmp_gt_i32 vcc, 17, v17
    s_nop 1
    v_cndmask_b32 v41, 0, v18, vcc
    v_cmp_gt_i32 vcc, 18, v17
    s_nop 1
    v_cndmask_b32 v42, 0, v18, vcc
    v_cmp_gt_i32 vcc, 19, v17
    s_nop 1
    v_cndmask_b32 v43, 0, v18, vcc
    v_cmp_gt_i32 vcc, 24, v17
    s_nop 1
    v_cndmask_b32 v44, 0, v18, vcc
    v_cmp_gt_i32 vcc, 25, v17
    s_nop 1
    v_cndmask_b32 v45, 0, v18, vcc
    v_cmp_gt_i32 vcc, 26, v17
    s_nop 1
    v_cndmask_b32 v46, 0, v18, vcc
    v_cmp_gt_i32 vcc, 27, v17
    s_nop 1
    v_cndmask_b32 v47, 0, v18, vcc
    s_add_u32 s51, s50, 4096
    s_add_u32 s52, s50, 33554432
    s_add_u32 s53, s52, 4096
    buffer_load_dwordx4 v[48:51], v1, s[8:11], s50 offen offset:0 sc1
    buffer_load_dwordx4 a[224:227], v1, s[8:11], s52 offen offset:0 sc1
    buffer_load_dwordx4 v[52:55], v1, s[8:11], s50 offen offset:512 sc1
    buffer_load_dwordx4 a[228:231], v1, s[8:11], s52 offen offset:512 sc1
    buffer_load_dwordx4 v[56:59], v1, s[8:11], s50 offen offset:2048 sc1
    buffer_load_dwordx4 a[232:235], v1, s[8:11], s52 offen offset:2048 sc1
    buffer_load_dwordx4 v[60:63], v1, s[8:11], s50 offen offset:2560 sc1
    buffer_load_dwordx4 a[236:239], v1, s[8:11], s52 offen offset:2560 sc1
    buffer_load_dwordx4 v[64:67], v1, s[8:11], s51 offen offset:0 sc1
    buffer_load_dwordx4 a[240:243], v1, s[8:11], s53 offen offset:0 sc1
    buffer_load_dwordx4 v[68:71], v1, s[8:11], s51 offen offset:512 sc1
    buffer_load_dwordx4 a[244:247], v1, s[8:11], s53 offen offset:512 sc1
    buffer_load_dwordx4 v[72:75], v1, s[8:11], s51 offen offset:2048 sc1
    buffer_load_dwordx4 a[248:251], v1, s[8:11], s53 offen offset:2048 sc1
    buffer_load_dwordx4 v[76:79], v1, s[8:11], s51 offen offset:2560 sc1
    buffer_load_dwordx4 a[252:255], v1, s[8:11], s53 offen offset:2560 sc1
    s_add_u32 s52, s52, 8192
    s_add_u32 s53, s50, 8192
    s_add_u32 s51, s50, 12288
    buffer_load_dwordx4 v[80:83], v0, s[8:11], s52 offen offset:0 sc1
    buffer_load_dwordx4 v[84:87], v0, s[8:11], s52 offen offset:1024 sc1
    buffer_load_dwordx4 v[88:91], v0, s[8:11], s52 offen offset:2048 sc1
    buffer_load_dwordx4 v[92:95], v0, s[8:11], s52 offen offset:3072 sc1
    buffer_load_dwordx4 a[192:195], v2, s[8:11], s53 offen offset:0 sc1
    buffer_load_dwordx4 a[196:199], v2, s[8:11], s53 offen offset:512 sc1
    buffer_load_dwordx4 a[200:203], v2, s[8:11], s53 offen offset:1024 sc1
    buffer_load_dwordx4 a[204:207], v2, s[8:11], s53 offen offset:1536 sc1
    buffer_load_dwordx4 a[208:211], v2, s[8:11], s51 offen offset:0 sc1
    buffer_load_dwordx4 a[212:215], v2, s[8:11], s51 offen offset:512 sc1
    buffer_load_dwordx4 a[216:219], v2, s[8:11], s51 offen offset:1024 sc1
    buffer_load_dwordx4 a[220:223], v2, s[8:11], s51 offen offset:1536 sc1
L_p2_seg:
    s_lshl_b32 s57, s79, 15
    s_waitcnt vmcnt(0)
    buffer_load_dword v15, v12, s[32:35], s57 offen
    v_mfma_f32_32x32x16_bf16 v[176:191], v[48:51], a[224:227], v[32:47]
    v_mfma_f32_32x32x16_bf16 v[176:191], v[52:55], a[228:231], v[176:191]
    v_mfma_f32_32x32x16_bf16 v[176:191], v[56:59], a[232:235], v[176:191]
    v_mfma_f32_32x32x16_bf16 v[176:191], v[60:63], a[236:239], v[176:191]
    v_mfma_f32_32x32x16_bf16 v[176:191], v[64:67], a[240:243], v[176:191]
    v_mfma_f32_32x32x16_bf16 v[176:191], v[68:71], a[244:247], v[176:191]
    v_mfma_f32_32x32x16_bf16 v[176:191], v[72:75], a[248:251], v[176:191]
    v_mfma_f32_32x32x16_bf16 v[176:191], v[76:79], a[252:255], v[176:191]
    v_mfma_f32_32x32x16_bf16 v[112:127], v[80:83], a[128:131], 0
    v_mfma_f32_32x32x16_bf16 v[128:143], v[80:83], a[132:135], 0
    v_mfma_f32_32x32x16_bf16 v[144:159], v[80:83], a[136:139], 0
    v_mfma_f32_32x32x16_bf16 v[160:175], v[80:83], a[140:143], 0
    v_mfma_f32_32x32x16_bf16 v[112:127], v[84:87], a[144:147], v[112:127]
    v_max3_f32 v7, v176, v177, v178
    v_max_f32 v7, v7, v179
    v_mfma_f32_32x32x16_bf16 v[128:143], v[84:87], a[148:151], v[128:143]
    v_max3_f32 v7, v7, v180, v181
    v_max3_f32 v7, v7, v182, v183
    v_mfma_f32_32x32x16_bf16 v[144:159], v[84:87], a[152:155], v[144:159]
    v_max3_f32 v7, v7, v184, v185
    v_max3_f32 v7, v7, v186, v187
    v_mfma_f32_32x32x16_bf16 v[160:175], v[84:87], a[156:159], v[160:175]
    v_max3_f32 v7, v7, v188, v189
    v_max3_f32 v7, v7, v190, v191
    v_mfma_f32_32x32x16_bf16 v[112:127], v[88:91], a[160:163], v[112:127]
    v_mfma_f32_32x32x16_bf16 v[128:143], v[88:91], a[164:167], v[128:143]
    v_mfma_f32_32x32x16_bf16 v[144:159], v[88:91], a[168:171], v[144:159]
    v_mfma_f32_32x32x16_bf16 v[160:175], v[88:91], a[172:175], v[160:175]
    v_mfma_f32_32x32x16_bf16 v[112:127], v[92:95], a[176:179], v[112:127]
    v_mfma_f32_32x32x16_bf16 v[128:143], v[92:95], a[180:183], v[128:143]
    v_mfma_f32_32x32x16_bf16 v[144:159], v[92:95], a[184:187], v[144:159]
    v_mfma_f32_32x32x16_bf16 v[160:175], v[92:95], a[188:191], v[160:175]
    s_and_b32 s47, s45, 1
    s_lshl_b32 s47, s47, 20
    s_lshl_b32 s48, s43, 21
    s_add_u32 s47, s47, s48
    s_add_u32 s47, s47, 83886080
    s_lshl_b32 s56, s40, 15
    s_add_u32 s56, s56, s47
    s_lshl_b32 s55, s41, 18
    s_add_u32 s55, s55, s47
    s_lshl_b32 s48, s40, 10
    s_add_u32 s55, s55, s48
    s_lshr_b32 s78, s45, 1
    s_and_b32 s78, s78, 1
    s_xor_b32 s78, s78, 1
    s_mov_b32 s49, 0
    s_cmp_eq_u32 s79, 63
    s_cbranch_scc1 L_p2_full
L_p2_light:
    buffer_load_dword v8, v10, s[8:11], s54 offen sc1
    s_add_u32 s49, s49, 1
    s_cmp_gt_u32 s49, 400000
    s_cbranch_scc1 L_end
    s_waitcnt vmcnt(0)
    v_cmp_eq_u32 vcc, -1, v8
    s_cbranch_vccnz L_p2_light
L_p2_full:
    buffer_load_dwordx4 v[96:99], v3, s[8:11], s54 offen offset:0 sc1
    buffer_load_dwordx4 v[100:103], v3, s[8:11], s54 offen offset:256 sc1
    buffer_load_dwordx4 v[104:107], v3, s[8:11], s54 offen offset:2048 sc1
    buffer_load_dwordx4 v[108:111], v3, s[8:11], s54 offen offset:2304 sc1
    s_add_u32 s49, s49, 1
    s_cmp_gt_u32 s49, 400000
    s_cbranch_scc1 L_end
    s_waitcnt vmcnt(3)
    ds_write2_b32 v13, v96, v97 offset0:0 offset1:68
    v_max3_u32 v8, v96, v97, v98
    v_max_u32 v8, v8, v99
    s_waitcnt vmcnt(2)
    ds_write2_b32 v13, v100, v101 offset0:136 offset1:204
    v_max3_u32 v8, v8, v100, v101
    v_max3_u32 v8, v8, v102, v103
    s_waitcnt vmcnt(1)
    ds_write2_b32 v13, v104, v105 offset0:32 offset1:100
    v_max3_u32 v8, v8, v104, v105
    v_max3_u32 v8, v8, v106, v107
    s_waitcnt vmcnt(0)
    ds_write2_b32 v13, v108, v109 offset0:168 offset1:236
    v_max3_u32 v8, v8, v108, v109
    v_max3_u32 v8, v8, v110, v111
    v_cmp_eq_u32 vcc, -1, v8
    s_waitcnt lgkmcnt(0)
    s_cbranch_vccnz L_p2_full
    ds_read_b128 v[48:51], v14 offset:0
    ds_read_b128 v[52:55], v14 offset:32
    ds_read_b128 v[56:59], v14 offset:64
    ds_read_b128 v[60:63], v14 offset:96
    ds_read_b128 v[64:67], v14 offset:128
    ds_read_b128 v[68:71], v14 offset:160
    ds_read_b128 v[72:75], v14 offset:192
    ds_read_b128 v[76:79], v14 offset:224
    v_swap_b32 v99, v102
    v_swap_b32 v107, v110
    s_waitcnt lgkmcnt(7)
    v_mfma_f32_32x32x16_bf16 v[192:207], v[48:51], a[224:227], 0
    s_waitcnt lgkmcnt(6)
    v_mfma_f32_32x32x16_bf16 v[192:207], v[52:55], a[228:231], v[192:207]
    s_waitcnt lgkmcnt(5)
    v_mfma_f32_32x32x16_bf16 v[192:207], v[56:59], a[232:235], v[192:207]
    s_waitcnt lgkmcnt(4)
    v_mfma_f32_32x32x16_bf16 v[192:207], v[60:63], a[236:239], v[192:207]
    s_waitcnt lgkmcnt(3)
    v_mfma_f32_32x32x16_bf16 v[192:207], v[64:67], a[240:243], v[192:207]
    s_waitcnt lgkmcnt(2)
    v_mfma_f32_32x32x16_bf16 v[192:207], v[68:71], a[244:247], v[192:207]
    s_waitcnt lgkmcnt(1)
    v_mfma_f32_32x32x16_bf16 v[192:207], v[72:75], a[248:251], v[192:207]
    s_waitcnt lgkmcnt(0)
    v_mfma_f32_32x32x16_bf16 v[192:207], v[76:79], a[252:255], v[192:207]
    s_nop 11
    v_max3_f32 v7, v7, v192, v193
    v_max3_f32 v7, v7, v194, v195
    v_mov_b32 v8, v7
    s_nop 1
    v_permlane32_swap_b32 v7, v8
    v_max_f32 v7, v7, v8
    v_mul_f32 v8, s96, v7
    v_pk_fma_f32 v[176:177], v[176:177], s[96:97], v[8:9] op_sel_hi:[1,1,0] neg_lo:[0,0,1] neg_hi:[0,0,1]
    v_pk_fma_f32 v[178:179], v[178:179], s[96:97], v[8:9] op_sel_hi:[1,1,0] neg_lo:[0,0,1] neg_hi:[0,0,1]
    v_pk_fma_f32 v[180:181], v[180:181], s[96:97], v[8:9] op_sel_hi:[1,1,0] neg_lo:[0,0,1] neg_hi:[0,0,1]
    v_pk_fma_f32 v[182:183], v[182:183], s[96:97], v[8:9] op_sel_hi:[1,1,0] neg_lo:[0,0,1] neg_hi:[0,0,1]
    v_pk_fma_f32 v[184:185], v[184:185], s[96:97], v[8:9] op_sel_hi:[1,1,0] neg_lo:[0,0,1] neg_hi:[0,0,1]
    v_pk_fma_f32 v[186:187], v[186:187], s[96:97], v[8:9] op_sel_hi:[1,1,0] neg_lo:[0,0,1] neg_hi:[0,0,1]
    v_pk_fma_f32 v[188:189], v[188:189], s[96:97], v[8:9] op_sel_hi:[1,1,0] neg_lo:[0,0,1] neg_hi:[0,0,1]
    v_pk_fma_f32 v[190:191], v[190:191], s[96:97], v[8:9] op_sel_hi:[1,1,0] neg_lo:[0,0,1] neg_hi:[0,0,1]
    v_pk_fma_f32 v[192:193], v[192:193], s[96:97], v[8:9] op_sel_hi:[1,1,0] neg_lo:[0,0,1] neg_hi:[0,0,1]
    v_pk_fma_f32 v[194:195], v[194:195], s[96:97], v[8:9] op_sel_hi:[1,1,0] neg_lo:[0,0,1] neg_hi:[0,0,1]
    v_exp_f32 v176, v176
    v_exp_f32 v177, v177
    v_exp_f32 v178, v178
    v_exp_f32 v179, v179
    v_exp_f32 v180, v180
    v_exp_f32 v181, v181
    v_exp_f32 v182, v182
    v_exp_f32 v183, v183
    v_exp_f32 v184, v184
    v_exp_f32 v185, v185
    v_exp_f32 v186, v186
    v_exp_f32 v187, v187
    v_exp_f32 v188, v188
    v_exp_f32 v189, v189
    v_exp_f32 v190, v190
    v_exp_f32 v191, v191
    v_exp_f32 v192, v192
    v_exp_f32 v193, v193
    v_exp_f32 v194, v194
    v_exp_f32 v195, v195
    v_pk_add_f32 v[196:197], v[176:177], v[178:179]
    v_pk_add_f32 v[198:199], v[180:181], v[182:183]
    v_pk_add_f32 v[200:201], v[184:185], v[186:187]
    v_pk_add_f32 v[202:203], v[188:189], v[190:191]
    v_pk_add_f32 v[204:205], v[192:193], v[194:195]
    v_pk_add_f32 v[196:197], v[196:197], v[198:199]
    v_pk_add_f32 v[200:201], v[200:201], v[202:203]
    v_pk_add_f32 v[196:197], v[196:197], v[204:205]
    v_pk_add_f32 v[196:197], v[196:197], v[200:201]
    v_add_f32 v196, v196, v197
    v_mov_b32 v197, v196
    s_nop 1
    v_permlane32_swap_b32 v196, v197
    v_add_f32 v196, v196, v197
    v_rcp_f32 v196, v196
    s_nop 0
    v_pk_mul_f32 v[176:177], v[176:177], v[196:197] op_sel_hi:[1,0]
    v_pk_mul_f32 v[178:179], v[178:179], v[196:197] op_sel_hi:[1,0]
    v_pk_mul_f32 v[180:181], v[180:181], v[196:197] op_sel_hi:[1,0]
    v_pk_mul_f32 v[182:183], v[182:183], v[196:197] op_sel_hi:[1,0]
    v_pk_mul_f32 v[184:185], v[184:185], v[196:197] op_sel_hi:[1,0]
    v_pk_mul_f32 v[186:187], v[186:187], v[196:197] op_sel_hi:[1,0]
    v_pk_mul_f32 v[188:189], v[188:189], v[196:197] op_sel_hi:[1,0]
    v_pk_mul_f32 v[190:191], v[190:191], v[196:197] op_sel_hi:[1,0]
    v_pk_mul_f32 v[192:193], v[192:193], v[196:197] op_sel_hi:[1,0]
    v_pk_mul_f32 v[194:195], v[194:195], v[196:197] op_sel_hi:[1,0]
    v_cvt_pk_bf16_f32 v240, v176, v177
    v_cvt_pk_bf16_f32 v241, v178, v179
    v_cvt_pk_bf16_f32 v242, v184, v185
    v_cvt_pk_bf16_f32 v243, v186, v187
    v_cvt_pk_bf16_f32 v244, v180, v181
    v_cvt_pk_bf16_f32 v245, v182, v183
    v_cvt_pk_bf16_f32 v246, v188, v189
    v_cvt_pk_bf16_f32 v247, v190, v191
    v_cvt_pk_bf16_f32 v248, v192, v193
    v_cvt_pk_bf16_f32 v249, v194, v195
    v_mfma_f32_32x32x16_bf16 v[176:191], a[192:195], v[240:243], 0
    v_mfma_f32_32x32x16_bf16 v[192:207], a[200:203], v[240:243], 0
    v_mfma_f32_32x32x16_bf16 v[208:223], a[208:211], v[240:243], 0
    v_mfma_f32_32x32x16_bf16 v[224:239], a[216:219], v[240:243], 0
    v_mfma_f32_32x32x16_bf16 v[176:191], a[196:199], v[244:247], v[176:191]
    v_mfma_f32_32x32x16_bf16 v[192:207], a[204:207], v[244:247], v[192:207]
    v_mfma_f32_32x32x16_bf16 v[208:223], a[212:215], v[244:247], v[208:223]
    v_mfma_f32_32x32x16_bf16 v[224:239], a[220:223], v[244:247], v[224:239]
    v_mfma_f32_32x32x8_bf16 v[176:191], v[98:99], v[248:249], v[176:191]
    v_mfma_f32_32x32x8_bf16 v[192:207], v[102:103], v[248:249], v[192:207]
    v_mfma_f32_32x32x8_bf16 v[208:223], v[106:107], v[248:249], v[208:223]
    v_mfma_f32_32x32x8_bf16 v[224:239], v[110:111], v[248:249], v[224:239]
    s_add_u32 s45, s45, 1
    s_add_u32 s79, s79, 7
    s_add_u32 s50, s50, 3670016
    s_add_u32 s54, s54, 917504
    v_cvt_pk_bf16_f32 v176, v176, v192
    v_cvt_pk_bf16_f32 v177, v177, v193
    v_cvt_pk_bf16_f32 v178, v178, v194
    v_cvt_pk_bf16_f32 v179, v179, v195
    v_cvt_pk_bf16_f32 v180, v180, v196
    v_cvt_pk_bf16_f32 v181, v181, v197
    v_cvt_pk_bf16_f32 v182, v182, v198
    v_cvt_pk_bf16_f32 v183, v183, v199
    v_cvt_pk_bf16_f32 v184, v184, v200
    v_cvt_pk_bf16_f32 v185, v185, v201
    v_cvt_pk_bf16_f32 v186, v186, v202
    v_cvt_pk_bf16_f32 v187, v187, v203
    v_cvt_pk_bf16_f32 v188, v188, v204
    v_cvt_pk_bf16_f32 v189, v189, v205
    v_cvt_pk_bf16_f32 v190, v190, v206
    v_cvt_pk_bf16_f32 v191, v191, v207
    s_cmp_ge_u32 s45, s44
    s_cbranch_scc1 L_p2_nopf
    s_add_u32 s51, s50, 4096
    s_add_u32 s52, s50, 33554432
    s_add_u32 s53, s52, 4096
    buffer_load_dwordx4 v[48:51], v1, s[8:11], s50 offen offset:0 sc1
    buffer_load_dwordx4 a[224:227], v1, s[8:11], s52 offen offset:0 sc1
    buffer_load_dwordx4 v[52:55], v1, s[8:11], s50 offen offset:512 sc1
    buffer_load_dwordx4 a[228:231], v1, s[8:11], s52 offen offset:512 sc1
    buffer_load_dwordx4 v[56:59], v1, s[8:11], s50 offen offset:2048 sc1
    buffer_load_dwordx4 a[232:235], v1, s[8:11], s52 offen offset:2048 sc1
    buffer_load_dwordx4 v[60:63], v1, s[8:11], s50 offen offset:2560 sc1
    buffer_load_dwordx4 a[236:239], v1, s[8:11], s52 offen offset:2560 sc1
    buffer_load_dwordx4 v[64:67], v1, s[8:11], s51 offen offset:0 sc1
    buffer_load_dwordx4 a[240:243], v1, s[8:11], s53 offen offset:0 sc1
    buffer_load_dwordx4 v[68:71], v1, s[8:11], s51 offen offset:512 sc1
    buffer_load_dwordx4 a[244:247], v1, s[8:11], s53 offen offset:512 sc1
    buffer_load_dwordx4 v[72:75], v1, s[8:11], s51 offen offset:2048 sc1
    buffer_load_dwordx4 a[248:251], v1, s[8:11], s53 offen offset:2048 sc1
    buffer_load_dwordx4 v[76:79], v1, s[8:11], s51 offen offset:2560 sc1
    buffer_load_dwordx4 a[252:255], v1, s[8:11], s53 offen offset:2560 sc1
    s_add_u32 s52, s52, 8192
    s_add_u32 s53, s50, 8192
    s_add_u32 s51, s50, 12288
    buffer_load_dwordx4 v[80:83], v0, s[8:11], s52 offen offset:0 sc1
    buffer_load_dwordx4 v[84:87], v0, s[8:11], s52 offen offset:1024 sc1
    buffer_load_dwordx4 v[88:91], v0, s[8:11], s52 offen offset:2048 sc1
    buffer_load_dwordx4 v[92:95], v0, s[8:11], s52 offen offset:3072 sc1
    buffer_load_dwordx4 a[192:195], v2, s[8:11], s53 offen offset:0 sc1
    buffer_load_dwordx4 a[196:199], v2, s[8:11], s53 offen offset:512 sc1
    buffer_load_dwordx4 a[200:203], v2, s[8:11], s53 offen offset:1024 sc1
    buffer_load_dwordx4 a[204:207], v2, s[8:11], s53 offen offset:1536 sc1
    buffer_load_dwordx4 a[208:211], v2, s[8:11], s51 offen offset:0 sc1
    buffer_load_dwordx4 a[212:215], v2, s[8:11], s51 offen offset:512 sc1
    buffer_load_dwordx4 a[216:219], v2, s[8:11], s51 offen offset:1024 sc1
    buffer_load_dwordx4 a[220:223], v2, s[8:11], s51 offen offset:1536 sc1
L_p2_nopf:
    v_mfma_f32_32x32x16_bf16 v[112:127], v[176:179], a[0:3], v[112:127]
    v_cvt_pk_bf16_f32 v208, v208, v224
    v_cvt_pk_bf16_f32 v209, v209, v225
    v_cvt_pk_bf16_f32 v210, v210, v226
    v_cvt_pk_bf16_f32 v211, v211, v227
    v_mfma_f32_32x32x16_bf16 v[128:143], v[176:179], a[4:7], v[128:143]
    v_cvt_pk_bf16_f32 v212, v212, v228
    v_cvt_pk_bf16_f32 v213, v213, v229
    v_cvt_pk_bf16_f32 v214, v214, v230
    v_cvt_pk_bf16_f32 v215, v215, v231
    v_mfma_f32_32x32x16_bf16 v[144:159], v[176:179], a[8:11], v[144:159]
    v_cvt_pk_bf16_f32 v216, v216, v232
    v_cvt_pk_bf16_f32 v217, v217, v233
    v_cvt_pk_bf16_f32 v218, v218, v234
    v_cvt_pk_bf16_f32 v219, v219, v235
    v_mfma_f32_32x32x16_bf16 v[160:175], v[176:179], a[12:15], v[160:175]
    v_cvt_pk_bf16_f32 v220, v220, v236
    v_cvt_pk_bf16_f32 v221, v221, v237
    v_cvt_pk_bf16_f32 v222, v222, v238
    v_cvt_pk_bf16_f32 v223, v223, v239
    v_mfma_f32_32x32x16_bf16 v[112:127], v[180:183], a[16:19], v[112:127]
    v_mfma_f32_32x32x16_bf16 v[128:143], v[180:183], a[20:23], v[128:143]
    v_mfma_f32_32x32x16_bf16 v[144:159], v[180:183], a[24:27], v[144:159]
    v_mfma_f32_32x32x16_bf16 v[160:175], v[180:183], a[28:31], v[160:175]
    v_mfma_f32_32x32x16_bf16 v[112:127], v[184:187], a[32:35], v[112:127]
    v_mfma_f32_32x32x16_bf16 v[128:143], v[184:187], a[36:39], v[128:143]
    v_mfma_f32_32x32x16_bf16 v[144:159], v[184:187], a[40:43], v[144:159]
    v_mfma_f32_32x32x16_bf16 v[160:175], v[184:187], a[44:47], v[160:175]
    v_mfma_f32_32x32x16_bf16 v[112:127], v[188:191], a[48:51], v[112:127]
    v_mfma_f32_32x32x16_bf16 v[128:143], v[188:191], a[52:55], v[128:143]
    v_mfma_f32_32x32x16_bf16 v[144:159], v[188:191], a[56:59], v[144:159]
    v_mfma_f32_32x32x16_bf16 v[160:175], v[188:191], a[60:63], v[160:175]
    v_mfma_f32_32x32x16_bf16 v[112:127], v[208:211], a[64:67], v[112:127]
    v_mfma_f32_32x32x16_bf16 v[128:143], v[208:211], a[68:71], v[128:143]
    v_mfma_f32_32x32x16_bf16 v[144:159], v[208:211], a[72:75], v[144:159]
    v_mfma_f32_32x32x16_bf16 v[160:175], v[208:211], a[76:79], v[160:175]
    v_mfma_f32_32x32x16_bf16 v[112:127], v[212:215], a[80:83], v[112:127]
    v_mfma_f32_32x32x16_bf16 v[128:143], v[212:215], a[84:87], v[128:143]
    v_mfma_f32_32x32x16_bf16 v[144:159], v[212:215], a[88:91], v[144:159]
    v_mfma_f32_32x32x16_bf16 v[160:175], v[212:215], a[92:95], v[160:175]
    v_mfma_f32_32x32x16_bf16 v[112:127], v[216:219], a[96:99], v[112:127]
    v_mfma_f32_32x32x16_bf16 v[128:143], v[216:219], a[100:103], v[128:143]
    v_mfma_f32_32x32x16_bf16 v[144:159], v[216:219], a[104:107], v[144:159]
    v_mfma_f32_32x32x16_bf16 v[160:175], v[216:219], a[108:111], v[160:175]
    v_mfma_f32_32x32x16_bf16 v[112:127], v[220:223], a[112:115], v[112:127]
    v_mfma_f32_32x32x16_bf16 v[128:143], v[220:223], a[116:119], v[128:143]
    v_mfma_f32_32x32x16_bf16 v[144:159], v[220:223], a[120:123], v[144:159]
    v_mfma_f32_32x32x16_bf16 v[160:175], v[220:223], a[124:127], v[160:175]
    v_cvt_pk_bf16_f32 v176, v112, v128
    s_nop 10
    v_cvt_pk_bf16_f32 v177, v144, v160
    v_cvt_pk_bf16_f32 v178, v113, v129
    v_cvt_pk_bf16_f32 v179, v145, v161
    v_and_or_b32 v176, v176, -2, s78
    buffer_store_dwordx4 v[176:179], v0, s[8:11], s55 offen sc1
    s_add_u32 s55, s55, 32768
    v_cvt_pk_bf16_f32 v180, v114, v130
    v_cvt_pk_bf16_f32 v181, v146, v162
    v_cvt_pk_bf16_f32 v182, v115, v131
    v_cvt_pk_bf16_f32 v183, v147, v163
    v_and_or_b32 v180, v180, -2, s78
    buffer_store_dwordx4 v[180:183], v0, s[8:11], s55 offen sc1
    s_add_u32 s55, s55, 32768
    v_cvt_pk_bf16_f32 v184, v116, v132
    v_cvt_pk_bf16_f32 v185, v148, v164
    v_cvt_pk_bf16_f32 v186, v117, v133
    v_cvt_pk_bf16_f32 v187, v149, v165
    v_and_or_b32 v184, v184, -2, s78
    buffer_store_dwordx4 v[184:187], v0, s[8:11], s55 offen sc1
    s_add_u32 s55, s55, 32768
    v_cvt_pk_bf16_f32 v188, v118, v134
    v_cvt_pk_bf16_f32 v189, v150, v166
    v_cvt_pk_bf16_f32 v190, v119, v135
    v_cvt_pk_bf16_f32 v191, v151, v167
    v_and_or_b32 v188, v188, -2, s78
    buffer_store_dwordx4 v[188:191], v0, s[8:11], s55 offen sc1
    s_add_u32 s55, s55, 32768
    v_cvt_pk_bf16_f32 v192, v120, v136
    v_cvt_pk_bf16_f32 v193, v152, v168
    v_cvt_pk_bf16_f32 v194, v121, v137
    v_cvt_pk_bf16_f32 v195, v153, v169
    v_and_or_b32 v192, v192, -2, s78
    buffer_store_dwordx4 v[192:195], v0, s[8:11], s55 offen sc1
    s_add_u32 s55, s55, 32768
    v_cvt_pk_bf16_f32 v196, v122, v138
    v_cvt_pk_bf16_f32 v197, v154, v170
    v_cvt_pk_bf16_f32 v198, v123, v139
    v_cvt_pk_bf16_f32 v199, v155, v171
    v_and_or_b32 v196, v196, -2, s78
    buffer_store_dwordx4 v[196:199], v0, s[8:11], s55 offen sc1
    s_add_u32 s55, s55, 32768
    v_cvt_pk_bf16_f32 v200, v124, v140
    v_cvt_pk_bf16_f32 v201, v156, v172
    v_cvt_pk_bf16_f32 v202, v125, v141
    v_cvt_pk_bf16_f32 v203, v157, v173
    v_and_or_b32 v200, v200, -2, s78
    buffer_store_dwordx4 v[200:203], v0, s[8:11], s55 offen sc1
    s_add_u32 s55, s55, 32768
    v_cvt_pk_bf16_f32 v204, v126, v142
    v_cvt_pk_bf16_f32 v205, v158, v174
    v_cvt_pk_bf16_f32 v206, v127, v143
    v_cvt_pk_bf16_f32 v207, v159, v175
    v_and_or_b32 v204, v204, -2, s78
    buffer_store_dwordx4 v[204:207], v0, s[8:11], s55 offen sc1
    s_mov_b32 s49, 0
L_p2_rs:
    s_mov_b32 s47, s56
    buffer_load_dwordx4 v[208:211], v11, s[8:11], s47 offen sc1
    s_add_u32 s47, s47, 4096
    buffer_load_dwordx4 v[212:215], v11, s[8:11], s47 offen sc1
    s_add_u32 s47, s47, 4096
    buffer_load_dwordx4 v[216:219], v11, s[8:11], s47 offen sc1
    s_add_u32 s47, s47, 4096
    buffer_load_dwordx4 v[220:223], v11, s[8:11], s47 offen sc1
    s_add_u32 s47, s47, 4096
    buffer_load_dwordx4 v[224:227], v11, s[8:11], s47 offen sc1
    s_add_u32 s47, s47, 4096
    buffer_load_dwordx4 v[228:231], v11, s[8:11], s47 offen sc1
    s_add_u32 s47, s47, 4096
    buffer_load_dwordx4 v[232:235], v11, s[8:11], s47 offen sc1
    s_add_u32 s47, s47, 4096
    buffer_load_dwordx4 v[236:239], v11, s[8:11], s47 offen sc1
    s_add_u32 s49, s49, 1
    s_cmp_gt_u32 s49, 400000
    s_cbranch_scc1 L_end
    v_mov_b32 v7, 0
    v_mov_b64 v[112:113], 0
    v_mov_b64 v[114:115], 0
    v_mov_b64 v[116:117], 0
    v_mov_b64 v[118:119], 0
    s_waitcnt vmcnt(7)
    v_bitop3_b32 v7, v7, v208, s78 bitop3:0xf6
    v_dot2c_f32_bf16 v112, s98, v208
    v_dot2c_f32_bf16 v113, s99, v208
    v_dot2c_f32_bf16 v114, s98, v209
    v_dot2c_f32_bf16 v115, s99, v209
    v_dot2c_f32_bf16 v116, s98, v210
    v_dot2c_f32_bf16 v117, s99, v210
    v_dot2c_f32_bf16 v118, s98, v211
    v_dot2c_f32_bf16 v119, s99, v211
    s_waitcnt vmcnt(6)
    v_bitop3_b32 v7, v7, v212, s78 bitop3:0xf6
    v_dot2c_f32_bf16 v112, s98, v212
    v_dot2c_f32_bf16 v113, s99, v212
    v_dot2c_f32_bf16 v114, s98, v213
    v_dot2c_f32_bf16 v115, s99, v213
    v_dot2c_f32_bf16 v116, s98, v214
    v_dot2c_f32_bf16 v117, s99, v214
    v_dot2c_f32_bf16 v118, s98, v215
    v_dot2c_f32_bf16 v119, s99, v215
    s_waitcnt vmcnt(5)
    v_bitop3_b32 v7, v7, v216, s78 bitop3:0xf6
    v_dot2c_f32_bf16 v112, s98, v216
    v_dot2c_f32_bf16 v113, s99, v216
    v_dot2c_f32_bf16 v114, s98, v217
    v_dot2c_f32_bf16 v115, s99, v217
    v_dot2c_f32_bf16 v116, s98, v218
    v_dot2c_f32_bf16 v117, s99, v218
    v_dot2c_f32_bf16 v118, s98, v219
    v_dot2c_f32_bf16 v119, s99, v219
    s_waitcnt vmcnt(4)
    v_bitop3_b32 v7, v7, v220, s78 bitop3:0xf6
    v_dot2c_f32_bf16 v112, s98, v220
    v_dot2c_f32_bf16 v113, s99, v220
    v_dot2c_f32_bf16 v114, s98, v221
    v_dot2c_f32_bf16 v115, s99, v221
    v_dot2c_f32_bf16 v116, s98, v222
    v_dot2c_f32_bf16 v117, s99, v222
    v_dot2c_f32_bf16 v118, s98, v223
    v_dot2c_f32_bf16 v119, s99, v223
    s_waitcnt vmcnt(3)
    v_bitop3_b32 v7, v7, v224, s78 bitop3:0xf6
    v_dot2c_f32_bf16 v112, s98, v224
    v_dot2c_f32_bf16 v113, s99, v224
    v_dot2c_f32_bf16 v114, s98, v225
    v_dot2c_f32_bf16 v115, s99, v225
    v_dot2c_f32_bf16 v116, s98, v226
    v_dot2c_f32_bf16 v117, s99, v226
    v_dot2c_f32_bf16 v118, s98, v227
    v_dot2c_f32_bf16 v119, s99, v227
    s_waitcnt vmcnt(2)
    v_bitop3_b32 v7, v7, v228, s78 bitop3:0xf6
    v_dot2c_f32_bf16 v112, s98, v228
    v_dot2c_f32_bf16 v113, s99, v228
    v_dot2c_f32_bf16 v114, s98, v229
    v_dot2c_f32_bf16 v115, s99, v229
    v_dot2c_f32_bf16 v116, s98, v230
    v_dot2c_f32_bf16 v117, s99, v230
    v_dot2c_f32_bf16 v118, s98, v231
    v_dot2c_f32_bf16 v119, s99, v231
    s_waitcnt vmcnt(1)
    v_bitop3_b32 v7, v7, v232, s78 bitop3:0xf6
    v_dot2c_f32_bf16 v112, s98, v232
    v_dot2c_f32_bf16 v113, s99, v232
    v_dot2c_f32_bf16 v114, s98, v233
    v_dot2c_f32_bf16 v115, s99, v233
    v_dot2c_f32_bf16 v116, s98, v234
    v_dot2c_f32_bf16 v117, s99, v234
    v_dot2c_f32_bf16 v118, s98, v235
    v_dot2c_f32_bf16 v119, s99, v235
    s_waitcnt vmcnt(0)
    v_bitop3_b32 v7, v7, v236, s78 bitop3:0xf6
    v_dot2c_f32_bf16 v112, s98, v236
    v_dot2c_f32_bf16 v113, s99, v236
    v_dot2c_f32_bf16 v114, s98, v237
    v_dot2c_f32_bf16 v115, s99, v237
    v_dot2c_f32_bf16 v116, s98, v238
    v_dot2c_f32_bf16 v117, s99, v238
    v_dot2c_f32_bf16 v118, s98, v239
    v_dot2c_f32_bf16 v119, s99, v239
    v_and_b32 v7, 1, v7
    v_cmp_ne_u32 vcc, 0, v7
    s_cbranch_vccnz L_p2_rs
    v_permlane32_swap_b32 v112, v116
    v_permlane32_swap_b32 v113, v117
    v_permlane32_swap_b32 v114, v118
    v_permlane32_swap_b32 v115, v119
    v_pk_add_f32 v[112:113], v[112:113], v[116:117]
    v_pk_add_f32 v[114:115], v[114:115], v[118:119]
    s_nop 1
    v_permlane16_swap_b32 v112, v114
    v_permlane16_swap_b32 v113, v115
    v_pk_add_f32 v[112:113], v[112:113], v[114:115]
    v_lshlrev_b32 v114, 16, v15
    v_and_b32 v115, 0xffff0000, v15
    v_pk_add_f32 v[112:113], v[112:113], v[114:115]
    v_cvt_pk_bf16_f32 v112, v112, v113
    buffer_store_dword v112, v12, s[92:95], s57 offen
    s_cmp_lt_u32 s45, s44
    s_cbranch_scc1 L_p2_seg
    s_waitcnt vmcnt(0)
    s_branch L_end
L_chain:
    v_and_b32 v127, 63, v0
    v_lshlrev_b32 v126, 4, v127
    s_lshl_b32 s54, s41, 15
    v_add_u32 v0, s54, v126
    v_add_u32 v1, 131072, v126
    v_mov_b32 v11, v1
    s_lshl_b32 s54, s41, 11
    s_add_u32 m0, s54, 131072
    v_lshrrev_b32 v125, 4, v127
    v_and_b32 v123, 15, v127
    v_bfe_u32 v122, v127, 2, 2
    v_and_b32 v121, 1, v127
    v_lshl_add_u32 v124, v122, 1, v121
    v_bfe_u32 v120, v127, 1, 1
    v_and_b32 v118, 3, v127
    s_xor_b32 s54, s41, 0
    s_lshl_b32 s54, s54, 10
    s_add_u32 s54, s54, 147456
    v_add_u32 v4, s54, v126
    s_xor_b32 s54, s41, 1
    s_lshl_b32 s54, s54, 10
    s_add_u32 s54, s54, 147456
    v_add_u32 v5, s54, v126
    s_xor_b32 s54, s41, 2
    s_lshl_b32 s54, s54, 10
    s_add_u32 s54, s54, 147456
    v_add_u32 v6, s54, v126
    s_xor_b32 s54, s41, 3
    s_lshl_b32 s54, s54, 10
    s_add_u32 s54, s54, 147456
    v_add_u32 v7, s54, v126
    v_mul_u32_u24 v2, 544, v125
    v_lshl_add_u32 v15, v121, 7, v2
    v_bfe_u32 v119, v127, 1, 3
    v_lshl_add_u32 v15, v119, 2, v15
    s_lshl_b32 s54, s41, 5
    s_add_u32 s54, s54, 151552
    v_add_u32 v15, s54, v15
    v_lshl_add_u32 v2, v123, 2, v2
    s_lshl_b32 s54, s41, 6
    s_add_u32 s54, s54, 158720
    v_add_u32 v2, s54, v2
    v_mul_u32_u24 v3, 272, v124
    v_lshl_add_u32 v3, v125, 4, v3
    v_add_u32 v3, 151552, v3
    v_lshlrev_b32 v8, 14, v122
    v_lshrrev_b32 v119, 1, v125
    v_lshl_add_u32 v8, v119, 13, v8
    v_and_b32 v116, 1, v125
    v_lshl_add_u32 v8, v116, 11, v8
    v_lshl_add_u32 v8, v118, 4, v8
    s_lshl_b32 s54, s41, 16
    s_lshl_b32 s55, s40, 6
    s_add_u32 s54, s54, s55
    v_add_u32 v8, s54, v8
    v_lshlrev_b32 v10, 5, v120
    v_lshl_add_u32 v10, v116, 4, v10
    v_lshl_add_u32 v10, v121, 3, v10
    v_lshl_add_u32 v10, v119, 2, v10
    s_lshr_b32 s54, s40, 3
    s_lshl_b32 s54, s54, 11
    s_and_b32 s55, s40, 7
    s_lshl_b32 s55, s55, 7
    s_add_u32 s54, s54, s55
    s_lshr_b32 s55, s41, 1
    s_lshl_b32 s55, s55, 10
    s_add_u32 s54, s54, s55
    s_and_b32 s55, s41, 1
    s_lshl_b32 s55, s55, 6
    s_add_u32 s54, s54, s55
    v_add_u32 v10, s54, v10
    v_mov_b32 v119, 0x7ffffff0
    v_cmp_ne_u32 vcc, 0, v122
    s_nop 1
    v_cndmask_b32 v10, v10, v119, vcc
    v_mov_b32 v9, 0x4444
    v_mov_b32 v119, 0x80eeee
    v_cmp_eq_u32 vcc, 1, v120
    s_nop 1
    v_cndmask_b32 v9, v9, v119, vcc
    s_mov_b32 s44, 0x3e0293ee
    v_mov_b64 v[16:17], -1
    v_mov_b64 v[18:19], -1
    s_lshl_b32 s54, s41, 11
    s_lshl_b32 s55, s40, 13
    s_add_u32 s54, s54, s55
    s_add_u32 s54, s54, 1048576
    buffer_store_dwordx4 v[16:19], v126, s[8:11], s54 offen sc1
    buffer_store_dwordx4 v[16:19], v126, s[8:11], s54 offen offset:1024 sc1
    s_lshl_b32 s54, s41, 6
    s_lshl_b32 s55, s40, 8
    s_add_u32 s54, s54, s55
    s_add_u32 s54, s54, 524288
    s_mov_b64 exec, 15
    buffer_store_dwordx4 v[16:19], v126, s[8:11], s54 offen sc1
    s_mov_b64 exec, -1
    v_lshlrev_b32 v117, 10, v124
    v_lshl_add_u32 v117, v125, 6, v117
    v_lshl_add_u32 v117, v120, 5, v117
    s_lshl_b32 s54, s41, 8
    v_add_u32 v117, s54, v117
    v_mov_b64 v[28:29], 0
    v_mov_b64 v[30:31], 0
    ds_write_b128 v1, v[28:31] offset:24576
    v_mov_b32 v32, 0x3f803f80
    v_mov_b32 v33, v32
    v_mov_b32 v34, v32
    v_mov_b32 v35, v32
    ds_write_b128 v1, v[32:35] offset:25600
    v_lshlrev_b32 v37, 4, v121
    v_mov_b32 v38, 0x3f80
    v_lshlrev_b32 v37, v37, v38
    v_cmp_eq_u32 vcc, 0, v122
    s_nop 1
    v_cndmask_b32 v40, 0, v37, vcc
    v_cmp_eq_u32 vcc, 1, v122
    s_nop 1
    v_cndmask_b32 v41, 0, v37, vcc
    v_cmp_eq_u32 vcc, 2, v122
    s_nop 1
    v_cndmask_b32 v42, 0, v37, vcc
    v_cmp_eq_u32 vcc, 3, v122
    s_nop 1
    v_cndmask_b32 v43, 0, v37, vcc
    ds_write_b128 v1, v[40:43] offset:26624
    s_waitcnt lgkmcnt(0)
    v_lshrrev_b32 v119, 1, v125
    v_lshlrev_b32 v119, 18, v119
    v_and_b32 v118, 1, v125
    v_lshl_add_u32 v119, v118, 16, v119
    v_lshl_add_u32 v119, v123, 2, v119
    s_lshl_b32 s54, s41, 6
    s_lshl_b32 s55, s40, 8
    s_add_u32 s54, s54, s55
    v_add_u32 v12, s54, v119
    v_lshlrev_b32 v119, 12, v125
    v_lshl_add_u32 v119, v123, 4, v119
    s_lshl_b32 s54, s41, 8
    s_lshl_b32 s55, s40, 17
    s_add_u32 s54, s54, s55
    v_add_u32 v13, s54, v119
    s_mov_b32 s58, 0x05040100
    s_mov_b32 s59, 0x07060302
    v_lshrrev_b32 v119, 1, v125
    v_lshlrev_b32 v119, 18, v119
    v_and_b32 v118, 1, v125
    v_lshl_add_u32 v119, v118, 16, v119
    v_lshlrev_b32 v118, 2, v125
    v_sub_u32 v118, v123, v118
    v_and_b32 v118, 15, v118
    v_lshl_add_u32 v119, v118, 4, v119
    s_lshl_b32 s54, s41, 20
    s_lshl_b32 s55, s40, 8
    s_add_u32 s54, s54, s55
    v_add_u32 v12, s54, v119
    v_add_u32 v118, s41, v125
    v_and_b32 v118, 3, v118
    v_lshlrev_b32 v118, 6, v118
    v_lshl_add_u32 v118, v125, 8, v118
    v_lshl_add_u32 v118, v123, 2, v118
    s_lshl_b32 s54, s41, 12
    s_add_u32 s54, s54, 131072
    v_add_u32 v114, s54, v118
    v_add_u32 v119, s54, v126
    v_xor_b32 v115, 4096, v114
    v_xor_b32 v116, 8192, v114
    v_xor_b32 v118, 12288, v114
    s_xor_b32 s54, s41, 0
    s_lshl_b32 s54, s54, 15
    buffer_load_dwordx4 v[32:35], v13, s[24:27], s54 offen offset:0
    buffer_load_dwordx4 v[36:39], v13, s[24:27], s54 offen offset:1024
    buffer_load_dwordx4 v[40:43], v13, s[24:27], s54 offen offset:2048
    buffer_load_dwordx4 v[44:47], v13, s[24:27], s54 offen offset:3072
    s_xor_b32 s54, s41, 0
    s_lshl_b32 s54, s54, 15
    s_add_u32 s54, s54, 16384
    buffer_load_dwordx4 v[48:51], v13, s[24:27], s54 offen offset:0
    buffer_load_dwordx4 v[52:55], v13, s[24:27], s54 offen offset:1024
    buffer_load_dwordx4 v[56:59], v13, s[24:27], s54 offen offset:2048
    buffer_load_dwordx4 v[60:63], v13, s[24:27], s54 offen offset:3072
    s_xor_b32 s54, s41, 1
    s_lshl_b32 s54, s54, 15
    buffer_load_dwordx4 v[64:67], v13, s[24:27], s54 offen offset:0
    buffer_load_dwordx4 v[68:71], v13, s[24:27], s54 offen offset:1024
    buffer_load_dwordx4 v[72:75], v13, s[24:27], s54 offen offset:2048
    buffer_load_dwordx4 v[76:79], v13, s[24:27], s54 offen offset:3072
    s_waitcnt vmcnt(8)
    v_perm_b32 v160, v36, v32, s58
    v_perm_b32 v161, v36, v32, s59
    v_perm_b32 v162, v44, v40, s58
    v_perm_b32 v163, v44, v40, s59
    v_perm_b32 v168, v37, v33, s58
    v_perm_b32 v169, v37, v33, s59
    v_perm_b32 v170, v45, v41, s58
    v_perm_b32 v171, v45, v41, s59
    v_perm_b32 v176, v38, v34, s58
    v_perm_b32 v177, v38, v34, s59
    v_perm_b32 v178, v46, v42, s58
    v_perm_b32 v179, v46, v42, s59
    v_perm_b32 v184, v39, v35, s58
    v_perm_b32 v185, v39, v35, s59
    v_perm_b32 v186, v47, v43, s58
    v_perm_b32 v187, v47, v43, s59
    s_barrier
    s_cmp_lg_u32 s41, 0
    s_cbranch_scc1 L_ch_noinit
    s_lshr_b32 s54, s38, 5
    s_lshl_b32 s54, s54, 1
    s_add_u32 s54, s54, s39
    s_lshl_b32 s54, s54, 2
    v_mov_b32 v112, s54
    s_and_b32 s54, s38, 31
    s_lshl_b32 s54, 1, s54
    v_mov_b32 v113, s54
    s_mov_b64 exec, 1
    global_atomic_or v112, v113, s[36:37] offset:128 sc1
    s_mov_b64 exec, -1
L_ch_noinit:
    s_xor_b32 s54, s41, 1
    s_lshl_b32 s54, s54, 15
    s_add_u32 s54, s54, 16384
    buffer_load_dwordx4 v[32:35], v13, s[24:27], s54 offen offset:0
    buffer_load_dwordx4 v[36:39], v13, s[24:27], s54 offen offset:1024
    buffer_load_dwordx4 v[40:43], v13, s[24:27], s54 offen offset:2048
    buffer_load_dwordx4 v[44:47], v13, s[24:27], s54 offen offset:3072
    s_waitcnt vmcnt(8)
    v_perm_b32 v164, v52, v48, s58
    v_perm_b32 v165, v52, v48, s59
    v_perm_b32 v166, v60, v56, s58
    v_perm_b32 v167, v60, v56, s59
    v_perm_b32 v172, v53, v49, s58
    v_perm_b32 v173, v53, v49, s59
    v_perm_b32 v174, v61, v57, s58
    v_perm_b32 v175, v61, v57, s59
    v_perm_b32 v180, v54, v50, s58
    v_perm_b32 v181, v54, v50, s59
    v_perm_b32 v182, v62, v58, s58
    v_perm_b32 v183, v62, v58, s59
    v_perm_b32 v188, v55, v51, s58
    v_perm_b32 v189, v55, v51, s59
    v_perm_b32 v190, v63, v59, s58
    v_perm_b32 v191, v63, v59, s59
    s_xor_b32 s54, s41, 2
    s_lshl_b32 s54, s54, 15
    buffer_load_dwordx4 v[48:51], v13, s[24:27], s54 offen offset:0
    buffer_load_dwordx4 v[52:55], v13, s[24:27], s54 offen offset:1024
    buffer_load_dwordx4 v[56:59], v13, s[24:27], s54 offen offset:2048
    buffer_load_dwordx4 v[60:63], v13, s[24:27], s54 offen offset:3072
    s_waitcnt vmcnt(8)
    v_perm_b32 v192, v68, v64, s58
    v_perm_b32 v193, v68, v64, s59
    v_perm_b32 v194, v76, v72, s58
    v_perm_b32 v195, v76, v72, s59
    v_perm_b32 v200, v69, v65, s58
    v_perm_b32 v201, v69, v65, s59
    v_perm_b32 v202, v77, v73, s58
    v_perm_b32 v203, v77, v73, s59
    v_perm_b32 v208, v70, v66, s58
    v_perm_b32 v209, v70, v66, s59
    v_perm_b32 v210, v78, v74, s58
    v_perm_b32 v211, v78, v74, s59
    v_perm_b32 v28, v71, v67, s58
    v_perm_b32 v29, v71, v67, s59
    v_perm_b32 v30, v79, v75, s58
    v_perm_b32 v31, v79, v75, s59
    ds_write_b128 v0, v[28:31] offset:30720
    s_xor_b32 s54, s41, 2
    s_lshl_b32 s54, s54, 15
    s_add_u32 s54, s54, 16384
    buffer_load_dwordx4 v[64:67], v13, s[24:27], s54 offen offset:0
    buffer_load_dwordx4 v[68:71], v13, s[24:27], s54 offen offset:1024
    buffer_load_dwordx4 v[72:75], v13, s[24:27], s54 offen offset:2048
    buffer_load_dwordx4 v[76:79], v13, s[24:27], s54 offen offset:3072
    s_waitcnt vmcnt(8)
    s_waitcnt lgkmcnt(0)
    v_perm_b32 v196, v36, v32, s58
    v_perm_b32 v197, v36, v32, s59
    v_perm_b32 v198, v44, v40, s58
    v_perm_b32 v199, v44, v40, s59
    v_perm_b32 v204, v37, v33, s58
    v_perm_b32 v205, v37, v33, s59
    v_perm_b32 v206, v45, v41, s58
    v_perm_b32 v207, v45, v41, s59
    v_perm_b32 v212, v38, v34, s58
    v_perm_b32 v213, v38, v34, s59
    v_perm_b32 v214, v46, v42, s58
    v_perm_b32 v215, v46, v42, s59
    v_perm_b32 v28, v39, v35, s58
    v_perm_b32 v29, v39, v35, s59
    v_perm_b32 v30, v47, v43, s58
    v_perm_b32 v31, v47, v43, s59
    ds_write_b128 v0, v[28:31] offset:31744
    s_xor_b32 s54, s41, 3
    s_lshl_b32 s54, s54, 15
    buffer_load_dwordx4 v[32:35], v13, s[24:27], s54 offen offset:0
    buffer_load_dwordx4 v[36:39], v13, s[24:27], s54 offen offset:1024
    buffer_load_dwordx4 v[40:43], v13, s[24:27], s54 offen offset:2048
    buffer_load_dwordx4 v[44:47], v13, s[24:27], s54 offen offset:3072
    s_waitcnt vmcnt(8)
    s_waitcnt lgkmcnt(0)
    v_perm_b32 v216, v52, v48, s58
    v_perm_b32 v217, v52, v48, s59
    v_perm_b32 v218, v60, v56, s58
    v_perm_b32 v219, v60, v56, s59
    v_perm_b32 v224, v53, v49, s58
    v_perm_b32 v225, v53, v49, s59
    v_perm_b32 v226, v61, v57, s58
    v_perm_b32 v227, v61, v57, s59
    v_perm_b32 v232, v54, v50, s58
    v_perm_b32 v233, v54, v50, s59
    v_perm_b32 v234, v62, v58, s58
    v_perm_b32 v235, v62, v58, s59
    v_perm_b32 v28, v55, v51, s58
    v_perm_b32 v29, v55, v51, s59
    v_perm_b32 v30, v63, v59, s58
    v_perm_b32 v31, v63, v59, s59
    ds_write_b128 v0, v[28:31] offset:24576
    s_xor_b32 s54, s41, 3
    s_lshl_b32 s54, s54, 15
    s_add_u32 s54, s54, 16384
    buffer_load_dwordx4 v[48:51], v13, s[24:27], s54 offen offset:0
    buffer_load_dwordx4 v[52:55], v13, s[24:27], s54 offen offset:1024
    buffer_load_dwordx4 v[56:59], v13, s[24:27], s54 offen offset:2048
    buffer_load_dwordx4 v[60:63], v13, s[24:27], s54 offen offset:3072
    s_waitcnt vmcnt(8)
    s_waitcnt lgkmcnt(0)
    v_perm_b32 v220, v68, v64, s58
    v_perm_b32 v221, v68, v64, s59
    v_perm_b32 v222, v76, v72, s58
    v_perm_b32 v223, v76, v72, s59
    v_perm_b32 v228, v69, v65, s58
    v_perm_b32 v229, v69, v65, s59
    v_perm_b32 v230, v77, v73, s58
    v_perm_b32 v231, v77, v73, s59
    v_perm_b32 v236, v70, v66, s58
    v_perm_b32 v237, v70, v66, s59
    v_perm_b32 v238, v78, v74, s58
    v_perm_b32 v239, v78, v74, s59
    v_perm_b32 v28, v71, v67, s58
    v_perm_b32 v29, v71, v67, s59
    v_perm_b32 v30, v79, v75, s58
    v_perm_b32 v31, v79, v75, s59
    ds_write_b128 v0, v[28:31] offset:25600
    s_mov_b32 s54, 0
    buffer_load_dwordx4 v[64:67], v12, s[12:15], s54 offen
    s_mov_b32 s54, 8192
    buffer_load_dwordx4 v[68:71], v12, s[12:15], s54 offen
    s_mov_b32 s54, 131072
    buffer_load_dwordx4 v[72:75], v12, s[12:15], s54 offen
    s_mov_b32 s54, 139264
    buffer_load_dwordx4 v[76:79], v12, s[12:15], s54 offen
    s_waitcnt vmcnt(8)
    s_waitcnt lgkmcnt(0)
    v_perm_b32 v240, v36, v32, s58
    v_perm_b32 v241, v36, v32, s59
    v_perm_b32 v242, v44, v40, s58
    v_perm_b32 v243, v44, v40, s59
    v_perm_b32 v248, v37, v33, s58
    v_perm_b32 v249, v37, v33, s59
    v_perm_b32 v250, v45, v41, s58
    v_perm_b32 v251, v45, v41, s59
    v_perm_b32 v24, v38, v34, s58
    v_perm_b32 v25, v38, v34, s59
    v_perm_b32 v26, v46, v42, s58
    v_perm_b32 v27, v46, v42, s59
    ds_write_b128 v0, v[24:27] offset:28672
    v_perm_b32 v28, v39, v35, s58
    v_perm_b32 v29, v39, v35, s59
    v_perm_b32 v30, v47, v43, s58
    v_perm_b32 v31, v47, v43, s59
    ds_write_b128 v0, v[28:31] offset:26624
    s_mov_b32 s54, 32768
    buffer_load_dwordx4 v[32:35], v12, s[12:15], s54 offen
    s_mov_b32 s54, 40960
    buffer_load_dwordx4 v[36:39], v12, s[12:15], s54 offen
    s_mov_b32 s54, 163840
    buffer_load_dwordx4 v[40:43], v12, s[12:15], s54 offen
    s_mov_b32 s54, 172032
    buffer_load_dwordx4 v[44:47], v12, s[12:15], s54 offen
    s_waitcnt vmcnt(8)
    s_waitcnt lgkmcnt(0)
    v_perm_b32 v244, v52, v48, s58
    v_perm_b32 v245, v52, v48, s59
    v_perm_b32 v246, v60, v56, s58
    v_perm_b32 v247, v60, v56, s59
    v_perm_b32 v252, v53, v49, s58
    v_perm_b32 v253, v53, v49, s59
    v_perm_b32 v254, v61, v57, s58
    v_perm_b32 v255, v61, v57, s59
    v_perm_b32 v24, v54, v50, s58
    v_perm_b32 v25, v54, v50, s59
    v_perm_b32 v26, v62, v58, s58
    v_perm_b32 v27, v62, v58, s59
    ds_write_b128 v0, v[24:27] offset:29696
    v_perm_b32 v28, v55, v51, s58
    v_perm_b32 v29, v55, v51, s59
    v_perm_b32 v30, v63, v59, s58
    v_perm_b32 v31, v63, v59, s59
    ds_write_b128 v0, v[28:31] offset:27648
    s_mov_b32 s54, 16384
    buffer_load_dwordx4 v[48:51], v12, s[12:15], s54 offen
    s_mov_b32 s54, 24576
    buffer_load_dwordx4 v[52:55], v12, s[12:15], s54 offen
    s_mov_b32 s54, 147456
    buffer_load_dwordx4 v[56:59], v12, s[12:15], s54 offen
    s_mov_b32 s54, 155648
    buffer_load_dwordx4 v[60:63], v12, s[12:15], s54 offen
    s_waitcnt vmcnt(8)
    s_waitcnt lgkmcnt(0)
    s_barrier
    ds_write_b128 v119, v[64:67] offset:0
    ds_write_b128 v119, v[68:71] offset:1024
    ds_write_b128 v119, v[72:75] offset:2048
    ds_write_b128 v119, v[76:79] offset:3072
    s_waitcnt lgkmcnt(0)
    s_barrier
    ds_read2st64_b32 v[64:65], v114 offset0:0 offset1:4
    ds_read2st64_b32 v[66:67], v114 offset0:8 offset1:12
    ds_read2st64_b32 v[68:69], v115 offset0:0 offset1:4
    ds_read2st64_b32 v[70:71], v115 offset0:8 offset1:12
    ds_read2st64_b32 v[72:73], v116 offset0:0 offset1:4
    ds_read2st64_b32 v[74:75], v116 offset0:8 offset1:12
    ds_read2st64_b32 v[76:77], v118 offset0:0 offset1:4
    ds_read2st64_b32 v[78:79], v118 offset0:8 offset1:12
    s_waitcnt lgkmcnt(6)
    v_lshlrev_b32 v112, 16, v64
    v_lshlrev_b32 v113, 16, v65
    v_mul_f32 v112, s44, v112
    v_mul_f32 v113, s44, v113
    v_cvt_pk_bf16_f32 v16, v112, v113
    v_lshlrev_b32 v112, 16, v66
    v_lshlrev_b32 v113, 16, v67
    v_mul_f32 v112, s44, v112
    v_mul_f32 v113, s44, v113
    v_cvt_pk_bf16_f32 v17, v112, v113
    v_and_b32 v112, 0xffff0000, v64
    v_and_b32 v113, 0xffff0000, v65
    v_mul_f32 v112, s44, v112
    v_mul_f32 v113, s44, v113
    v_cvt_pk_bf16_f32 v18, v112, v113
    v_and_b32 v112, 0xffff0000, v66
    v_and_b32 v113, 0xffff0000, v67
    v_mul_f32 v112, s44, v112
    v_mul_f32 v113, s44, v113
    v_cvt_pk_bf16_f32 v19, v112, v113
    s_waitcnt lgkmcnt(4)
    v_lshlrev_b32 v112, 16, v68
    v_lshlrev_b32 v113, 16, v69
    v_mul_f32 v112, s44, v112
    v_mul_f32 v113, s44, v113
    v_cvt_pk_bf16_f32 v20, v112, v113
    v_accvgpr_write_b32 a0, v20
    v_lshlrev_b32 v112, 16, v70
    v_lshlrev_b32 v113, 16, v71
    v_mul_f32 v112, s44, v112
    v_mul_f32 v113, s44, v113
    v_cvt_pk_bf16_f32 v21, v112, v113
    v_accvgpr_write_b32 a1, v21
    v_and_b32 v112, 0xffff0000, v68
    v_and_b32 v113, 0xffff0000, v69
    v_mul_f32 v112, s44, v112
    v_mul_f32 v113, s44, v113
    v_cvt_pk_bf16_f32 v22, v112, v113
    v_accvgpr_write_b32 a8, v22
    v_and_b32 v112, 0xffff0000, v70
    v_and_b32 v113, 0xffff0000, v71
    v_mul_f32 v112, s44, v112
    v_mul_f32 v113, s44, v113
    v_cvt_pk_bf16_f32 v23, v112, v113
    v_accvgpr_write_b32 a9, v23
    s_waitcnt lgkmcnt(2)
    v_lshlrev_b32 v112, 16, v72
    v_lshlrev_b32 v113, 16, v73
    v_mul_f32 v112, s44, v112
    v_mul_f32 v113, s44, v113
    v_cvt_pk_bf16_f32 v24, v112, v113
    v_accvgpr_write_b32 a32, v24
    v_lshlrev_b32 v112, 16, v74
    v_lshlrev_b32 v113, 16, v75
    v_mul_f32 v112, s44, v112
    v_mul_f32 v113, s44, v113
    v_cvt_pk_bf16_f32 v25, v112, v113
    v_accvgpr_write_b32 a33, v25
    v_and_b32 v112, 0xffff0000, v72
    v_and_b32 v113, 0xffff0000, v73
    v_mul_f32 v112, s44, v112
    v_mul_f32 v113, s44, v113
    v_cvt_pk_bf16_f32 v26, v112, v113
    v_accvgpr_write_b32 a40, v26
    v_and_b32 v112, 0xffff0000, v74
    v_and_b32 v113, 0xffff0000, v75
    v_mul_f32 v112, s44, v112
    v_mul_f32 v113, s44, v113
    v_cvt_pk_bf16_f32 v27, v112, v113
    v_accvgpr_write_b32 a41, v27
    s_waitcnt lgkmcnt(0)
    v_lshlrev_b32 v112, 16, v76
    v_lshlrev_b32 v113, 16, v77
    v_mul_f32 v112, s44, v112
    v_mul_f32 v113, s44, v113
    v_cvt_pk_bf16_f32 v28, v112, v113
    v_accvgpr_write_b32 a64, v28
    v_lshlrev_b32 v112, 16, v78
    v_lshlrev_b32 v113, 16, v79
    v_mul_f32 v112, s44, v112
    v_mul_f32 v113, s44, v113
    v_cvt_pk_bf16_f32 v29, v112, v113
    v_accvgpr_write_b32 a65, v29
    v_and_b32 v112, 0xffff0000, v76
    v_and_b32 v113, 0xffff0000, v77
    v_mul_f32 v112, s44, v112
    v_mul_f32 v113, s44, v113
    v_cvt_pk_bf16_f32 v30, v112, v113
    v_accvgpr_write_b32 a72, v30
    v_and_b32 v112, 0xffff0000, v78
    v_and_b32 v113, 0xffff0000, v79
    v_mul_f32 v112, s44, v112
    v_mul_f32 v113, s44, v113
    v_cvt_pk_bf16_f32 v31, v112, v113
    v_accvgpr_write_b32 a73, v31
    ds_write_b64 v0, v[16:17] offset:0
    ds_write_b64 v0, v[18:19] offset:2048
    s_mov_b32 s54, 49152
    buffer_load_dwordx4 v[64:67], v12, s[12:15], s54 offen
    s_mov_b32 s54, 57344
    buffer_load_dwordx4 v[68:71], v12, s[12:15], s54 offen
    s_mov_b32 s54, 180224
    buffer_load_dwordx4 v[72:75], v12, s[12:15], s54 offen
    s_mov_b32 s54, 188416
    buffer_load_dwordx4 v[76:79], v12, s[12:15], s54 offen
    s_waitcnt vmcnt(8)
    s_waitcnt lgkmcnt(0)
    s_barrier
    ds_write_b128 v119, v[32:35] offset:0
    ds_write_b128 v119, v[36:39] offset:1024
    ds_write_b128 v119, v[40:43] offset:2048
    ds_write_b128 v119, v[44:47] offset:3072
    s_waitcnt lgkmcnt(0)
    s_barrier
    ds_read2st64_b32 v[32:33], v114 offset0:0 offset1:4
    ds_read2st64_b32 v[34:35], v114 offset0:8 offset1:12
    ds_read2st64_b32 v[36:37], v115 offset0:0 offset1:4
    ds_read2st64_b32 v[38:39], v115 offset0:8 offset1:12
    ds_read2st64_b32 v[40:41], v116 offset0:0 offset1:4
    ds_read2st64_b32 v[42:43], v116 offset0:8 offset1:12
    ds_read2st64_b32 v[44:45], v118 offset0:0 offset1:4
    ds_read2st64_b32 v[46:47], v118 offset0:8 offset1:12
    s_waitcnt lgkmcnt(6)
    v_lshlrev_b32 v112, 16, v32
    v_lshlrev_b32 v113, 16, v33
    v_mul_f32 v112, s44, v112
    v_mul_f32 v113, s44, v113
    v_cvt_pk_bf16_f32 v16, v112, v113
    v_lshlrev_b32 v112, 16, v34
    v_lshlrev_b32 v113, 16, v35
    v_mul_f32 v112, s44, v112
    v_mul_f32 v113, s44, v113
    v_cvt_pk_bf16_f32 v17, v112, v113
    v_and_b32 v112, 0xffff0000, v32
    v_and_b32 v113, 0xffff0000, v33
    v_mul_f32 v112, s44, v112
    v_mul_f32 v113, s44, v113
    v_cvt_pk_bf16_f32 v18, v112, v113
    v_and_b32 v112, 0xffff0000, v34
    v_and_b32 v113, 0xffff0000, v35
    v_mul_f32 v112, s44, v112
    v_mul_f32 v113, s44, v113
    v_cvt_pk_bf16_f32 v19, v112, v113
    s_waitcnt lgkmcnt(4)
    v_lshlrev_b32 v112, 16, v36
    v_lshlrev_b32 v113, 16, v37
    v_mul_f32 v112, s44, v112
    v_mul_f32 v113, s44, v113
    v_cvt_pk_bf16_f32 v20, v112, v113
    v_accvgpr_write_b32 a16, v20
    v_lshlrev_b32 v112, 16, v38
    v_lshlrev_b32 v113, 16, v39
    v_mul_f32 v112, s44, v112
    v_mul_f32 v113, s44, v113
    v_cvt_pk_bf16_f32 v21, v112, v113
    v_accvgpr_write_b32 a17, v21
    v_and_b32 v112, 0xffff0000, v36
    v_and_b32 v113, 0xffff0000, v37
    v_mul_f32 v112, s44, v112
    v_mul_f32 v113, s44, v113
    v_cvt_pk_bf16_f32 v22, v112, v113
    v_accvgpr_write_b32 a24, v22
    v_and_b32 v112, 0xffff0000, v38
    v_and_b32 v113, 0xffff0000, v39
    v_mul_f32 v112, s44, v112
    v_mul_f32 v113, s44, v113
    v_cvt_pk_bf16_f32 v23, v112, v113
    v_accvgpr_write_b32 a25, v23
    s_waitcnt lgkmcnt(2)
    v_lshlrev_b32 v112, 16, v40
    v_lshlrev_b32 v113, 16, v41
    v_mul_f32 v112, s44, v112
    v_mul_f32 v113, s44, v113
    v_cvt_pk_bf16_f32 v24, v112, v113
    v_accvgpr_write_b32 a48, v24
    v_lshlrev_b32 v112, 16, v42
    v_lshlrev_b32 v113, 16, v43
    v_mul_f32 v112, s44, v112
    v_mul_f32 v113, s44, v113
    v_cvt_pk_bf16_f32 v25, v112, v113
    v_accvgpr_write_b32 a49, v25
    v_and_b32 v112, 0xffff0000, v40
    v_and_b32 v113, 0xffff0000, v41
    v_mul_f32 v112, s44, v112
    v_mul_f32 v113, s44, v113
    v_cvt_pk_bf16_f32 v26, v112, v113
    v_accvgpr_write_b32 a56, v26
    v_and_b32 v112, 0xffff0000, v42
    v_and_b32 v113, 0xffff0000, v43
    v_mul_f32 v112, s44, v112
    v_mul_f32 v113, s44, v113
    v_cvt_pk_bf16_f32 v27, v112, v113
    v_accvgpr_write_b32 a57, v27
    s_waitcnt lgkmcnt(0)
    v_lshlrev_b32 v112, 16, v44
    v_lshlrev_b32 v113, 16, v45
    v_mul_f32 v112, s44, v112
    v_mul_f32 v113, s44, v113
    v_cvt_pk_bf16_f32 v28, v112, v113
    v_accvgpr_write_b32 a80, v28
    v_lshlrev_b32 v112, 16, v46
    v_lshlrev_b32 v113, 16, v47
    v_mul_f32 v112, s44, v112
    v_mul_f32 v113, s44, v113
    v_cvt_pk_bf16_f32 v29, v112, v113
    v_accvgpr_write_b32 a81, v29
    v_and_b32 v112, 0xffff0000, v44
    v_and_b32 v113, 0xffff0000, v45
    v_mul_f32 v112, s44, v112
    v_mul_f32 v113, s44, v113
    v_cvt_pk_bf16_f32 v30, v112, v113
    v_accvgpr_write_b32 a88, v30
    v_and_b32 v112, 0xffff0000, v46
    v_and_b32 v113, 0xffff0000, v47
    v_mul_f32 v112, s44, v112
    v_mul_f32 v113, s44, v113
    v_cvt_pk_bf16_f32 v31, v112, v113
    v_accvgpr_write_b32 a89, v31
    ds_write_b64 v0, v[16:17] offset:12288
    ds_write_b64 v0, v[18:19] offset:14336
    s_mov_b32 s54, 524288
    buffer_load_dwordx4 v[32:35], v12, s[12:15], s54 offen
    s_mov_b32 s54, 532480
    buffer_load_dwordx4 v[36:39], v12, s[12:15], s54 offen
    s_mov_b32 s54, 655360
    buffer_load_dwordx4 v[40:43], v12, s[12:15], s54 offen
    s_mov_b32 s54, 663552
    buffer_load_dwordx4 v[44:47], v12, s[12:15], s54 offen
    s_waitcnt vmcnt(8)
    s_waitcnt lgkmcnt(0)
    s_barrier
    ds_write_b128 v119, v[48:51] offset:0
    ds_write_b128 v119, v[52:55] offset:1024
    ds_write_b128 v119, v[56:59] offset:2048
    ds_write_b128 v119, v[60:63] offset:3072
    s_waitcnt lgkmcnt(0)
    s_barrier
    ds_read2st64_b32 v[48:49], v114 offset0:0 offset1:4
    ds_read2st64_b32 v[50:51], v114 offset0:8 offset1:12
    ds_read2st64_b32 v[52:53], v115 offset0:0 offset1:4
    ds_read2st64_b32 v[54:55], v115 offset0:8 offset1:12
    ds_read2st64_b32 v[56:57], v116 offset0:0 offset1:4
    ds_read2st64_b32 v[58:59], v116 offset0:8 offset1:12
    ds_read2st64_b32 v[60:61], v118 offset0:0 offset1:4
    ds_read2st64_b32 v[62:63], v118 offset0:8 offset1:12
    s_waitcnt lgkmcnt(6)
    v_lshlrev_b32 v112, 16, v48
    v_lshlrev_b32 v113, 16, v49
    v_mul_f32 v112, s44, v112
    v_mul_f32 v113, s44, v113
    v_cvt_pk_bf16_f32 v16, v112, v113
    v_lshlrev_b32 v112, 16, v50
    v_lshlrev_b32 v113, 16, v51
    v_mul_f32 v112, s44, v112
    v_mul_f32 v113, s44, v113
    v_cvt_pk_bf16_f32 v17, v112, v113
    v_and_b32 v112, 0xffff0000, v48
    v_and_b32 v113, 0xffff0000, v49
    v_mul_f32 v112, s44, v112
    v_mul_f32 v113, s44, v113
    v_cvt_pk_bf16_f32 v18, v112, v113
    v_and_b32 v112, 0xffff0000, v50
    v_and_b32 v113, 0xffff0000, v51
    v_mul_f32 v112, s44, v112
    v_mul_f32 v113, s44, v113
    v_cvt_pk_bf16_f32 v19, v112, v113
    s_waitcnt lgkmcnt(4)
    v_lshlrev_b32 v112, 16, v52
    v_lshlrev_b32 v113, 16, v53
    v_mul_f32 v112, s44, v112
    v_mul_f32 v113, s44, v113
    v_cvt_pk_bf16_f32 v20, v112, v113
    v_accvgpr_write_b32 a2, v20
    v_lshlrev_b32 v112, 16, v54
    v_lshlrev_b32 v113, 16, v55
    v_mul_f32 v112, s44, v112
    v_mul_f32 v113, s44, v113
    v_cvt_pk_bf16_f32 v21, v112, v113
    v_accvgpr_write_b32 a3, v21
    v_and_b32 v112, 0xffff0000, v52
    v_and_b32 v113, 0xffff0000, v53
    v_mul_f32 v112, s44, v112
    v_mul_f32 v113, s44, v113
    v_cvt_pk_bf16_f32 v22, v112, v113
    v_accvgpr_write_b32 a10, v22
    v_and_b32 v112, 0xffff0000, v54
    v_and_b32 v113, 0xffff0000, v55
    v_mul_f32 v112, s44, v112
    v_mul_f32 v113, s44, v113
    v_cvt_pk_bf16_f32 v23, v112, v113
    v_accvgpr_write_b32 a11, v23
    s_waitcnt lgkmcnt(2)
    v_lshlrev_b32 v112, 16, v56
    v_lshlrev_b32 v113, 16, v57
    v_mul_f32 v112, s44, v112
    v_mul_f32 v113, s44, v113
    v_cvt_pk_bf16_f32 v24, v112, v113
    v_accvgpr_write_b32 a34, v24
    v_lshlrev_b32 v112, 16, v58
    v_lshlrev_b32 v113, 16, v59
    v_mul_f32 v112, s44, v112
    v_mul_f32 v113, s44, v113
    v_cvt_pk_bf16_f32 v25, v112, v113
    v_accvgpr_write_b32 a35, v25
    v_and_b32 v112, 0xffff0000, v56
    v_and_b32 v113, 0xffff0000, v57
    v_mul_f32 v112, s44, v112
    v_mul_f32 v113, s44, v113
    v_cvt_pk_bf16_f32 v26, v112, v113
    v_accvgpr_write_b32 a42, v26
    v_and_b32 v112, 0xffff0000, v58
    v_and_b32 v113, 0xffff0000, v59
    v_mul_f32 v112, s44, v112
    v_mul_f32 v113, s44, v113
    v_cvt_pk_bf16_f32 v27, v112, v113
    v_accvgpr_write_b32 a43, v27
    s_waitcnt lgkmcnt(0)
    v_lshlrev_b32 v112, 16, v60
    v_lshlrev_b32 v113, 16, v61
    v_mul_f32 v112, s44, v112
    v_mul_f32 v113, s44, v113
    v_cvt_pk_bf16_f32 v28, v112, v113
    v_accvgpr_write_b32 a66, v28
    v_lshlrev_b32 v112, 16, v62
    v_lshlrev_b32 v113, 16, v63
    v_mul_f32 v112, s44, v112
    v_mul_f32 v113, s44, v113
    v_cvt_pk_bf16_f32 v29, v112, v113
    v_accvgpr_write_b32 a67, v29
    v_and_b32 v112, 0xffff0000, v60
    v_and_b32 v113, 0xffff0000, v61
    v_mul_f32 v112, s44, v112
    v_mul_f32 v113, s44, v113
    v_cvt_pk_bf16_f32 v30, v112, v113
    v_accvgpr_write_b32 a74, v30
    v_and_b32 v112, 0xffff0000, v62
    v_and_b32 v113, 0xffff0000, v63
    v_mul_f32 v112, s44, v112
    v_mul_f32 v113, s44, v113
    v_cvt_pk_bf16_f32 v31, v112, v113
    v_accvgpr_write_b32 a75, v31
    ds_write_b64 v0, v[16:17] offset:8
    ds_write_b64 v0, v[18:19] offset:2056
    s_mov_b32 s54, 557056
    buffer_load_dwordx4 v[48:51], v12, s[12:15], s54 offen
    s_mov_b32 s54, 565248
    buffer_load_dwordx4 v[52:55], v12, s[12:15], s54 offen
    s_mov_b32 s54, 688128
    buffer_load_dwordx4 v[56:59], v12, s[12:15], s54 offen
    s_mov_b32 s54, 696320
    buffer_load_dwordx4 v[60:63], v12, s[12:15], s54 offen
    s_waitcnt vmcnt(8)
    s_waitcnt lgkmcnt(0)
    s_barrier
    ds_write_b128 v119, v[64:67] offset:0
    ds_write_b128 v119, v[68:71] offset:1024
    ds_write_b128 v119, v[72:75] offset:2048
    ds_write_b128 v119, v[76:79] offset:3072
    s_waitcnt lgkmcnt(0)
    s_barrier
    ds_read2st64_b32 v[64:65], v114 offset0:0 offset1:4
    ds_read2st64_b32 v[66:67], v114 offset0:8 offset1:12
    ds_read2st64_b32 v[68:69], v115 offset0:0 offset1:4
    ds_read2st64_b32 v[70:71], v115 offset0:8 offset1:12
    ds_read2st64_b32 v[72:73], v116 offset0:0 offset1:4
    ds_read2st64_b32 v[74:75], v116 offset0:8 offset1:12
    ds_read2st64_b32 v[76:77], v118 offset0:0 offset1:4
    ds_read2st64_b32 v[78:79], v118 offset0:8 offset1:12
    s_waitcnt lgkmcnt(6)
    v_lshlrev_b32 v112, 16, v64
    v_lshlrev_b32 v113, 16, v65
    v_mul_f32 v112, s44, v112
    v_mul_f32 v113, s44, v113
    v_cvt_pk_bf16_f32 v16, v112, v113
    v_lshlrev_b32 v112, 16, v66
    v_lshlrev_b32 v113, 16, v67
    v_mul_f32 v112, s44, v112
    v_mul_f32 v113, s44, v113
    v_cvt_pk_bf16_f32 v17, v112, v113
    v_and_b32 v112, 0xffff0000, v64
    v_and_b32 v113, 0xffff0000, v65
    v_mul_f32 v112, s44, v112
    v_mul_f32 v113, s44, v113
    v_cvt_pk_bf16_f32 v18, v112, v113
    v_and_b32 v112, 0xffff0000, v66
    v_and_b32 v113, 0xffff0000, v67
    v_mul_f32 v112, s44, v112
    v_mul_f32 v113, s44, v113
    v_cvt_pk_bf16_f32 v19, v112, v113
    s_waitcnt lgkmcnt(4)
    v_lshlrev_b32 v112, 16, v68
    v_lshlrev_b32 v113, 16, v69
    v_mul_f32 v112, s44, v112
    v_mul_f32 v113, s44, v113
    v_cvt_pk_bf16_f32 v20, v112, v113
    v_accvgpr_write_b32 a18, v20
    v_lshlrev_b32 v112, 16, v70
    v_lshlrev_b32 v113, 16, v71
    v_mul_f32 v112, s44, v112
    v_mul_f32 v113, s44, v113
    v_cvt_pk_bf16_f32 v21, v112, v113
    v_accvgpr_write_b32 a19, v21
    v_and_b32 v112, 0xffff0000, v68
    v_and_b32 v113, 0xffff0000, v69
    v_mul_f32 v112, s44, v112
    v_mul_f32 v113, s44, v113
    v_cvt_pk_bf16_f32 v22, v112, v113
    v_accvgpr_write_b32 a26, v22
    v_and_b32 v112, 0xffff0000, v70
    v_and_b32 v113, 0xffff0000, v71
    v_mul_f32 v112, s44, v112
    v_mul_f32 v113, s44, v113
    v_cvt_pk_bf16_f32 v23, v112, v113
    v_accvgpr_write_b32 a27, v23
    s_waitcnt lgkmcnt(2)
    v_lshlrev_b32 v112, 16, v72
    v_lshlrev_b32 v113, 16, v73
    v_mul_f32 v112, s44, v112
    v_mul_f32 v113, s44, v113
    v_cvt_pk_bf16_f32 v24, v112, v113
    v_accvgpr_write_b32 a50, v24
    v_lshlrev_b32 v112, 16, v74
    v_lshlrev_b32 v113, 16, v75
    v_mul_f32 v112, s44, v112
    v_mul_f32 v113, s44, v113
    v_cvt_pk_bf16_f32 v25, v112, v113
    v_accvgpr_write_b32 a51, v25
    v_and_b32 v112, 0xffff0000, v72
    v_and_b32 v113, 0xffff0000, v73
    v_mul_f32 v112, s44, v112
    v_mul_f32 v113, s44, v113
    v_cvt_pk_bf16_f32 v26, v112, v113
    v_accvgpr_write_b32 a58, v26
    v_and_b32 v112, 0xffff0000, v74
    v_and_b32 v113, 0xffff0000, v75
    v_mul_f32 v112, s44, v112
    v_mul_f32 v113, s44, v113
    v_cvt_pk_bf16_f32 v27, v112, v113
    v_accvgpr_write_b32 a59, v27
    s_waitcnt lgkmcnt(0)
    v_lshlrev_b32 v112, 16, v76
    v_lshlrev_b32 v113, 16, v77
    v_mul_f32 v112, s44, v112
    v_mul_f32 v113, s44, v113
    v_cvt_pk_bf16_f32 v28, v112, v113
    v_accvgpr_write_b32 a82, v28
    v_lshlrev_b32 v112, 16, v78
    v_lshlrev_b32 v113, 16, v79
    v_mul_f32 v112, s44, v112
    v_mul_f32 v113, s44, v113
    v_cvt_pk_bf16_f32 v29, v112, v113
    v_accvgpr_write_b32 a83, v29
    v_and_b32 v112, 0xffff0000, v76
    v_and_b32 v113, 0xffff0000, v77
    v_mul_f32 v112, s44, v112
    v_mul_f32 v113, s44, v113
    v_cvt_pk_bf16_f32 v30, v112, v113
    v_accvgpr_write_b32 a90, v30
    v_and_b32 v112, 0xffff0000, v78
    v_and_b32 v113, 0xffff0000, v79
    v_mul_f32 v112, s44, v112
    v_mul_f32 v113, s44, v113
    v_cvt_pk_bf16_f32 v31, v112, v113
    v_accvgpr_write_b32 a91, v31
    ds_write_b64 v0, v[16:17] offset:12296
    ds_write_b64 v0, v[18:19] offset:14344
    s_mov_b32 s54, 540672
    buffer_load_dwordx4 v[64:67], v12, s[12:15], s54 offen
    s_mov_b32 s54, 548864
    buffer_load_dwordx4 v[68:71], v12, s[12:15], s54 offen
    s_mov_b32 s54, 671744
    buffer_load_dwordx4 v[72:75], v12, s[12:15], s54 offen
    s_mov_b32 s54, 679936
    buffer_load_dwordx4 v[76:79], v12, s[12:15], s54 offen
    s_waitcnt vmcnt(8)
    s_waitcnt lgkmcnt(0)
    s_barrier
    ds_write_b128 v119, v[32:35] offset:0
    ds_write_b128 v119, v[36:39] offset:1024
    ds_write_b128 v119, v[40:43] offset:2048
    ds_write_b128 v119, v[44:47] offset:3072
    s_waitcnt lgkmcnt(0)
    s_barrier
    ds_read2st64_b32 v[32:33], v114 offset0:0 offset1:4
    ds_read2st64_b32 v[34:35], v114 offset0:8 offset1:12
    ds_read2st64_b32 v[36:37], v115 offset0:0 offset1:4
    ds_read2st64_b32 v[38:39], v115 offset0:8 offset1:12
    ds_read2st64_b32 v[40:41], v116 offset0:0 offset1:4
    ds_read2st64_b32 v[42:43], v116 offset0:8 offset1:12
    ds_read2st64_b32 v[44:45], v118 offset0:0 offset1:4
    ds_read2st64_b32 v[46:47], v118 offset0:8 offset1:12
    s_waitcnt lgkmcnt(6)
    v_lshlrev_b32 v112, 16, v32
    v_lshlrev_b32 v113, 16, v33
    v_mul_f32 v112, s44, v112
    v_mul_f32 v113, s44, v113
    v_cvt_pk_bf16_f32 v16, v112, v113
    v_lshlrev_b32 v112, 16, v34
    v_lshlrev_b32 v113, 16, v35
    v_mul_f32 v112, s44, v112
    v_mul_f32 v113, s44, v113
    v_cvt_pk_bf16_f32 v17, v112, v113
    v_and_b32 v112, 0xffff0000, v32
    v_and_b32 v113, 0xffff0000, v33
    v_mul_f32 v112, s44, v112
    v_mul_f32 v113, s44, v113
    v_cvt_pk_bf16_f32 v18, v112, v113
    v_and_b32 v112, 0xffff0000, v34
    v_and_b32 v113, 0xffff0000, v35
    v_mul_f32 v112, s44, v112
    v_mul_f32 v113, s44, v113
    v_cvt_pk_bf16_f32 v19, v112, v113
    s_waitcnt lgkmcnt(4)
    v_lshlrev_b32 v112, 16, v36
    v_lshlrev_b32 v113, 16, v37
    v_mul_f32 v112, s44, v112
    v_mul_f32 v113, s44, v113
    v_cvt_pk_bf16_f32 v20, v112, v113
    v_accvgpr_write_b32 a4, v20
    v_lshlrev_b32 v112, 16, v38
    v_lshlrev_b32 v113, 16, v39
    v_mul_f32 v112, s44, v112
    v_mul_f32 v113, s44, v113
    v_cvt_pk_bf16_f32 v21, v112, v113
    v_accvgpr_write_b32 a5, v21
    v_and_b32 v112, 0xffff0000, v36
    v_and_b32 v113, 0xffff0000, v37
    v_mul_f32 v112, s44, v112
    v_mul_f32 v113, s44, v113
    v_cvt_pk_bf16_f32 v22, v112, v113
    v_accvgpr_write_b32 a12, v22
    v_and_b32 v112, 0xffff0000, v38
    v_and_b32 v113, 0xffff0000, v39
    v_mul_f32 v112, s44, v112
    v_mul_f32 v113, s44, v113
    v_cvt_pk_bf16_f32 v23, v112, v113
    v_accvgpr_write_b32 a13, v23
    s_waitcnt lgkmcnt(2)
    v_lshlrev_b32 v112, 16, v40
    v_lshlrev_b32 v113, 16, v41
    v_mul_f32 v112, s44, v112
    v_mul_f32 v113, s44, v113
    v_cvt_pk_bf16_f32 v24, v112, v113
    v_accvgpr_write_b32 a36, v24
    v_lshlrev_b32 v112, 16, v42
    v_lshlrev_b32 v113, 16, v43
    v_mul_f32 v112, s44, v112
    v_mul_f32 v113, s44, v113
    v_cvt_pk_bf16_f32 v25, v112, v113
    v_accvgpr_write_b32 a37, v25
    v_and_b32 v112, 0xffff0000, v40
    v_and_b32 v113, 0xffff0000, v41
    v_mul_f32 v112, s44, v112
    v_mul_f32 v113, s44, v113
    v_cvt_pk_bf16_f32 v26, v112, v113
    v_accvgpr_write_b32 a44, v26
    v_and_b32 v112, 0xffff0000, v42
    v_and_b32 v113, 0xffff0000, v43
    v_mul_f32 v112, s44, v112
    v_mul_f32 v113, s44, v113
    v_cvt_pk_bf16_f32 v27, v112, v113
    v_accvgpr_write_b32 a45, v27
    s_waitcnt lgkmcnt(0)
    v_lshlrev_b32 v112, 16, v44
    v_lshlrev_b32 v113, 16, v45
    v_mul_f32 v112, s44, v112
    v_mul_f32 v113, s44, v113
    v_cvt_pk_bf16_f32 v28, v112, v113
    v_accvgpr_write_b32 a68, v28
    v_lshlrev_b32 v112, 16, v46
    v_lshlrev_b32 v113, 16, v47
    v_mul_f32 v112, s44, v112
    v_mul_f32 v113, s44, v113
    v_cvt_pk_bf16_f32 v29, v112, v113
    v_accvgpr_write_b32 a69, v29
    v_and_b32 v112, 0xffff0000, v44
    v_and_b32 v113, 0xffff0000, v45
    v_mul_f32 v112, s44, v112
    v_mul_f32 v113, s44, v113
    v_cvt_pk_bf16_f32 v30, v112, v113
    v_accvgpr_write_b32 a76, v30
    v_and_b32 v112, 0xffff0000, v46
    v_and_b32 v113, 0xffff0000, v47
    v_mul_f32 v112, s44, v112
    v_mul_f32 v113, s44, v113
    v_cvt_pk_bf16_f32 v31, v112, v113
    v_accvgpr_write_b32 a77, v31
    ds_write_b64 v0, v[16:17] offset:1024
    ds_write_b64 v0, v[18:19] offset:3072
    s_mov_b32 s54, 573440
    buffer_load_dwordx4 v[32:35], v12, s[12:15], s54 offen
    s_mov_b32 s54, 581632
    buffer_load_dwordx4 v[36:39], v12, s[12:15], s54 offen
    s_mov_b32 s54, 704512
    buffer_load_dwordx4 v[40:43], v12, s[12:15], s54 offen
    s_mov_b32 s54, 712704
    buffer_load_dwordx4 v[44:47], v12, s[12:15], s54 offen
    s_waitcnt vmcnt(8)
    s_waitcnt lgkmcnt(0)
    s_barrier
    ds_write_b128 v119, v[48:51] offset:0
    ds_write_b128 v119, v[52:55] offset:1024
    ds_write_b128 v119, v[56:59] offset:2048
    ds_write_b128 v119, v[60:63] offset:3072
    s_waitcnt lgkmcnt(0)
    s_barrier
    ds_read2st64_b32 v[48:49], v114 offset0:0 offset1:4
    ds_read2st64_b32 v[50:51], v114 offset0:8 offset1:12
    ds_read2st64_b32 v[52:53], v115 offset0:0 offset1:4
    ds_read2st64_b32 v[54:55], v115 offset0:8 offset1:12
    ds_read2st64_b32 v[56:57], v116 offset0:0 offset1:4
    ds_read2st64_b32 v[58:59], v116 offset0:8 offset1:12
    ds_read2st64_b32 v[60:61], v118 offset0:0 offset1:4
    ds_read2st64_b32 v[62:63], v118 offset0:8 offset1:12
    s_waitcnt lgkmcnt(6)
    v_lshlrev_b32 v112, 16, v48
    v_lshlrev_b32 v113, 16, v49
    v_mul_f32 v112, s44, v112
    v_mul_f32 v113, s44, v113
    v_cvt_pk_bf16_f32 v16, v112, v113
    v_lshlrev_b32 v112, 16, v50
    v_lshlrev_b32 v113, 16, v51
    v_mul_f32 v112, s44, v112
    v_mul_f32 v113, s44, v113
    v_cvt_pk_bf16_f32 v17, v112, v113
    v_and_b32 v112, 0xffff0000, v48
    v_and_b32 v113, 0xffff0000, v49
    v_mul_f32 v112, s44, v112
    v_mul_f32 v113, s44, v113
    v_cvt_pk_bf16_f32 v18, v112, v113
    v_and_b32 v112, 0xffff0000, v50
    v_and_b32 v113, 0xffff0000, v51
    v_mul_f32 v112, s44, v112
    v_mul_f32 v113, s44, v113
    v_cvt_pk_bf16_f32 v19, v112, v113
    s_waitcnt lgkmcnt(4)
    v_lshlrev_b32 v112, 16, v52
    v_lshlrev_b32 v113, 16, v53
    v_mul_f32 v112, s44, v112
    v_mul_f32 v113, s44, v113
    v_cvt_pk_bf16_f32 v20, v112, v113
    v_accvgpr_write_b32 a20, v20
    v_lshlrev_b32 v112, 16, v54
    v_lshlrev_b32 v113, 16, v55
    v_mul_f32 v112, s44, v112
    v_mul_f32 v113, s44, v113
    v_cvt_pk_bf16_f32 v21, v112, v113
    v_accvgpr_write_b32 a21, v21
    v_and_b32 v112, 0xffff0000, v52
    v_and_b32 v113, 0xffff0000, v53
    v_mul_f32 v112, s44, v112
    v_mul_f32 v113, s44, v113
    v_cvt_pk_bf16_f32 v22, v112, v113
    v_accvgpr_write_b32 a28, v22
    v_and_b32 v112, 0xffff0000, v54
    v_and_b32 v113, 0xffff0000, v55
    v_mul_f32 v112, s44, v112
    v_mul_f32 v113, s44, v113
    v_cvt_pk_bf16_f32 v23, v112, v113
    v_accvgpr_write_b32 a29, v23
    s_waitcnt lgkmcnt(2)
    v_lshlrev_b32 v112, 16, v56
    v_lshlrev_b32 v113, 16, v57
    v_mul_f32 v112, s44, v112
    v_mul_f32 v113, s44, v113
    v_cvt_pk_bf16_f32 v24, v112, v113
    v_accvgpr_write_b32 a52, v24
    v_lshlrev_b32 v112, 16, v58
    v_lshlrev_b32 v113, 16, v59
    v_mul_f32 v112, s44, v112
    v_mul_f32 v113, s44, v113
    v_cvt_pk_bf16_f32 v25, v112, v113
    v_accvgpr_write_b32 a53, v25
    v_and_b32 v112, 0xffff0000, v56
    v_and_b32 v113, 0xffff0000, v57
    v_mul_f32 v112, s44, v112
    v_mul_f32 v113, s44, v113
    v_cvt_pk_bf16_f32 v26, v112, v113
    v_accvgpr_write_b32 a60, v26
    v_and_b32 v112, 0xffff0000, v58
    v_and_b32 v113, 0xffff0000, v59
    v_mul_f32 v112, s44, v112
    v_mul_f32 v113, s44, v113
    v_cvt_pk_bf16_f32 v27, v112, v113
    v_accvgpr_write_b32 a61, v27
    s_waitcnt lgkmcnt(0)
    v_lshlrev_b32 v112, 16, v60
    v_lshlrev_b32 v113, 16, v61
    v_mul_f32 v112, s44, v112
    v_mul_f32 v113, s44, v113
    v_cvt_pk_bf16_f32 v28, v112, v113
    v_accvgpr_write_b32 a84, v28
    v_lshlrev_b32 v112, 16, v62
    v_lshlrev_b32 v113, 16, v63
    v_mul_f32 v112, s44, v112
    v_mul_f32 v113, s44, v113
    v_cvt_pk_bf16_f32 v29, v112, v113
    v_accvgpr_write_b32 a85, v29
    v_and_b32 v112, 0xffff0000, v60
    v_and_b32 v113, 0xffff0000, v61
    v_mul_f32 v112, s44, v112
    v_mul_f32 v113, s44, v113
    v_cvt_pk_bf16_f32 v30, v112, v113
    v_accvgpr_write_b32 a92, v30
    v_and_b32 v112, 0xffff0000, v62
    v_and_b32 v113, 0xffff0000, v63
    v_mul_f32 v112, s44, v112
    v_mul_f32 v113, s44, v113
    v_cvt_pk_bf16_f32 v31, v112, v113
    v_accvgpr_write_b32 a93, v31
    ds_write_b64 v0, v[16:17] offset:13312
    ds_write_b64 v0, v[18:19] offset:15360
    s_mov_b32 s54, 0
    buffer_load_dwordx4 v[48:51], v12, s[16:19], s54 offen
    s_mov_b32 s54, 8192
    buffer_load_dwordx4 v[52:55], v12, s[16:19], s54 offen
    s_mov_b32 s54, 131072
    buffer_load_dwordx4 v[56:59], v12, s[16:19], s54 offen
    s_mov_b32 s54, 139264
    buffer_load_dwordx4 v[60:63], v12, s[16:19], s54 offen
    s_waitcnt vmcnt(8)
    s_waitcnt lgkmcnt(0)
    s_barrier
    ds_write_b128 v119, v[64:67] offset:0
    ds_write_b128 v119, v[68:71] offset:1024
    ds_write_b128 v119, v[72:75] offset:2048
    ds_write_b128 v119, v[76:79] offset:3072
    s_waitcnt lgkmcnt(0)
    s_barrier
    ds_read2st64_b32 v[64:65], v114 offset0:0 offset1:4
    ds_read2st64_b32 v[66:67], v114 offset0:8 offset1:12
    ds_read2st64_b32 v[68:69], v115 offset0:0 offset1:4
    ds_read2st64_b32 v[70:71], v115 offset0:8 offset1:12
    ds_read2st64_b32 v[72:73], v116 offset0:0 offset1:4
    ds_read2st64_b32 v[74:75], v116 offset0:8 offset1:12
    ds_read2st64_b32 v[76:77], v118 offset0:0 offset1:4
    ds_read2st64_b32 v[78:79], v118 offset0:8 offset1:12
    s_waitcnt lgkmcnt(6)
    v_lshlrev_b32 v112, 16, v64
    v_lshlrev_b32 v113, 16, v65
    v_mul_f32 v112, s44, v112
    v_mul_f32 v113, s44, v113
    v_cvt_pk_bf16_f32 v16, v112, v113
    v_lshlrev_b32 v112, 16, v66
    v_lshlrev_b32 v113, 16, v67
    v_mul_f32 v112, s44, v112
    v_mul_f32 v113, s44, v113
    v_cvt_pk_bf16_f32 v17, v112, v113
    v_and_b32 v112, 0xffff0000, v64
    v_and_b32 v113, 0xffff0000, v65
    v_mul_f32 v112, s44, v112
    v_mul_f32 v113, s44, v113
    v_cvt_pk_bf16_f32 v18, v112, v113
    v_and_b32 v112, 0xffff0000, v66
    v_and_b32 v113, 0xffff0000, v67
    v_mul_f32 v112, s44, v112
    v_mul_f32 v113, s44, v113
    v_cvt_pk_bf16_f32 v19, v112, v113
    s_waitcnt lgkmcnt(4)
    v_lshlrev_b32 v112, 16, v68
    v_lshlrev_b32 v113, 16, v69
    v_mul_f32 v112, s44, v112
    v_mul_f32 v113, s44, v113
    v_cvt_pk_bf16_f32 v20, v112, v113
    v_accvgpr_write_b32 a6, v20
    v_lshlrev_b32 v112, 16, v70
    v_lshlrev_b32 v113, 16, v71
    v_mul_f32 v112, s44, v112
    v_mul_f32 v113, s44, v113
    v_cvt_pk_bf16_f32 v21, v112, v113
    v_accvgpr_write_b32 a7, v21
    v_and_b32 v112, 0xffff0000, v68
    v_and_b32 v113, 0xffff0000, v69
    v_mul_f32 v112, s44, v112
    v_mul_f32 v113, s44, v113
    v_cvt_pk_bf16_f32 v22, v112, v113
    v_accvgpr_write_b32 a14, v22
    v_and_b32 v112, 0xffff0000, v70
    v_and_b32 v113, 0xffff0000, v71
    v_mul_f32 v112, s44, v112
    v_mul_f32 v113, s44, v113
    v_cvt_pk_bf16_f32 v23, v112, v113
    v_accvgpr_write_b32 a15, v23
    s_waitcnt lgkmcnt(2)
    v_lshlrev_b32 v112, 16, v72
    v_lshlrev_b32 v113, 16, v73
    v_mul_f32 v112, s44, v112
    v_mul_f32 v113, s44, v113
    v_cvt_pk_bf16_f32 v24, v112, v113
    v_accvgpr_write_b32 a38, v24
    v_lshlrev_b32 v112, 16, v74
    v_lshlrev_b32 v113, 16, v75
    v_mul_f32 v112, s44, v112
    v_mul_f32 v113, s44, v113
    v_cvt_pk_bf16_f32 v25, v112, v113
    v_accvgpr_write_b32 a39, v25
    v_and_b32 v112, 0xffff0000, v72
    v_and_b32 v113, 0xffff0000, v73
    v_mul_f32 v112, s44, v112
    v_mul_f32 v113, s44, v113
    v_cvt_pk_bf16_f32 v26, v112, v113
    v_accvgpr_write_b32 a46, v26
    v_and_b32 v112, 0xffff0000, v74
    v_and_b32 v113, 0xffff0000, v75
    v_mul_f32 v112, s44, v112
    v_mul_f32 v113, s44, v113
    v_cvt_pk_bf16_f32 v27, v112, v113
    v_accvgpr_write_b32 a47, v27
    s_waitcnt lgkmcnt(0)
    v_lshlrev_b32 v112, 16, v76
    v_lshlrev_b32 v113, 16, v77
    v_mul_f32 v112, s44, v112
    v_mul_f32 v113, s44, v113
    v_cvt_pk_bf16_f32 v28, v112, v113
    v_accvgpr_write_b32 a70, v28
    v_lshlrev_b32 v112, 16, v78
    v_lshlrev_b32 v113, 16, v79
    v_mul_f32 v112, s44, v112
    v_mul_f32 v113, s44, v113
    v_cvt_pk_bf16_f32 v29, v112, v113
    v_accvgpr_write_b32 a71, v29
    v_and_b32 v112, 0xffff0000, v76
    v_and_b32 v113, 0xffff0000, v77
    v_mul_f32 v112, s44, v112
    v_mul_f32 v113, s44, v113
    v_cvt_pk_bf16_f32 v30, v112, v113
    v_accvgpr_write_b32 a78, v30
    v_and_b32 v112, 0xffff0000, v78
    v_and_b32 v113, 0xffff0000, v79
    v_mul_f32 v112, s44, v112
    v_mul_f32 v113, s44, v113
    v_cvt_pk_bf16_f32 v31, v112, v113
    v_accvgpr_write_b32 a79, v31
    ds_write_b64 v0, v[16:17] offset:1032
    ds_write_b64 v0, v[18:19] offset:3080
    s_mov_b32 s54, 32768
    buffer_load_dwordx4 v[64:67], v12, s[16:19], s54 offen
    s_mov_b32 s54, 40960
    buffer_load_dwordx4 v[68:71], v12, s[16:19], s54 offen
    s_mov_b32 s54, 163840
    buffer_load_dwordx4 v[72:75], v12, s[16:19], s54 offen
    s_mov_b32 s54, 172032
    buffer_load_dwordx4 v[76:79], v12, s[16:19], s54 offen
    s_waitcnt vmcnt(8)
    s_waitcnt lgkmcnt(0)
    s_barrier
    ds_write_b128 v119, v[32:35] offset:0
    ds_write_b128 v119, v[36:39] offset:1024
    ds_write_b128 v119, v[40:43] offset:2048
    ds_write_b128 v119, v[44:47] offset:3072
    s_waitcnt lgkmcnt(0)
    s_barrier
    ds_read2st64_b32 v[32:33], v114 offset0:0 offset1:4
    ds_read2st64_b32 v[34:35], v114 offset0:8 offset1:12
    ds_read2st64_b32 v[36:37], v115 offset0:0 offset1:4
    ds_read2st64_b32 v[38:39], v115 offset0:8 offset1:12
    ds_read2st64_b32 v[40:41], v116 offset0:0 offset1:4
    ds_read2st64_b32 v[42:43], v116 offset0:8 offset1:12
    ds_read2st64_b32 v[44:45], v118 offset0:0 offset1:4
    ds_read2st64_b32 v[46:47], v118 offset0:8 offset1:12
    s_waitcnt lgkmcnt(6)
    v_lshlrev_b32 v112, 16, v32
    v_lshlrev_b32 v113, 16, v33
    v_mul_f32 v112, s44, v112
    v_mul_f32 v113, s44, v113
    v_cvt_pk_bf16_f32 v16, v112, v113
    v_lshlrev_b32 v112, 16, v34
    v_lshlrev_b32 v113, 16, v35
    v_mul_f32 v112, s44, v112
    v_mul_f32 v113, s44, v113
    v_cvt_pk_bf16_f32 v17, v112, v113
    v_and_b32 v112, 0xffff0000, v32
    v_and_b32 v113, 0xffff0000, v33
    v_mul_f32 v112, s44, v112
    v_mul_f32 v113, s44, v113
    v_cvt_pk_bf16_f32 v18, v112, v113
    v_and_b32 v112, 0xffff0000, v34
    v_and_b32 v113, 0xffff0000, v35
    v_mul_f32 v112, s44, v112
    v_mul_f32 v113, s44, v113
    v_cvt_pk_bf16_f32 v19, v112, v113
    s_waitcnt lgkmcnt(4)
    v_lshlrev_b32 v112, 16, v36
    v_lshlrev_b32 v113, 16, v37
    v_mul_f32 v112, s44, v112
    v_mul_f32 v113, s44, v113
    v_cvt_pk_bf16_f32 v20, v112, v113
    v_accvgpr_write_b32 a22, v20
    v_lshlrev_b32 v112, 16, v38
    v_lshlrev_b32 v113, 16, v39
    v_mul_f32 v112, s44, v112
    v_mul_f32 v113, s44, v113
    v_cvt_pk_bf16_f32 v21, v112, v113
    v_accvgpr_write_b32 a23, v21
    v_and_b32 v112, 0xffff0000, v36
    v_and_b32 v113, 0xffff0000, v37
    v_mul_f32 v112, s44, v112
    v_mul_f32 v113, s44, v113
    v_cvt_pk_bf16_f32 v22, v112, v113
    v_accvgpr_write_b32 a30, v22
    v_and_b32 v112, 0xffff0000, v38
    v_and_b32 v113, 0xffff0000, v39
    v_mul_f32 v112, s44, v112
    v_mul_f32 v113, s44, v113
    v_cvt_pk_bf16_f32 v23, v112, v113
    v_accvgpr_write_b32 a31, v23
    s_waitcnt lgkmcnt(2)
    v_lshlrev_b32 v112, 16, v40
    v_lshlrev_b32 v113, 16, v41
    v_mul_f32 v112, s44, v112
    v_mul_f32 v113, s44, v113
    v_cvt_pk_bf16_f32 v24, v112, v113
    v_accvgpr_write_b32 a54, v24
    v_lshlrev_b32 v112, 16, v42
    v_lshlrev_b32 v113, 16, v43
    v_mul_f32 v112, s44, v112
    v_mul_f32 v113, s44, v113
    v_cvt_pk_bf16_f32 v25, v112, v113
    v_accvgpr_write_b32 a55, v25
    v_and_b32 v112, 0xffff0000, v40
    v_and_b32 v113, 0xffff0000, v41
    v_mul_f32 v112, s44, v112
    v_mul_f32 v113, s44, v113
    v_cvt_pk_bf16_f32 v26, v112, v113
    v_accvgpr_write_b32 a62, v26
    v_and_b32 v112, 0xffff0000, v42
    v_and_b32 v113, 0xffff0000, v43
    v_mul_f32 v112, s44, v112
    v_mul_f32 v113, s44, v113
    v_cvt_pk_bf16_f32 v27, v112, v113
    v_accvgpr_write_b32 a63, v27
    s_waitcnt lgkmcnt(0)
    v_lshlrev_b32 v112, 16, v44
    v_lshlrev_b32 v113, 16, v45
    v_mul_f32 v112, s44, v112
    v_mul_f32 v113, s44, v113
    v_cvt_pk_bf16_f32 v28, v112, v113
    v_accvgpr_write_b32 a86, v28
    v_lshlrev_b32 v112, 16, v46
    v_lshlrev_b32 v113, 16, v47
    v_mul_f32 v112, s44, v112
    v_mul_f32 v113, s44, v113
    v_cvt_pk_bf16_f32 v29, v112, v113
    v_accvgpr_write_b32 a87, v29
    v_and_b32 v112, 0xffff0000, v44
    v_and_b32 v113, 0xffff0000, v45
    v_mul_f32 v112, s44, v112
    v_mul_f32 v113, s44, v113
    v_cvt_pk_bf16_f32 v30, v112, v113
    v_accvgpr_write_b32 a94, v30
    v_and_b32 v112, 0xffff0000, v46
    v_and_b32 v113, 0xffff0000, v47
    v_mul_f32 v112, s44, v112
    v_mul_f32 v113, s44, v113
    v_cvt_pk_bf16_f32 v31, v112, v113
    v_accvgpr_write_b32 a95, v31
    ds_write_b64 v0, v[16:17] offset:13320
    ds_write_b64 v0, v[18:19] offset:15368
    s_mov_b32 s54, 16384
    buffer_load_dwordx4 v[32:35], v12, s[16:19], s54 offen
    s_mov_b32 s54, 24576
    buffer_load_dwordx4 v[36:39], v12, s[16:19], s54 offen
    s_mov_b32 s54, 147456
    buffer_load_dwordx4 v[40:43], v12, s[16:19], s54 offen
    s_mov_b32 s54, 155648
    buffer_load_dwordx4 v[44:47], v12, s[16:19], s54 offen
    s_waitcnt vmcnt(8)
    s_waitcnt lgkmcnt(0)
    s_barrier
    ds_write_b128 v119, v[48:51] offset:0
    ds_write_b128 v119, v[52:55] offset:1024
    ds_write_b128 v119, v[56:59] offset:2048
    ds_write_b128 v119, v[60:63] offset:3072
    s_waitcnt lgkmcnt(0)
    s_barrier
    ds_read2st64_b32 v[48:49], v114 offset0:0 offset1:4
    ds_read2st64_b32 v[50:51], v114 offset0:8 offset1:12
    ds_read2st64_b32 v[52:53], v115 offset0:0 offset1:4
    ds_read2st64_b32 v[54:55], v115 offset0:8 offset1:12
    ds_read2st64_b32 v[56:57], v116 offset0:0 offset1:4
    ds_read2st64_b32 v[58:59], v116 offset0:8 offset1:12
    ds_read2st64_b32 v[60:61], v118 offset0:0 offset1:4
    ds_read2st64_b32 v[62:63], v118 offset0:8 offset1:12
    s_waitcnt lgkmcnt(6)
    v_perm_b32 v16, v49, v48, s58
    v_perm_b32 v17, v51, v50, s58
    v_perm_b32 v18, v49, v48, s59
    v_perm_b32 v19, v51, v50, s59
    s_waitcnt lgkmcnt(4)
    v_perm_b32 v20, v53, v52, s58
    v_accvgpr_write_b32 a96, v20
    v_perm_b32 v21, v55, v54, s58
    v_accvgpr_write_b32 a97, v21
    v_perm_b32 v22, v53, v52, s59
    v_accvgpr_write_b32 a104, v22
    v_perm_b32 v23, v55, v54, s59
    v_accvgpr_write_b32 a105, v23
    s_waitcnt lgkmcnt(2)
    v_perm_b32 v24, v57, v56, s58
    v_accvgpr_write_b32 a120, v24
    v_perm_b32 v25, v59, v58, s58
    v_accvgpr_write_b32 a121, v25
    v_perm_b32 v26, v57, v56, s59
    v_accvgpr_write_b32 a128, v26
    v_perm_b32 v27, v59, v58, s59
    v_accvgpr_write_b32 a129, v27
    s_waitcnt lgkmcnt(0)
    v_perm_b32 v28, v61, v60, s58
    v_accvgpr_write_b32 a152, v28
    v_perm_b32 v29, v63, v62, s58
    v_accvgpr_write_b32 a153, v29
    v_perm_b32 v30, v61, v60, s59
    v_accvgpr_write_b32 a160, v30
    v_perm_b32 v31, v63, v62, s59
    v_accvgpr_write_b32 a161, v31
    ds_write_b64 v0, v[16:17] offset:4096
    ds_write_b64 v0, v[18:19] offset:6144
    s_mov_b32 s54, 49152
    buffer_load_dwordx4 v[48:51], v12, s[16:19], s54 offen
    s_mov_b32 s54, 57344
    buffer_load_dwordx4 v[52:55], v12, s[16:19], s54 offen
    s_mov_b32 s54, 180224
    buffer_load_dwordx4 v[56:59], v12, s[16:19], s54 offen
    s_mov_b32 s54, 188416
    buffer_load_dwordx4 v[60:63], v12, s[16:19], s54 offen
    s_waitcnt vmcnt(8)
    s_waitcnt lgkmcnt(0)
    s_barrier
    ds_write_b128 v119, v[64:67] offset:0
    ds_write_b128 v119, v[68:71] offset:1024
    ds_write_b128 v119, v[72:75] offset:2048
    ds_write_b128 v119, v[76:79] offset:3072
    s_waitcnt lgkmcnt(0)
    s_barrier
    ds_read2st64_b32 v[64:65], v114 offset0:0 offset1:4
    ds_read2st64_b32 v[66:67], v114 offset0:8 offset1:12
    ds_read2st64_b32 v[68:69], v115 offset0:0 offset1:4
    ds_read2st64_b32 v[70:71], v115 offset0:8 offset1:12
    ds_read2st64_b32 v[72:73], v116 offset0:0 offset1:4
    ds_read2st64_b32 v[74:75], v116 offset0:8 offset1:12
    ds_read2st64_b32 v[76:77], v118 offset0:0 offset1:4
    ds_read2st64_b32 v[78:79], v118 offset0:8 offset1:12
    s_waitcnt lgkmcnt(6)
    v_perm_b32 v16, v65, v64, s58
    v_perm_b32 v17, v67, v66, s58
    v_perm_b32 v18, v65, v64, s59
    v_perm_b32 v19, v67, v66, s59
    s_waitcnt lgkmcnt(4)
    v_perm_b32 v20, v69, v68, s58
    v_perm_b32 v21, v71, v70, s58
    v_perm_b32 v22, v69, v68, s59
    v_accvgpr_write_b32 a112, v22
    v_perm_b32 v23, v71, v70, s59
    v_accvgpr_write_b32 a113, v23
    s_waitcnt lgkmcnt(2)
    v_perm_b32 v24, v73, v72, s58
    v_accvgpr_write_b32 a136, v24
    v_perm_b32 v25, v75, v74, s58
    v_accvgpr_write_b32 a137, v25
    v_perm_b32 v26, v73, v72, s59
    v_accvgpr_write_b32 a144, v26
    v_perm_b32 v27, v75, v74, s59
    v_accvgpr_write_b32 a145, v27
    s_waitcnt lgkmcnt(0)
    v_perm_b32 v28, v77, v76, s58
    v_perm_b32 v29, v79, v78, s58
    v_perm_b32 v30, v77, v76, s59
    v_accvgpr_write_b32 a168, v30
    v_perm_b32 v31, v79, v78, s59
    v_accvgpr_write_b32 a169, v31
    ds_write_b64 v0, v[16:17] offset:8192
    ds_write_b64 v0, v[18:19] offset:10240
    ds_write_b64 v0, v[20:21] offset:16384
    ds_write_b64 v0, v[28:29] offset:18432
    s_mov_b32 s54, 524288
    buffer_load_dwordx4 v[64:67], v12, s[16:19], s54 offen
    s_mov_b32 s54, 532480
    buffer_load_dwordx4 v[68:71], v12, s[16:19], s54 offen
    s_mov_b32 s54, 655360
    buffer_load_dwordx4 v[72:75], v12, s[16:19], s54 offen
    s_mov_b32 s54, 663552
    buffer_load_dwordx4 v[76:79], v12, s[16:19], s54 offen
    s_waitcnt vmcnt(8)
    s_waitcnt lgkmcnt(0)
    s_barrier
    ds_write_b128 v119, v[32:35] offset:0
    ds_write_b128 v119, v[36:39] offset:1024
    ds_write_b128 v119, v[40:43] offset:2048
    ds_write_b128 v119, v[44:47] offset:3072
    s_waitcnt lgkmcnt(0)
    s_barrier
    ds_read2st64_b32 v[32:33], v114 offset0:0 offset1:4
    ds_read2st64_b32 v[34:35], v114 offset0:8 offset1:12
    ds_read2st64_b32 v[36:37], v115 offset0:0 offset1:4
    ds_read2st64_b32 v[38:39], v115 offset0:8 offset1:12
    ds_read2st64_b32 v[40:41], v116 offset0:0 offset1:4
    ds_read2st64_b32 v[42:43], v116 offset0:8 offset1:12
    ds_read2st64_b32 v[44:45], v118 offset0:0 offset1:4
    ds_read2st64_b32 v[46:47], v118 offset0:8 offset1:12
    s_waitcnt lgkmcnt(6)
    v_perm_b32 v16, v33, v32, s58
    v_perm_b32 v17, v35, v34, s58
    v_perm_b32 v18, v33, v32, s59
    v_perm_b32 v19, v35, v34, s59
    s_waitcnt lgkmcnt(4)
    v_perm_b32 v20, v37, v36, s58
    v_accvgpr_write_b32 a98, v20
    v_perm_b32 v21, v39, v38, s58
    v_accvgpr_write_b32 a99, v21
    v_perm_b32 v22, v37, v36, s59
    v_accvgpr_write_b32 a106, v22
    v_perm_b32 v23, v39, v38, s59
    v_accvgpr_write_b32 a107, v23
    s_waitcnt lgkmcnt(2)
    v_perm_b32 v24, v41, v40, s58
    v_accvgpr_write_b32 a122, v24
    v_perm_b32 v25, v43, v42, s58
    v_accvgpr_write_b32 a123, v25
    v_perm_b32 v26, v41, v40, s59
    v_accvgpr_write_b32 a130, v26
    v_perm_b32 v27, v43, v42, s59
    v_accvgpr_write_b32 a131, v27
    s_waitcnt lgkmcnt(0)
    v_perm_b32 v28, v45, v44, s58
    v_accvgpr_write_b32 a154, v28
    v_perm_b32 v29, v47, v46, s58
    v_accvgpr_write_b32 a155, v29
    v_perm_b32 v30, v45, v44, s59
    v_accvgpr_write_b32 a162, v30
    v_perm_b32 v31, v47, v46, s59
    v_accvgpr_write_b32 a163, v31
    ds_write_b64 v0, v[16:17] offset:4104
    ds_write_b64 v0, v[18:19] offset:6152
    s_mov_b32 s54, 557056
    buffer_load_dwordx4 v[32:35], v12, s[16:19], s54 offen
    s_mov_b32 s54, 565248
    buffer_load_dwordx4 v[36:39], v12, s[16:19], s54 offen
    s_mov_b32 s54, 688128
    buffer_load_dwordx4 v[40:43], v12, s[16:19], s54 offen
    s_mov_b32 s54, 696320
    buffer_load_dwordx4 v[44:47], v12, s[16:19], s54 offen
    s_waitcnt vmcnt(8)
    s_waitcnt lgkmcnt(0)
    s_barrier
    ds_write_b128 v119, v[48:51] offset:0
    ds_write_b128 v119, v[52:55] offset:1024
    ds_write_b128 v119, v[56:59] offset:2048
    ds_write_b128 v119, v[60:63] offset:3072
    s_waitcnt lgkmcnt(0)
    s_barrier
    ds_read2st64_b32 v[48:49], v114 offset0:0 offset1:4
    ds_read2st64_b32 v[50:51], v114 offset0:8 offset1:12
    ds_read2st64_b32 v[52:53], v115 offset0:0 offset1:4
    ds_read2st64_b32 v[54:55], v115 offset0:8 offset1:12
    ds_read2st64_b32 v[56:57], v116 offset0:0 offset1:4
    ds_read2st64_b32 v[58:59], v116 offset0:8 offset1:12
    ds_read2st64_b32 v[60:61], v118 offset0:0 offset1:4
    ds_read2st64_b32 v[62:63], v118 offset0:8 offset1:12
    s_waitcnt lgkmcnt(6)
    v_perm_b32 v16, v49, v48, s58
    v_perm_b32 v17, v51, v50, s58
    v_perm_b32 v18, v49, v48, s59
    v_perm_b32 v19, v51, v50, s59
    s_waitcnt lgkmcnt(4)
    v_perm_b32 v20, v53, v52, s58
    v_perm_b32 v21, v55, v54, s58
    v_perm_b32 v22, v53, v52, s59
    v_accvgpr_write_b32 a114, v22
    v_perm_b32 v23, v55, v54, s59
    v_accvgpr_write_b32 a115, v23
    s_waitcnt lgkmcnt(2)
    v_perm_b32 v24, v57, v56, s58
    v_accvgpr_write_b32 a138, v24
    v_perm_b32 v25, v59, v58, s58
    v_accvgpr_write_b32 a139, v25
    v_perm_b32 v26, v57, v56, s59
    v_accvgpr_write_b32 a146, v26
    v_perm_b32 v27, v59, v58, s59
    v_accvgpr_write_b32 a147, v27
    s_waitcnt lgkmcnt(0)
    v_perm_b32 v28, v61, v60, s58
    v_perm_b32 v29, v63, v62, s58
    v_perm_b32 v30, v61, v60, s59
    v_accvgpr_write_b32 a170, v30
    v_perm_b32 v31, v63, v62, s59
    v_accvgpr_write_b32 a171, v31
    ds_write_b64 v0, v[16:17] offset:8200
    ds_write_b64 v0, v[18:19] offset:10248
    ds_write_b64 v0, v[20:21] offset:16392
    ds_write_b64 v0, v[28:29] offset:18440
    s_mov_b32 s54, 540672
    buffer_load_dwordx4 v[48:51], v12, s[16:19], s54 offen
    s_mov_b32 s54, 548864
    buffer_load_dwordx4 v[52:55], v12, s[16:19], s54 offen
    s_mov_b32 s54, 671744
    buffer_load_dwordx4 v[56:59], v12, s[16:19], s54 offen
    s_mov_b32 s54, 679936
    buffer_load_dwordx4 v[60:63], v12, s[16:19], s54 offen
    s_waitcnt vmcnt(8)
    s_waitcnt lgkmcnt(0)
    s_barrier
    ds_write_b128 v119, v[64:67] offset:0
    ds_write_b128 v119, v[68:71] offset:1024
    ds_write_b128 v119, v[72:75] offset:2048
    ds_write_b128 v119, v[76:79] offset:3072
    s_waitcnt lgkmcnt(0)
    s_barrier
    ds_read2st64_b32 v[64:65], v114 offset0:0 offset1:4
    ds_read2st64_b32 v[66:67], v114 offset0:8 offset1:12
    ds_read2st64_b32 v[68:69], v115 offset0:0 offset1:4
    ds_read2st64_b32 v[70:71], v115 offset0:8 offset1:12
    ds_read2st64_b32 v[72:73], v116 offset0:0 offset1:4
    ds_read2st64_b32 v[74:75], v116 offset0:8 offset1:12
    ds_read2st64_b32 v[76:77], v118 offset0:0 offset1:4
    ds_read2st64_b32 v[78:79], v118 offset0:8 offset1:12
    s_waitcnt lgkmcnt(6)
    v_perm_b32 v16, v65, v64, s58
    v_perm_b32 v17, v67, v66, s58
    v_perm_b32 v18, v65, v64, s59
    v_perm_b32 v19, v67, v66, s59
    s_waitcnt lgkmcnt(4)
    v_perm_b32 v20, v69, v68, s58
    v_accvgpr_write_b32 a100, v20
    v_perm_b32 v21, v71, v70, s58
    v_accvgpr_write_b32 a101, v21
    v_perm_b32 v22, v69, v68, s59
    v_accvgpr_write_b32 a108, v22
    v_perm_b32 v23, v71, v70, s59
    v_accvgpr_write_b32 a109, v23
    s_waitcnt lgkmcnt(2)
    v_perm_b32 v24, v73, v72, s58
    v_accvgpr_write_b32 a124, v24
    v_perm_b32 v25, v75, v74, s58
    v_accvgpr_write_b32 a125, v25
    v_perm_b32 v26, v73, v72, s59
    v_accvgpr_write_b32 a132, v26
    v_perm_b32 v27, v75, v74, s59
    v_accvgpr_write_b32 a133, v27
    s_waitcnt lgkmcnt(0)
    v_perm_b32 v28, v77, v76, s58
    v_accvgpr_write_b32 a156, v28
    v_perm_b32 v29, v79, v78, s58
    v_accvgpr_write_b32 a157, v29
    v_perm_b32 v30, v77, v76, s59
    v_accvgpr_write_b32 a164, v30
    v_perm_b32 v31, v79, v78, s59
    v_accvgpr_write_b32 a165, v31
    ds_write_b64 v0, v[16:17] offset:5120
    ds_write_b64 v0, v[18:19] offset:7168
    s_mov_b32 s54, 573440
    buffer_load_dwordx4 v[64:67], v12, s[16:19], s54 offen
    s_mov_b32 s54, 581632
    buffer_load_dwordx4 v[68:71], v12, s[16:19], s54 offen
    s_mov_b32 s54, 704512
    buffer_load_dwordx4 v[72:75], v12, s[16:19], s54 offen
    s_mov_b32 s54, 712704
    buffer_load_dwordx4 v[76:79], v12, s[16:19], s54 offen
    s_waitcnt vmcnt(8)
    s_waitcnt lgkmcnt(0)
    s_barrier
    ds_write_b128 v119, v[32:35] offset:0
    ds_write_b128 v119, v[36:39] offset:1024
    ds_write_b128 v119, v[40:43] offset:2048
    ds_write_b128 v119, v[44:47] offset:3072
    s_waitcnt lgkmcnt(0)
    s_barrier
    ds_read2st64_b32 v[32:33], v114 offset0:0 offset1:4
    ds_read2st64_b32 v[34:35], v114 offset0:8 offset1:12
    ds_read2st64_b32 v[36:37], v115 offset0:0 offset1:4
    ds_read2st64_b32 v[38:39], v115 offset0:8 offset1:12
    ds_read2st64_b32 v[40:41], v116 offset0:0 offset1:4
    ds_read2st64_b32 v[42:43], v116 offset0:8 offset1:12
    ds_read2st64_b32 v[44:45], v118 offset0:0 offset1:4
    ds_read2st64_b32 v[46:47], v118 offset0:8 offset1:12
    s_waitcnt lgkmcnt(6)
    v_perm_b32 v16, v33, v32, s58
    v_perm_b32 v17, v35, v34, s58
    v_perm_b32 v18, v33, v32, s59
    v_perm_b32 v19, v35, v34, s59
    s_waitcnt lgkmcnt(4)
    v_perm_b32 v20, v37, v36, s58
    v_perm_b32 v21, v39, v38, s58
    v_perm_b32 v22, v37, v36, s59
    v_accvgpr_write_b32 a116, v22
    v_perm_b32 v23, v39, v38, s59
    v_accvgpr_write_b32 a117, v23
    s_waitcnt lgkmcnt(2)
    v_perm_b32 v24, v41, v40, s58
    v_accvgpr_write_b32 a140, v24
    v_perm_b32 v25, v43, v42, s58
    v_accvgpr_write_b32 a141, v25
    v_perm_b32 v26, v41, v40, s59
    v_accvgpr_write_b32 a148, v26
    v_perm_b32 v27, v43, v42, s59
    v_accvgpr_write_b32 a149, v27
    s_waitcnt lgkmcnt(0)
    v_perm_b32 v28, v45, v44, s58
    v_perm_b32 v29, v47, v46, s58
    v_perm_b32 v30, v45, v44, s59
    v_accvgpr_write_b32 a172, v30
    v_perm_b32 v31, v47, v46, s59
    v_accvgpr_write_b32 a173, v31
    ds_write_b64 v0, v[16:17] offset:9216
    ds_write_b64 v0, v[18:19] offset:11264
    ds_write_b64 v0, v[20:21] offset:17408
    ds_write_b64 v0, v[28:29] offset:19456
    s_mov_b32 s54, 0
    buffer_load_dwordx4 v[32:35], v12, s[20:23], s54 offen
    s_mov_b32 s54, 8192
    buffer_load_dwordx4 v[36:39], v12, s[20:23], s54 offen
    s_mov_b32 s54, 131072
    buffer_load_dwordx4 v[40:43], v12, s[20:23], s54 offen
    s_mov_b32 s54, 139264
    buffer_load_dwordx4 v[44:47], v12, s[20:23], s54 offen
    s_waitcnt vmcnt(8)
    s_waitcnt lgkmcnt(0)
    s_barrier
    ds_write_b128 v119, v[48:51] offset:0
    ds_write_b128 v119, v[52:55] offset:1024
    ds_write_b128 v119, v[56:59] offset:2048
    ds_write_b128 v119, v[60:63] offset:3072
    s_waitcnt lgkmcnt(0)
    s_barrier
    ds_read2st64_b32 v[48:49], v114 offset0:0 offset1:4
    ds_read2st64_b32 v[50:51], v114 offset0:8 offset1:12
    ds_read2st64_b32 v[52:53], v115 offset0:0 offset1:4
    ds_read2st64_b32 v[54:55], v115 offset0:8 offset1:12
    ds_read2st64_b32 v[56:57], v116 offset0:0 offset1:4
    ds_read2st64_b32 v[58:59], v116 offset0:8 offset1:12
    ds_read2st64_b32 v[60:61], v118 offset0:0 offset1:4
    ds_read2st64_b32 v[62:63], v118 offset0:8 offset1:12
    s_waitcnt lgkmcnt(6)
    v_perm_b32 v16, v49, v48, s58
    v_perm_b32 v17, v51, v50, s58
    v_perm_b32 v18, v49, v48, s59
    v_perm_b32 v19, v51, v50, s59
    s_waitcnt lgkmcnt(4)
    v_perm_b32 v20, v53, v52, s58
    v_accvgpr_write_b32 a102, v20
    v_perm_b32 v21, v55, v54, s58
    v_accvgpr_write_b32 a103, v21
    v_perm_b32 v22, v53, v52, s59
    v_accvgpr_write_b32 a110, v22
    v_perm_b32 v23, v55, v54, s59
    v_accvgpr_write_b32 a111, v23
    s_waitcnt lgkmcnt(2)
    v_perm_b32 v24, v57, v56, s58
    v_accvgpr_write_b32 a126, v24
    v_perm_b32 v25, v59, v58, s58
    v_accvgpr_write_b32 a127, v25
    v_perm_b32 v26, v57, v56, s59
    v_accvgpr_write_b32 a134, v26
    v_perm_b32 v27, v59, v58, s59
    v_accvgpr_write_b32 a135, v27
    s_waitcnt lgkmcnt(0)
    v_perm_b32 v28, v61, v60, s58
    v_accvgpr_write_b32 a158, v28
    v_perm_b32 v29, v63, v62, s58
    v_accvgpr_write_b32 a159, v29
    v_perm_b32 v30, v61, v60, s59
    v_accvgpr_write_b32 a166, v30
    v_perm_b32 v31, v63, v62, s59
    v_accvgpr_write_b32 a167, v31
    ds_write_b64 v0, v[16:17] offset:5128
    ds_write_b64 v0, v[18:19] offset:7176
    s_mov_b32 s54, 32768
    buffer_load_dwordx4 v[48:51], v12, s[20:23], s54 offen
    s_mov_b32 s54, 40960
    buffer_load_dwordx4 v[52:55], v12, s[20:23], s54 offen
    s_mov_b32 s54, 163840
    buffer_load_dwordx4 v[56:59], v12, s[20:23], s54 offen
    s_mov_b32 s54, 172032
    buffer_load_dwordx4 v[60:63], v12, s[20:23], s54 offen
    s_waitcnt vmcnt(8)
    s_waitcnt lgkmcnt(0)
    s_barrier
    ds_write_b128 v119, v[64:67] offset:0
    ds_write_b128 v119, v[68:71] offset:1024
    ds_write_b128 v119, v[72:75] offset:2048
    ds_write_b128 v119, v[76:79] offset:3072
    s_waitcnt lgkmcnt(0)
    s_barrier
    ds_read2st64_b32 v[64:65], v114 offset0:0 offset1:4
    ds_read2st64_b32 v[66:67], v114 offset0:8 offset1:12
    ds_read2st64_b32 v[68:69], v115 offset0:0 offset1:4
    ds_read2st64_b32 v[70:71], v115 offset0:8 offset1:12
    ds_read2st64_b32 v[72:73], v116 offset0:0 offset1:4
    ds_read2st64_b32 v[74:75], v116 offset0:8 offset1:12
    ds_read2st64_b32 v[76:77], v118 offset0:0 offset1:4
    ds_read2st64_b32 v[78:79], v118 offset0:8 offset1:12
    s_waitcnt lgkmcnt(6)
    v_perm_b32 v16, v65, v64, s58
    v_perm_b32 v17, v67, v66, s58
    v_perm_b32 v18, v65, v64, s59
    v_perm_b32 v19, v67, v66, s59
    s_waitcnt lgkmcnt(4)
    v_perm_b32 v20, v69, v68, s58
    v_perm_b32 v21, v71, v70, s58
    v_perm_b32 v22, v69, v68, s59
    v_accvgpr_write_b32 a118, v22
    v_perm_b32 v23, v71, v70, s59
    v_accvgpr_write_b32 a119, v23
    s_waitcnt lgkmcnt(2)
    v_perm_b32 v24, v73, v72, s58
    v_accvgpr_write_b32 a142, v24
    v_perm_b32 v25, v75, v74, s58
    v_accvgpr_write_b32 a143, v25
    v_perm_b32 v26, v73, v72, s59
    v_accvgpr_write_b32 a150, v26
    v_perm_b32 v27, v75, v74, s59
    v_accvgpr_write_b32 a151, v27
    s_waitcnt lgkmcnt(0)
    v_perm_b32 v28, v77, v76, s58
    v_perm_b32 v29, v79, v78, s58
    v_perm_b32 v30, v77, v76, s59
    v_accvgpr_write_b32 a174, v30
    v_perm_b32 v31, v79, v78, s59
    v_accvgpr_write_b32 a175, v31
    ds_write_b64 v0, v[16:17] offset:9224
    ds_write_b64 v0, v[18:19] offset:11272
    ds_write_b64 v0, v[20:21] offset:17416
    ds_write_b64 v0, v[28:29] offset:19464
    s_mov_b32 s54, 16384
    buffer_load_dwordx4 v[64:67], v12, s[20:23], s54 offen
    s_mov_b32 s54, 24576
    buffer_load_dwordx4 v[68:71], v12, s[20:23], s54 offen
    s_mov_b32 s54, 147456
    buffer_load_dwordx4 v[72:75], v12, s[20:23], s54 offen
    s_mov_b32 s54, 155648
    buffer_load_dwordx4 v[76:79], v12, s[20:23], s54 offen
    s_waitcnt vmcnt(8)
    s_waitcnt lgkmcnt(0)
    s_barrier
    ds_write_b128 v119, v[32:35] offset:0
    ds_write_b128 v119, v[36:39] offset:1024
    ds_write_b128 v119, v[40:43] offset:2048
    ds_write_b128 v119, v[44:47] offset:3072
    s_waitcnt lgkmcnt(0)
    s_barrier
    ds_read2st64_b32 v[32:33], v114 offset0:0 offset1:4
    ds_read2st64_b32 v[34:35], v114 offset0:8 offset1:12
    ds_read2st64_b32 v[36:37], v115 offset0:0 offset1:4
    ds_read2st64_b32 v[38:39], v115 offset0:8 offset1:12
    ds_read2st64_b32 v[40:41], v116 offset0:0 offset1:4
    ds_read2st64_b32 v[42:43], v116 offset0:8 offset1:12
    ds_read2st64_b32 v[44:45], v118 offset0:0 offset1:4
    ds_read2st64_b32 v[46:47], v118 offset0:8 offset1:12
    s_waitcnt lgkmcnt(6)
    v_perm_b32 v16, v33, v32, s58
    v_accvgpr_write_b32 a176, v16
    v_perm_b32 v17, v35, v34, s58
    v_accvgpr_write_b32 a177, v17
    v_perm_b32 v18, v33, v32, s59
    v_accvgpr_write_b32 a184, v18
    v_perm_b32 v19, v35, v34, s59
    v_accvgpr_write_b32 a185, v19
    s_waitcnt lgkmcnt(4)
    v_perm_b32 v20, v37, v36, s58
    v_accvgpr_write_b32 a192, v20
    v_perm_b32 v21, v39, v38, s58
    v_accvgpr_write_b32 a193, v21
    v_perm_b32 v22, v37, v36, s59
    v_accvgpr_write_b32 a200, v22
    v_perm_b32 v23, v39, v38, s59
    v_accvgpr_write_b32 a201, v23
    s_waitcnt lgkmcnt(2)
    v_perm_b32 v24, v41, v40, s58
    v_accvgpr_write_b32 a224, v24
    v_perm_b32 v25, v43, v42, s58
    v_accvgpr_write_b32 a225, v25
    v_perm_b32 v26, v41, v40, s59
    v_accvgpr_write_b32 a232, v26
    v_perm_b32 v27, v43, v42, s59
    v_accvgpr_write_b32 a233, v27
    s_waitcnt lgkmcnt(0)
    v_perm_b32 v128, v45, v44, s58
    v_perm_b32 v129, v47, v46, s58
    v_perm_b32 v136, v45, v44, s59
    v_perm_b32 v137, v47, v46, s59
    s_mov_b32 s54, 49152
    buffer_load_dwordx4 v[32:35], v12, s[20:23], s54 offen
    s_mov_b32 s54, 57344
    buffer_load_dwordx4 v[36:39], v12, s[20:23], s54 offen
    s_mov_b32 s54, 180224
    buffer_load_dwordx4 v[40:43], v12, s[20:23], s54 offen
    s_mov_b32 s54, 188416
    buffer_load_dwordx4 v[44:47], v12, s[20:23], s54 offen
    s_waitcnt vmcnt(8)
    s_barrier
    ds_write_b128 v119, v[48:51] offset:0
    ds_write_b128 v119, v[52:55] offset:1024
    ds_write_b128 v119, v[56:59] offset:2048
    ds_write_b128 v119, v[60:63] offset:3072
    s_waitcnt lgkmcnt(0)
    s_barrier
    ds_read2st64_b32 v[48:49], v114 offset0:0 offset1:4
    ds_read2st64_b32 v[50:51], v114 offset0:8 offset1:12
    ds_read2st64_b32 v[52:53], v115 offset0:0 offset1:4
    ds_read2st64_b32 v[54:55], v115 offset0:8 offset1:12
    ds_read2st64_b32 v[56:57], v116 offset0:0 offset1:4
    ds_read2st64_b32 v[58:59], v116 offset0:8 offset1:12
    ds_read2st64_b32 v[60:61], v118 offset0:0 offset1:4
    ds_read2st64_b32 v[62:63], v118 offset0:8 offset1:12
    s_waitcnt lgkmcnt(6)
    v_perm_b32 v16, v49, v48, s58
    v_perm_b32 v17, v51, v50, s58
    v_perm_b32 v18, v49, v48, s59
    v_perm_b32 v19, v51, v50, s59
    s_waitcnt lgkmcnt(4)
    v_perm_b32 v20, v53, v52, s58
    v_accvgpr_write_b32 a208, v20
    v_perm_b32 v21, v55, v54, s58
    v_accvgpr_write_b32 a209, v21
    v_perm_b32 v22, v53, v52, s59
    v_accvgpr_write_b32 a216, v22
    v_perm_b32 v23, v55, v54, s59
    v_accvgpr_write_b32 a217, v23
    s_waitcnt lgkmcnt(2)
    v_perm_b32 v24, v57, v56, s58
    v_accvgpr_write_b32 a240, v24
    v_perm_b32 v25, v59, v58, s58
    v_accvgpr_write_b32 a241, v25
    v_perm_b32 v26, v57, v56, s59
    v_accvgpr_write_b32 a248, v26
    v_perm_b32 v27, v59, v58, s59
    v_accvgpr_write_b32 a249, v27
    s_waitcnt lgkmcnt(0)
    v_perm_b32 v144, v61, v60, s58
    v_perm_b32 v145, v63, v62, s58
    v_perm_b32 v152, v61, v60, s59
    v_perm_b32 v153, v63, v62, s59
    ds_write_b64 v0, v[16:17] offset:20480
    ds_write_b64 v0, v[18:19] offset:22528
    s_mov_b32 s54, 524288
    buffer_load_dwordx4 v[48:51], v12, s[20:23], s54 offen
    s_mov_b32 s54, 532480
    buffer_load_dwordx4 v[52:55], v12, s[20:23], s54 offen
    s_mov_b32 s54, 655360
    buffer_load_dwordx4 v[56:59], v12, s[20:23], s54 offen
    s_mov_b32 s54, 663552
    buffer_load_dwordx4 v[60:63], v12, s[20:23], s54 offen
    s_waitcnt vmcnt(8)
    s_waitcnt lgkmcnt(0)
    s_barrier
    ds_write_b128 v119, v[64:67] offset:0
    ds_write_b128 v119, v[68:71] offset:1024
    ds_write_b128 v119, v[72:75] offset:2048
    ds_write_b128 v119, v[76:79] offset:3072
    s_waitcnt lgkmcnt(0)
    s_barrier
    ds_read2st64_b32 v[64:65], v114 offset0:0 offset1:4
    ds_read2st64_b32 v[66:67], v114 offset0:8 offset1:12
    ds_read2st64_b32 v[68:69], v115 offset0:0 offset1:4
    ds_read2st64_b32 v[70:71], v115 offset0:8 offset1:12
    ds_read2st64_b32 v[72:73], v116 offset0:0 offset1:4
    ds_read2st64_b32 v[74:75], v116 offset0:8 offset1:12
    ds_read2st64_b32 v[76:77], v118 offset0:0 offset1:4
    ds_read2st64_b32 v[78:79], v118 offset0:8 offset1:12
    s_waitcnt lgkmcnt(6)
    v_perm_b32 v16, v65, v64, s58
    v_accvgpr_write_b32 a178, v16
    v_perm_b32 v17, v67, v66, s58
    v_accvgpr_write_b32 a179, v17
    v_perm_b32 v18, v65, v64, s59
    v_accvgpr_write_b32 a186, v18
    v_perm_b32 v19, v67, v66, s59
    v_accvgpr_write_b32 a187, v19
    s_waitcnt lgkmcnt(4)
    v_perm_b32 v20, v69, v68, s58
    v_accvgpr_write_b32 a194, v20
    v_perm_b32 v21, v71, v70, s58
    v_accvgpr_write_b32 a195, v21
    v_perm_b32 v22, v69, v68, s59
    v_accvgpr_write_b32 a202, v22
    v_perm_b32 v23, v71, v70, s59
    v_accvgpr_write_b32 a203, v23
    s_waitcnt lgkmcnt(2)
    v_perm_b32 v24, v73, v72, s58
    v_accvgpr_write_b32 a226, v24
    v_perm_b32 v25, v75, v74, s58
    v_accvgpr_write_b32 a227, v25
    v_perm_b32 v26, v73, v72, s59
    v_accvgpr_write_b32 a234, v26
    v_perm_b32 v27, v75, v74, s59
    v_accvgpr_write_b32 a235, v27
    s_waitcnt lgkmcnt(0)
    v_perm_b32 v130, v77, v76, s58
    v_perm_b32 v131, v79, v78, s58
    v_perm_b32 v138, v77, v76, s59
    v_perm_b32 v139, v79, v78, s59
    s_mov_b32 s54, 557056
    buffer_load_dwordx4 v[64:67], v12, s[20:23], s54 offen
    s_mov_b32 s54, 565248
    buffer_load_dwordx4 v[68:71], v12, s[20:23], s54 offen
    s_mov_b32 s54, 688128
    buffer_load_dwordx4 v[72:75], v12, s[20:23], s54 offen
    s_mov_b32 s54, 696320
    buffer_load_dwordx4 v[76:79], v12, s[20:23], s54 offen
    s_waitcnt vmcnt(8)
    s_barrier
    ds_write_b128 v119, v[32:35] offset:0
    ds_write_b128 v119, v[36:39] offset:1024
    ds_write_b128 v119, v[40:43] offset:2048
    ds_write_b128 v119, v[44:47] offset:3072
    s_waitcnt lgkmcnt(0)
    s_barrier
    ds_read2st64_b32 v[32:33], v114 offset0:0 offset1:4
    ds_read2st64_b32 v[34:35], v114 offset0:8 offset1:12
    ds_read2st64_b32 v[36:37], v115 offset0:0 offset1:4
    ds_read2st64_b32 v[38:39], v115 offset0:8 offset1:12
    ds_read2st64_b32 v[40:41], v116 offset0:0 offset1:4
    ds_read2st64_b32 v[42:43], v116 offset0:8 offset1:12
    ds_read2st64_b32 v[44:45], v118 offset0:0 offset1:4
    ds_read2st64_b32 v[46:47], v118 offset0:8 offset1:12
    s_waitcnt lgkmcnt(6)
    v_perm_b32 v16, v33, v32, s58
    v_perm_b32 v17, v35, v34, s58
    v_perm_b32 v18, v33, v32, s59
    v_perm_b32 v19, v35, v34, s59
    s_waitcnt lgkmcnt(4)
    v_perm_b32 v20, v37, v36, s58
    v_accvgpr_write_b32 a210, v20
    v_perm_b32 v21, v39, v38, s58
    v_accvgpr_write_b32 a211, v21
    v_perm_b32 v22, v37, v36, s59
    v_accvgpr_write_b32 a218, v22
    v_perm_b32 v23, v39, v38, s59
    v_accvgpr_write_b32 a219, v23
    s_waitcnt lgkmcnt(2)
    v_perm_b32 v24, v41, v40, s58
    v_accvgpr_write_b32 a242, v24
    v_perm_b32 v25, v43, v42, s58
    v_accvgpr_write_b32 a243, v25
    v_perm_b32 v26, v41, v40, s59
    v_accvgpr_write_b32 a250, v26
    v_perm_b32 v27, v43, v42, s59
    v_accvgpr_write_b32 a251, v27
    s_waitcnt lgkmcnt(0)
    v_perm_b32 v146, v45, v44, s58
    v_perm_b32 v147, v47, v46, s58
    v_perm_b32 v154, v45, v44, s59
    v_perm_b32 v155, v47, v46, s59
    ds_write_b64 v0, v[16:17] offset:20488
    ds_write_b64 v0, v[18:19] offset:22536
    s_mov_b32 s54, 540672
    buffer_load_dwordx4 v[32:35], v12, s[20:23], s54 offen
    s_mov_b32 s54, 548864
    buffer_load_dwordx4 v[36:39], v12, s[20:23], s54 offen
    s_mov_b32 s54, 671744
    buffer_load_dwordx4 v[40:43], v12, s[20:23], s54 offen
    s_mov_b32 s54, 679936
    buffer_load_dwordx4 v[44:47], v12, s[20:23], s54 offen
    s_waitcnt vmcnt(8)
    s_waitcnt lgkmcnt(0)
    s_barrier
    ds_write_b128 v119, v[48:51] offset:0
    ds_write_b128 v119, v[52:55] offset:1024
    ds_write_b128 v119, v[56:59] offset:2048
    ds_write_b128 v119, v[60:63] offset:3072
    s_waitcnt lgkmcnt(0)
    s_barrier
    ds_read2st64_b32 v[48:49], v114 offset0:0 offset1:4
    ds_read2st64_b32 v[50:51], v114 offset0:8 offset1:12
    ds_read2st64_b32 v[52:53], v115 offset0:0 offset1:4
    ds_read2st64_b32 v[54:55], v115 offset0:8 offset1:12
    ds_read2st64_b32 v[56:57], v116 offset0:0 offset1:4
    ds_read2st64_b32 v[58:59], v116 offset0:8 offset1:12
    ds_read2st64_b32 v[60:61], v118 offset0:0 offset1:4
    ds_read2st64_b32 v[62:63], v118 offset0:8 offset1:12
    s_waitcnt lgkmcnt(6)
    v_perm_b32 v16, v49, v48, s58
    v_accvgpr_write_b32 a180, v16
    v_perm_b32 v17, v51, v50, s58
    v_accvgpr_write_b32 a181, v17
    v_perm_b32 v18, v49, v48, s59
    v_accvgpr_write_b32 a188, v18
    v_perm_b32 v19, v51, v50, s59
    v_accvgpr_write_b32 a189, v19
    s_waitcnt lgkmcnt(4)
    v_perm_b32 v20, v53, v52, s58
    v_accvgpr_write_b32 a196, v20
    v_perm_b32 v21, v55, v54, s58
    v_accvgpr_write_b32 a197, v21
    v_perm_b32 v22, v53, v52, s59
    v_accvgpr_write_b32 a204, v22
    v_perm_b32 v23, v55, v54, s59
    v_accvgpr_write_b32 a205, v23
    s_waitcnt lgkmcnt(2)
    v_perm_b32 v24, v57, v56, s58
    v_accvgpr_write_b32 a228, v24
    v_perm_b32 v25, v59, v58, s58
    v_accvgpr_write_b32 a229, v25
    v_perm_b32 v26, v57, v56, s59
    v_accvgpr_write_b32 a236, v26
    v_perm_b32 v27, v59, v58, s59
    v_accvgpr_write_b32 a237, v27
    s_waitcnt lgkmcnt(0)
    v_perm_b32 v132, v61, v60, s58
    v_perm_b32 v133, v63, v62, s58
    v_perm_b32 v140, v61, v60, s59
    v_perm_b32 v141, v63, v62, s59
    s_mov_b32 s54, 573440
    buffer_load_dwordx4 v[48:51], v12, s[20:23], s54 offen
    s_mov_b32 s54, 581632
    buffer_load_dwordx4 v[52:55], v12, s[20:23], s54 offen
    s_mov_b32 s54, 704512
    buffer_load_dwordx4 v[56:59], v12, s[20:23], s54 offen
    s_mov_b32 s54, 712704
    buffer_load_dwordx4 v[60:63], v12, s[20:23], s54 offen
    s_waitcnt vmcnt(8)
    s_barrier
    ds_write_b128 v119, v[64:67] offset:0
    ds_write_b128 v119, v[68:71] offset:1024
    ds_write_b128 v119, v[72:75] offset:2048
    ds_write_b128 v119, v[76:79] offset:3072
    s_waitcnt lgkmcnt(0)
    s_barrier
    ds_read2st64_b32 v[64:65], v114 offset0:0 offset1:4
    ds_read2st64_b32 v[66:67], v114 offset0:8 offset1:12
    ds_read2st64_b32 v[68:69], v115 offset0:0 offset1:4
    ds_read2st64_b32 v[70:71], v115 offset0:8 offset1:12
    ds_read2st64_b32 v[72:73], v116 offset0:0 offset1:4
    ds_read2st64_b32 v[74:75], v116 offset0:8 offset1:12
    ds_read2st64_b32 v[76:77], v118 offset0:0 offset1:4
    ds_read2st64_b32 v[78:79], v118 offset0:8 offset1:12
    s_waitcnt lgkmcnt(6)
    v_perm_b32 v16, v65, v64, s58
    v_perm_b32 v17, v67, v66, s58
    v_perm_b32 v18, v65, v64, s59
    v_perm_b32 v19, v67, v66, s59
    s_waitcnt lgkmcnt(4)
    v_perm_b32 v20, v69, v68, s58
    v_accvgpr_write_b32 a212, v20
    v_perm_b32 v21, v71, v70, s58
    v_accvgpr_write_b32 a213, v21
    v_perm_b32 v22, v69, v68, s59
    v_accvgpr_write_b32 a220, v22
    v_perm_b32 v23, v71, v70, s59
    v_accvgpr_write_b32 a221, v23
    s_waitcnt lgkmcnt(2)
    v_perm_b32 v24, v73, v72, s58
    v_accvgpr_write_b32 a244, v24
    v_perm_b32 v25, v75, v74, s58
    v_accvgpr_write_b32 a245, v25
    v_perm_b32 v26, v73, v72, s59
    v_accvgpr_write_b32 a252, v26
    v_perm_b32 v27, v75, v74, s59
    v_accvgpr_write_b32 a253, v27
    s_waitcnt lgkmcnt(0)
    v_perm_b32 v148, v77, v76, s58
    v_perm_b32 v149, v79, v78, s58
    v_perm_b32 v156, v77, v76, s59
    v_perm_b32 v157, v79, v78, s59
    ds_write_b64 v0, v[16:17] offset:21504
    ds_write_b64 v0, v[18:19] offset:23552
    s_waitcnt vmcnt(4)
    s_waitcnt lgkmcnt(0)
    s_barrier
    ds_write_b128 v119, v[32:35] offset:0
    ds_write_b128 v119, v[36:39] offset:1024
    ds_write_b128 v119, v[40:43] offset:2048
    ds_write_b128 v119, v[44:47] offset:3072
    s_waitcnt lgkmcnt(0)
    s_barrier
    ds_read2st64_b32 v[32:33], v114 offset0:0 offset1:4
    ds_read2st64_b32 v[34:35], v114 offset0:8 offset1:12
    ds_read2st64_b32 v[36:37], v115 offset0:0 offset1:4
    ds_read2st64_b32 v[38:39], v115 offset0:8 offset1:12
    ds_read2st64_b32 v[40:41], v116 offset0:0 offset1:4
    ds_read2st64_b32 v[42:43], v116 offset0:8 offset1:12
    ds_read2st64_b32 v[44:45], v118 offset0:0 offset1:4
    ds_read2st64_b32 v[46:47], v118 offset0:8 offset1:12
    s_waitcnt lgkmcnt(6)
    v_perm_b32 v16, v33, v32, s58
    v_accvgpr_write_b32 a182, v16
    v_perm_b32 v17, v35, v34, s58
    v_accvgpr_write_b32 a183, v17
    v_perm_b32 v18, v33, v32, s59
    v_accvgpr_write_b32 a190, v18
    v_perm_b32 v19, v35, v34, s59
    v_accvgpr_write_b32 a191, v19
    s_waitcnt lgkmcnt(4)
    v_perm_b32 v20, v37, v36, s58
    v_accvgpr_write_b32 a198, v20
    v_perm_b32 v21, v39, v38, s58
    v_accvgpr_write_b32 a199, v21
    v_perm_b32 v22, v37, v36, s59
    v_accvgpr_write_b32 a206, v22
    v_perm_b32 v23, v39, v38, s59
    v_accvgpr_write_b32 a207, v23
    s_waitcnt lgkmcnt(2)
    v_perm_b32 v24, v41, v40, s58
    v_accvgpr_write_b32 a230, v24
    v_perm_b32 v25, v43, v42, s58
    v_accvgpr_write_b32 a231, v25
    v_perm_b32 v26, v41, v40, s59
    v_accvgpr_write_b32 a238, v26
    v_perm_b32 v27, v43, v42, s59
    v_accvgpr_write_b32 a239, v27
    s_waitcnt lgkmcnt(0)
    v_perm_b32 v134, v45, v44, s58
    v_perm_b32 v135, v47, v46, s58
    v_perm_b32 v142, v45, v44, s59
    v_perm_b32 v143, v47, v46, s59
    s_waitcnt vmcnt(0)
    s_barrier
    ds_write_b128 v119, v[48:51] offset:0
    ds_write_b128 v119, v[52:55] offset:1024
    ds_write_b128 v119, v[56:59] offset:2048
    ds_write_b128 v119, v[60:63] offset:3072
    s_waitcnt lgkmcnt(0)
    s_barrier
    ds_read2st64_b32 v[48:49], v114 offset0:0 offset1:4
    ds_read2st64_b32 v[50:51], v114 offset0:8 offset1:12
    ds_read2st64_b32 v[52:53], v115 offset0:0 offset1:4
    ds_read2st64_b32 v[54:55], v115 offset0:8 offset1:12
    ds_read2st64_b32 v[56:57], v116 offset0:0 offset1:4
    ds_read2st64_b32 v[58:59], v116 offset0:8 offset1:12
    ds_read2st64_b32 v[60:61], v118 offset0:0 offset1:4
    ds_read2st64_b32 v[62:63], v118 offset0:8 offset1:12
    s_waitcnt lgkmcnt(6)
    v_perm_b32 v16, v49, v48, s58
    v_perm_b32 v17, v51, v50, s58
    v_perm_b32 v18, v49, v48, s59
    v_perm_b32 v19, v51, v50, s59
    s_waitcnt lgkmcnt(4)
    v_perm_b32 v20, v53, v52, s58
    v_accvgpr_write_b32 a214, v20
    v_perm_b32 v21, v55, v54, s58
    v_accvgpr_write_b32 a215, v21
    v_perm_b32 v22, v53, v52, s59
    v_accvgpr_write_b32 a222, v22
    v_perm_b32 v23, v55, v54, s59
    v_accvgpr_write_b32 a223, v23
    s_waitcnt lgkmcnt(2)
    v_perm_b32 v24, v57, v56, s58
    v_accvgpr_write_b32 a246, v24
    v_perm_b32 v25, v59, v58, s58
    v_accvgpr_write_b32 a247, v25
    v_perm_b32 v26, v57, v56, s59
    v_accvgpr_write_b32 a254, v26
    v_perm_b32 v27, v59, v58, s59
    v_accvgpr_write_b32 a255, v27
    s_waitcnt lgkmcnt(0)
    v_perm_b32 v150, v61, v60, s58
    v_perm_b32 v151, v63, v62, s58
    v_perm_b32 v158, v61, v60, s59
    v_perm_b32 v159, v63, v62, s59
    ds_write_b64 v0, v[16:17] offset:21512
    ds_write_b64 v0, v[18:19] offset:23560
    s_waitcnt lgkmcnt(0)
    s_waitcnt vmcnt(0)
    s_barrier
    buffer_load_dwordx2 v[64:65], v117, s[28:31], 0 offen offset:0
    buffer_load_dwordx2 v[66:67], v117, s[28:31], 0 offen offset:16
    buffer_load_dwordx2 v[68:69], v117, s[28:31], 0 offen offset:8
    buffer_load_dwordx2 v[70:71], v117, s[28:31], 0 offen offset:24
    v_and_b32 v18, 7, v127
    v_lshlrev_b32 v18, 3, v18
    s_mov_b32 s56, 0
L_ch_wi:
    global_load_dwordx2 v[16:17], v18, s[36:37] offset:128 sc1
    s_add_u32 s56, s56, 1
    s_cmp_gt_u32 s56, 400000
    s_cbranch_scc1 L_end
    s_waitcnt vmcnt(0)
    v_or_b32 v17, v16, v17
    v_cmp_ne_u32 vcc, -1, v17
    s_cbranch_vccnz L_ch_wi
    v_readfirstlane_b32 s60, v16
    s_mov_b32 s42, 0
    s_lshl_b32 s62, s40, 6
    s_add_u32 s62, s62, 655360
    s_mov_b32 s56, 0
L_ch_wf:
    buffer_load_dword v16, off, s[8:11], s62 sc1
    buffer_load_dword v17, off, s[8:11], s62 offset:2048 sc1
    s_add_u32 s56, s56, 1
    s_cmp_gt_u32 s56, 400000
    s_cbranch_scc1 L_end
    s_waitcnt vmcnt(0)
    v_min_u32 v16, v16, v17
    v_cmp_eq_u32 vcc, 0, v16
    s_cbranch_vccnz L_ch_wf
    s_add_u32 s62, s62, 4096
    s_lshl_b32 s57, s40, 14
    s_lshl_b32 s54, s41, 11
    s_add_u32 s57, s57, s54
    s_add_u32 s57, s57, 16646144
    buffer_load_dwordx4 v1, s[8:11], s57 offen sc1 lds
    buffer_load_dwordx4 v1, s[8:11], s57 offen offset:1024 sc1 lds
    s_add_u32 s52, s54, 393216
    s_mov_b32 s51, 524288
    s_add_u32 s61, s57, 8192
    buffer_load_dwordx4 v[40:43], v1, s[8:11], s61 offen sc1
    buffer_load_dwordx4 v[44:47], v1, s[8:11], s61 offen offset:1024 sc1
    s_sub_u32 s49, s61, 131072
    s_add_u32 s49, s49, 524288
    s_add_u32 s61, s61, 524288
    s_add_u32 s57, s57, 524288
    s_lshl_b32 s63, s40, 12
    s_lshl_b32 s54, s41, 10
    s_add_u32 s63, s63, s54
    s_add_u32 s63, s63, 8126464
    s_mov_b32 s46, 1048576
    s_mov_b32 s47, 1052672
    s_lshl_b32 s48, s40, 2
    s_add_u32 s48, s48, s41
    s_lshl_b32 s48, s48, 11
    s_add_u32 s48, s48, 917504
    s_mov_b32 s45, 1
    s_mov_b32 s50, 0
    s_mov_b32 s56, 0
    ds_read_b128 v[72:75], v0 offset:0
    ds_read_b128 v[76:79], v0 offset:1024
    ds_read_b128 v[80:83], v0 offset:2048
    ds_read_b128 v[84:87], v0 offset:3072
    ds_read_b128 v[88:91], v0 offset:4096
    ds_read_b128 v[92:95], v0 offset:5120
    ds_read_b128 v[56:59], v0 offset:6144
    ds_read_b128 v[60:63], v0 offset:7168
    ds_read_b128 v[96:99], v0 offset:8192
    ds_read_b128 v[100:103], v0 offset:9216
    ds_read_b128 v[104:107], v0 offset:10240
    ds_read_b128 v[108:111], v0 offset:11264
    ds_read_b128 v[112:115], v0 offset:12288
    ds_read_b128 v[116:119], v0 offset:13312
    ds_read_b128 v[120:123], v0 offset:14336
    ds_read_b128 v[124:127], v0 offset:15360
    v_mov_b64 v[16:17], 0
    v_mov_b64 v[18:19], 0
    v_mov_b64 v[20:21], 0
    v_mov_b64 v[22:23], 0
    v_mov_b64 v[24:25], 0
    v_mov_b64 v[26:27], 0
    v_mov_b64 v[28:29], 0
    v_mov_b64 v[30:31], 0
    v_mov_b64 v[32:33], 0
    v_mov_b64 v[34:35], 0
    v_mov_b64 v[36:37], 0
    v_mov_b64 v[38:39], 0
    v_mov_b64 v[52:53], 0
    v_mov_b64 v[54:55], 0
    s_waitcnt vmcnt(0)
    s_xor_b32 m0, m0, 0x2000
    s_cmp_lg_u32 s60, -1
    s_cbranch_scc1 L_step_s
    s_branch L_step_f
.p2align 7
    s_endpgm
L_step_f:
    s_waitcnt vmcnt(3) lgkmcnt(0)
L_st2_f:
    v_smfmac_f32_16x16x64_bf16 v[16:19], v[64:67], v[72:79], v9
    ds_write_b128 v4, v[64:67]
    v_bitop3_b32 v13, v64, v65, s45 bitop3:0x7e
    v_smfmac_f32_16x16x64_bf16 v[20:23], v[64:67], v[80:87], v9
    v_bitop3_b32 v14, v66, v67, s45 bitop3:0x7e
    v_smfmac_f32_16x16x64_bf16 v[24:27], v[64:67], v[88:95], v9
    v_bitop3_b32 v13, v13, v14, s50 bitop3:0xa8
    v_smfmac_f32_16x16x64_bf16 v[28:31], v[64:67], v[56:63], v9
    v_cmp_ne_u32 vcc, 0, v13
    s_cbranch_vccnz L_e_fail_f
L_l_chk_f:
    s_waitcnt vmcnt(1)
    v_bitop3_b32 v13, v68, v69, s45 bitop3:0x7e
    v_bitop3_b32 v14, v70, v71, s45 bitop3:0x7e
    v_bitop3_b32 v13, v13, v14, s50 bitop3:0xa8
    v_cmp_ne_u32 vcc, 0, v13
    s_cbranch_vccnz L_l_fail_f
L_l_ok_f:
    v_smfmac_f32_16x16x64_bf16 v[16:19], v[68:71], v[112:119], v9
    s_waitcnt lgkmcnt(0)
    s_barrier
    ds_read_b128 v[72:75], v5 offset:0
    buffer_store_dwordx4 v[52:55], v1, s[8:11], s63 offen sc1
    v_lshlrev_b32 v13, 1, v1
    v_smfmac_f32_16x16x64_bf16 v[20:23], v[68:71], v[120:127], v9
    ds_read_b128 v[76:79], v6 offset:0
    ds_write_b128 v4, v[68:71] offset:4096
    v_smfmac_f32_16x16x64_bf16 v[24:27], v[68:71], v[96:103], v9
    buffer_load_dword v12, v13, s[8:11], s49 offen sc1
    ds_read_b128 v[80:83], v7 offset:0
    v_smfmac_f32_16x16x64_bf16 v[28:31], v[68:71], v[104:111], v9
    buffer_load_dword v12, off, s[8:11], s62 sc1
    s_waitcnt lgkmcnt(3)
    v_smfmac_f32_16x16x64_bf16 v[16:19], v[72:75], a[0:7], v9
    s_xor_b32 s45, s45, 1
    v_mov_b64 v[32:33], 0
    v_smfmac_f32_16x16x64_bf16 v[20:23], v[72:75], a[8:15], v9
    buffer_load_dwordx4 v1, s[8:11], s57 offen offset:0 sc1 lds
    s_waitcnt lgkmcnt(2)
    v_smfmac_f32_16x16x64_bf16 v[16:19], v[76:79], a[32:39], v9
    s_waitcnt lgkmcnt(0)
    s_barrier
    ds_read_b128 v[84:87], v5 offset:4096
    v_smfmac_f32_16x16x64_bf16 v[20:23], v[76:79], a[40:47], v9
    ds_read_b128 v[88:91], v6 offset:4096
    v_smfmac_f32_16x16x64_bf16 v[16:19], v[80:83], a[64:71], v9
    ds_read_b128 v[92:95], v7 offset:4096
    v_smfmac_f32_16x16x64_bf16 v[20:23], v[80:83], a[72:79], v9
    buffer_load_dwordx4 v1, s[8:11], s57 offen offset:1024 sc1 lds
    v_mov_b64 v[34:35], 0
    v_smfmac_f32_16x16x64_bf16 v[24:27], v[72:75], a[96:103], v9
    ds_read_b128 v[96:99], v0 offset:16384
    v_smfmac_f32_16x16x64_bf16 v[24:27], v[76:79], a[120:127], v9
    ds_read_b128 v[100:103], v0 offset:17408
    s_waitcnt lgkmcnt(2)
    v_smfmac_f32_16x16x64_bf16 v[16:19], v[84:87], a[16:23], v9
    ds_read_b128 v[104:107], v0 offset:18432
    v_smfmac_f32_16x16x64_bf16 v[16:19], v[88:91], a[48:55], v9
    ds_read_b128 v[108:111], v0 offset:19456
    v_smfmac_f32_16x16x64_bf16 v[16:19], v[92:95], a[80:87], v9
    ds_read_b128 v[112:115], v0 offset:20480
    v_smfmac_f32_16x16x64_bf16 v[20:23], v[84:87], a[24:31], v9
    ds_read_b128 v[116:119], v0 offset:21504
    v_smfmac_f32_16x16x64_bf16 v[20:23], v[88:91], a[56:63], v9
    ds_read_b128 v[120:123], v0 offset:22528
    v_add_f32 v16, v16, v18
    v_smfmac_f32_16x16x64_bf16 v[20:23], v[92:95], a[88:95], v9
    ds_read_b128 v[124:127], v0 offset:23552
    v_add_f32 v17, v17, v19
    v_smfmac_f32_16x16x64_bf16 v[24:27], v[80:83], a[152:159], v9
    s_waitcnt lgkmcnt(4)
    v_smfmac_f32_16x16x64_bf16 v[24:27], v[84:87], v[96:103], v9
    v_add_f32 v20, v20, v22
    v_add_f32 v21, v21, v23
    v_smfmac_f32_16x16x64_bf16 v[24:27], v[88:91], a[136:143], v9
    v_cvt_pk_bf16_f32 v16, v16, v20
    v_cvt_pk_bf16_f32 v17, v17, v21
    v_smfmac_f32_16x16x64_bf16 v[24:27], v[92:95], v[104:111], v9
    ds_write2_b32 v2, v16, v17 offset0:0 offset1:68
    v_smfmac_f32_16x16x64_bf16 v[28:31], v[72:75], a[104:111], v9
    ds_read_b128 v[96:99], v11 offset:0
    v_smfmac_f32_16x16x64_bf16 v[28:31], v[76:79], a[128:135], v9
    ds_read_b128 v[100:103], v11 offset:2048
    v_add_f32 v24, v24, v26
    v_smfmac_f32_16x16x64_bf16 v[28:31], v[80:83], a[160:167], v9
    ds_read_b128 v[104:107], v11 offset:4096
    v_add_f32 v25, v25, v27
    v_smfmac_f32_16x16x64_bf16 v[28:31], v[84:87], a[112:119], v9
    ds_read_b128 v[108:111], v11 offset:6144
    v_add_u32_sdwa v13, v3, v9 dst_sel:DWORD dst_unused:UNUSED_PAD src0_sel:DWORD src1_sel:WORD_1
    v_smfmac_f32_16x16x64_bf16 v[28:31], v[88:91], a[144:151], v9
    s_waitcnt lgkmcnt(4) vmcnt(5)
    s_barrier
    ds_read_b128 v[48:51], v3 offset:7168
    v_smfmac_f32_16x16x64_bf16 v[28:31], v[92:95], a[168:175], v9
    ds_read_b128 v[52:55], v3 offset:7232
    v_smfmac_f32_16x16x64_bf16 v[32:35], v[64:67], a[176:183], v9
    ds_read_b128 v[56:59], v3 offset:7296
    v_smfmac_f32_16x16x64_bf16 v[36:39], v[64:67], a[184:191], v9
    ds_read_b128 v[60:63], v3 offset:7360
    v_add_f32 v28, v28, v30
    v_add_f32 v29, v29, v31
    v_smfmac_f32_16x16x64_bf16 v[32:35], v[68:71], v[112:119], v9
    v_cvt_pk_bf16_f32 v27, v25, v29
    v_cvt_pk_bf16_f32 v25, v24, v28
    v_smfmac_f32_16x16x64_bf16 v[36:39], v[68:71], v[120:127], v9
    ds_write2_b32 v15, v25, v27 offset0:0 offset1:68
    v_smfmac_f32_16x16x64_bf16 v[32:35], v[72:75], a[192:199], v9
    ds_read_b128 v[112:115], v11 offset:1024
    v_smfmac_f32_16x16x64_bf16 v[36:39], v[72:75], a[200:207], v9
    ds_read_b128 v[116:119], v11 offset:3072
    s_waitcnt lgkmcnt(3)
    v_mfma_f32_16x16x32_bf16 v[16:19], v[96:99], v[48:51], 0
    ds_read_b128 v[120:123], v11 offset:5120
    v_mov_b64 v[28:29], 0
    v_mfma_f32_16x16x32_bf16 v[16:19], v[100:103], v[52:55], v[16:19]
    ds_read_b128 v[124:127], v11 offset:7168
    v_mov_b64 v[30:31], 0
    v_mfma_f32_16x16x32_bf16 v[16:19], v[104:107], v[56:59], v[16:19]
    s_waitcnt lgkmcnt(4)
    s_barrier
    ds_read_b128 v[96:99], v13 offset:0
    v_mfma_f32_16x16x32_bf16 v[16:19], v[108:111], v[60:63], v[16:19]
    ds_read_b128 v[100:103], v13 offset:64
    v_mov_b32 v73, 0
    v_smfmac_f32_16x16x64_bf16 v[32:35], v[76:79], a[224:231], v9
    ds_read_b128 v[68:71], v1 offset:25600
    v_smfmac_f32_16x16x64_bf16 v[36:39], v[76:79], a[232:239], v9
    s_waitcnt lgkmcnt(3)
    v_exp_f32 v104, v16
    v_mfma_f32_16x16x32_bf16 v[20:23], v[112:115], v[48:51], 0
    v_exp_f32 v105, v17
    v_mfma_f32_16x16x32_bf16 v[20:23], v[116:119], v[52:55], v[20:23]
    v_exp_f32 v106, v18
    v_mfma_f32_16x16x32_bf16 v[20:23], v[120:123], v[56:59], v[20:23]
    v_exp_f32 v107, v19
    v_mfma_f32_16x16x32_bf16 v[20:23], v[124:127], v[60:63], v[20:23]
    s_waitcnt lgkmcnt(0)
    v_cvt_pk_bf16_f32 v64, v104, v105
    v_smfmac_f32_16x16x64_bf16 v[28:31], v[96:99], v[48:55], v9
    v_cvt_pk_bf16_f32 v65, v106, v107
    v_smfmac_f32_16x16x64_bf16 v[28:31], v[100:103], v[56:63], v9
    v_exp_f32 v108, v20
    v_smfmac_f32_16x16x64_bf16 v[32:35], v[80:83], v[128:135], v9
    v_exp_f32 v109, v21
    v_smfmac_f32_16x16x64_bf16 v[32:35], v[84:87], a[208:215], v9
    v_exp_f32 v110, v22
    v_smfmac_f32_16x16x64_bf16 v[32:35], v[88:91], a[240:247], v9
    v_exp_f32 v111, v23
    v_smfmac_f32_16x16x64_bf16 v[32:35], v[92:95], v[144:151], v9
    v_add_f32 v28, v28, v30
    v_add_f32 v29, v29, v31
    v_smfmac_f32_16x16x64_bf16 v[36:39], v[80:83], v[136:143], v9
    v_exp_f32 v30, v28
    v_smfmac_f32_16x16x64_bf16 v[36:39], v[84:87], a[216:223], v9
    v_exp_f32 v31, v29
    v_smfmac_f32_16x16x64_bf16 v[36:39], v[88:91], a[248:255], v9
    v_cvt_pk_bf16_f32 v66, v108, v109
    v_cvt_pk_bf16_f32 v67, v110, v111
    v_smfmac_f32_16x16x64_bf16 v[36:39], v[92:95], v[152:159], v9
    v_cvt_pk_bf16_f32 v72, v30, v31
    v_add_f32 v32, v32, v34
    v_mfma_f32_16x16x32_bf16 v[76:79], v[68:71], v[64:67], 0
    v_add_f32 v33, v33, v35
    v_cvt_pk_bf16_f32 v24, v32, v33
    v_mfma_f32_16x16x32_bf16 v[80:83], v[40:43], v[64:67], 0
    v_add_f32 v36, v36, v38
    v_add_f32 v37, v37, v39
    v_mfma_f32_16x16x16_bf16 v[76:79], v[68:69], v[72:73], v[76:79]
    v_cvt_pk_bf16_f32 v26, v36, v37
    ds_read_b128 v[48:51], v1 offset:24576
    v_mfma_f32_16x16x32_bf16 v[84:87], v[44:47], v[64:67], 0
    ds_read_b128 v[52:55], v1 offset:24576
    ds_read_b128 v[56:59], v1 offset:24576
    v_mfma_f32_16x16x16_bf16 v[80:83], v[24:25], v[72:73], v[80:83]
    ds_read_b128 v[60:63], v1 offset:24576
    s_nop 0
    v_mfma_f32_16x16x16_bf16 v[84:87], v[26:27], v[72:73], v[84:87]
    v_rcp_f32 v14, v76
    v_subrev_u32 v13, 0x2b800000, v76
L_sfr_f:
    s_nop 2
    v_pk_mul_f32 v[80:81], v[80:81], v[14:15] op_sel_hi:[1,0]
    v_pk_mul_f32 v[82:83], v[82:83], v[14:15] op_sel_hi:[1,0]
    s_nop 0
    v_pk_mul_f32 v[84:85], v[84:85], v[14:15] op_sel_hi:[1,0]
    v_cvt_pk_bf16_f32 v64, v80, v84
    v_cvt_pk_bf16_f32 v65, v81, v85
    v_pk_mul_f32 v[86:87], v[86:87], v[14:15] op_sel_hi:[1,0]
    v_cvt_pk_bf16_f32 v66, v82, v86
    v_cvt_pk_bf16_f32 v67, v83, v87
    ds_write_b128 v4, v[64:67]
    s_waitcnt lgkmcnt(1)
    v_smfmac_f32_16x16x64_bf16 v[48:51], v[64:67], v[160:167], v9
    v_smfmac_f32_16x16x64_bf16 v[52:55], v[64:67], v[168:175], v9
    v_cmp_lt_u32 vcc, 0x28000000, v13
    s_cbranch_vccnz L_sfb_f
    v_smfmac_f32_16x16x64_bf16 v[56:59], v[64:67], v[176:183], v9
    buffer_load_dwordx4 v[40:43], v1, s[8:11], s61 offen offset:0 sc1
    v_smfmac_f32_16x16x64_bf16 v[60:63], v[64:67], v[184:191], v9
    s_waitcnt lgkmcnt(0)
    s_barrier
    ds_read_b128 v[68:71], v5 offset:0
    ds_read_b128 v[72:75], v6 offset:0
    ds_read_b128 v[76:79], v7 offset:0
    ds_read_b128 v[112:115], v0 offset:28672
    ds_read_b128 v[116:119], v0 offset:29696
    ds_read_b128 v[120:123], v0 offset:30720
    ds_read_b128 v[124:127], v0 offset:31744
    buffer_load_dwordx4 v[44:47], v1, s[8:11], s61 offen offset:1024 sc1
    s_waitcnt lgkmcnt(6)
    v_smfmac_f32_16x16x64_bf16 v[48:51], v[68:71], v[192:199], v9
    s_waitcnt lgkmcnt(4)
    ds_read_b128 v[96:99], v0 offset:24576
    v_smfmac_f32_16x16x64_bf16 v[48:51], v[72:75], v[216:223], v9
    ds_read_b128 v[100:103], v0 offset:25600
    v_smfmac_f32_16x16x64_bf16 v[48:51], v[76:79], v[240:247], v9
    ds_read_b128 v[104:107], v0 offset:26624
    v_smfmac_f32_16x16x64_bf16 v[52:55], v[68:71], v[200:207], v9
    ds_read_b128 v[108:111], v0 offset:27648
    v_smfmac_f32_16x16x64_bf16 v[52:55], v[72:75], v[224:231], v9
    v_cvt_pk_bf16_f32 v48, v48, v50
    v_smfmac_f32_16x16x64_bf16 v[52:55], v[76:79], v[248:255], v9
    v_cvt_pk_bf16_f32 v49, v49, v51
    v_smfmac_f32_16x16x64_bf16 v[56:59], v[68:71], v[208:215], v9
    v_and_or_b32 v48, v48, -2, s45
    v_smfmac_f32_16x16x64_bf16 v[56:59], v[72:75], v[232:239], v9
    v_cvt_pk_bf16_f32 v50, v52, v54
    s_waitcnt lgkmcnt(0)
    v_smfmac_f32_16x16x64_bf16 v[56:59], v[76:79], v[112:119], v9
    v_cvt_pk_bf16_f32 v51, v53, v55
    v_smfmac_f32_16x16x64_bf16 v[60:63], v[68:71], v[120:127], v9
    buffer_store_dwordx4 v[48:51], v8, s[8:11], s46 offen
    v_mov_b32 v52, v25
    v_smfmac_f32_16x16x64_bf16 v[60:63], v[72:75], v[96:103], v9
    v_cvt_pk_bf16_f32 v56, v56, v58
    v_smfmac_f32_16x16x64_bf16 v[60:63], v[76:79], v[104:111], v9
    s_cmp_lt_u32 s41, 2
    v_cvt_pk_bf16_f32 v57, v57, v59
    v_and_or_b32 v56, v56, -2, s45
    v_mov_b32 v53, v27
    v_mov_b32 v54, v24
    v_mov_b32 v55, v26
    s_nop 1
    v_cvt_pk_bf16_f32 v58, v60, v62
    v_cvt_pk_bf16_f32 v59, v61, v63
    buffer_store_dwordx4 v[56:59], v8, s[8:11], s47 offen
    s_cbranch_scc1 L_rs_e_f
    ds_read_b128 v[64:67], v1 offset:26624
    ds_read_b128 v[80:83], v0 offset:2048
    ds_read_b128 v[84:87], v0 offset:3072
    s_waitcnt lgkmcnt(0)
    ds_read_b128 v[88:91], v0 offset:4096
    ds_read_b128 v[92:95], v0 offset:5120
    ds_read_b128 v[112:115], v0 offset:12288
    s_waitcnt lgkmcnt(0)
    ds_read_b128 v[116:119], v0 offset:13312
    ds_read_b128 v[120:123], v0 offset:14336
    ds_read_b128 v[124:127], v0 offset:15360
    s_waitcnt lgkmcnt(0)
    s_add_u32 s42, s42, 1
    s_add_u32 s61, s61, 524288
    s_add_u32 s49, s49, 524288
    s_add_u32 s57, s57, 524288
    s_add_u32 s63, s63, 131072
    s_xor_b32 m0, m0, 0x2000
    v_xor_b32 v11, 0x2000, v11
    s_mov_b32 s50, 1
    s_mov_b32 s56, 0
    s_cmp_lt_u32 s42, 62
    s_cselect_b32 s54, 2048, 0
    buffer_load_dwordx4 v[16:19], v1, s[8:11], s48 offen offset:0 sc1
    buffer_load_dwordx4 v[20:23], v1, s[8:11], s48 offen offset:1024 sc1
    ds_read_b128 v[96:99], v0 offset:8192
    ds_read_b128 v[100:103], v0 offset:9216
    ds_read_b128 v[104:107], v0 offset:10240
    s_waitcnt lgkmcnt(0)
    buffer_load_dwordx4 v[32:35], v1, s[8:11], s48 offen offset:0 sc1
    buffer_load_dwordx4 v[36:39], v1, s[8:11], s48 offen offset:1024 sc1
    ds_read_b128 v[108:111], v0 offset:11264
L_rs_j_f:
    s_waitcnt lgkmcnt(0)
L_rs_a_f:
    s_waitcnt vmcnt(3)
    v_mfma_f32_16x16x32_bf16 v[28:31], v[64:67], v[16:19], 0
    s_waitcnt vmcnt(2)
    v_mfma_f32_16x16x32_bf16 v[28:31], v[64:67], v[20:23], v[28:31]
    v_bitop3_b32 v13, v16, v20, s45 bitop3:0x7e
    v_and_b32 v13, 1, v13
    v_cmp_ne_u32 vcc, 0, v13
    s_cbranch_vccnz L_rs_b_f
L_rs_ok_f:
    s_nop 3
    v_add_f32_dpp v28, v28, v28 row_ror:4 row_mask:0xf bank_mask:0xf
    v_add_f32_dpp v29, v29, v29 row_ror:4 row_mask:0xf bank_mask:0xf
    s_nop 0
    v_add_f32_dpp v28, v28, v28 row_ror:8 row_mask:0xf bank_mask:0xf
    v_add_f32_dpp v29, v29, v29 row_ror:8 row_mask:0xf bank_mask:0xf
    v_cvt_pk_bf16_f32 v28, v28, v29
    v_and_or_b32 v28, v28, -2, s45
    buffer_store_dword v28, v10, s[8:11], s51 offen
    s_barrier
    v_cmp_eq_u32 vcc, 0, v12
    s_cbranch_vccnz L_fl_f
L_fl_ok_f:
    s_add_u32 s62, s62, s54
    v_mov_b64 v[24:25], 0
    v_mov_b64 v[26:27], 0
    v_mov_b64 v[28:29], 0
    v_mov_b64 v[30:31], 0
    ds_read_b128 v[72:75], v0 offset:0
    s_waitcnt lgkmcnt(0)
    buffer_load_dwordx4 v[64:67], v1, s[8:11], s52 offen offset:0 sc1
    s_waitcnt vmcnt(2)
    v_mov_b64 v[16:17], 0
    v_mov_b64 v[18:19], 0
    v_mov_b64 v[20:21], 0
    v_mov_b64 v[22:23], 0
    v_mov_b64 v[36:37], 0
    v_mov_b64 v[38:39], 0
    buffer_load_dwordx4 v[32:35], v1, s[8:11], s52 offen offset:0 sc1
    ds_read_b128 v[76:79], v0 offset:1024
    ds_read_b128 v[56:59], v0 offset:6144
    s_waitcnt lgkmcnt(0)
    buffer_load_dwordx4 v[68:71], v1, s[8:11], s52 offen offset:1024 sc1
    ds_read_b128 v[60:63], v0 offset:7168
    s_waitcnt lgkmcnt(0)
    buffer_load_dwordx4 v[48:51], v1, s[8:11], s52 offen offset:1024 sc1
    s_cmp_lt_u32 s42, 63
    s_cbranch_scc1 L_step_f
    s_branch L_ch_last
L_rs_e_f:
    ds_read_b128 v[64:67], v1 offset:26624
    ds_read_b128 v[80:83], v0 offset:2048
    ds_read_b128 v[84:87], v0 offset:3072
    s_waitcnt lgkmcnt(0)
    ds_read_b128 v[88:91], v0 offset:4096
    ds_read_b128 v[92:95], v0 offset:5120
    ds_read_b128 v[112:115], v0 offset:12288
    s_waitcnt lgkmcnt(0)
    s_add_u32 s42, s42, 1
    s_add_u32 s61, s61, 524288
    s_add_u32 s49, s49, 524288
    s_add_u32 s57, s57, 524288
    s_add_u32 s63, s63, 131072
    s_xor_b32 m0, m0, 0x2000
    v_xor_b32 v11, 0x2000, v11
    s_mov_b32 s50, 1
    s_mov_b32 s56, 0
    s_cmp_lt_u32 s42, 62
    s_cselect_b32 s54, 2048, 0
    buffer_load_dwordx4 v[16:19], v1, s[8:11], s48 offen offset:0 sc1
    buffer_load_dwordx4 v[20:23], v1, s[8:11], s48 offen offset:1024 sc1
    ds_read_b128 v[116:119], v0 offset:13312
    ds_read_b128 v[120:123], v0 offset:14336
    ds_read_b128 v[124:127], v0 offset:15360
    s_waitcnt lgkmcnt(0)
    buffer_load_dwordx4 v[32:35], v1, s[8:11], s48 offen offset:0 sc1
    buffer_load_dwordx4 v[36:39], v1, s[8:11], s48 offen offset:1024 sc1
    ds_read_b128 v[96:99], v0 offset:8192
    ds_read_b128 v[100:103], v0 offset:9216
    ds_read_b128 v[104:107], v0 offset:10240
    ds_read_b128 v[108:111], v0 offset:11264
    s_branch L_rs_j_f
L_rs_b_f:
    s_mov_b64 exec, vcc
    buffer_load_dwordx4 v[16:19], v1, s[8:11], s48 offen offset:0 sc1
    buffer_load_dwordx4 v[20:23], v1, s[8:11], s48 offen offset:1024 sc1
    s_mov_b64 exec, -1
    s_add_u32 s56, s56, 1
    s_cmp_gt_u32 s56, 400000
    s_cbranch_scc1 L_end
    s_waitcnt vmcnt(3)
    v_mfma_f32_16x16x32_bf16 v[28:31], v[64:67], v[32:35], 0
    s_waitcnt vmcnt(2)
    v_mfma_f32_16x16x32_bf16 v[28:31], v[64:67], v[36:39], v[28:31]
    v_bitop3_b32 v13, v32, v36, s45 bitop3:0x7e
    v_and_b32 v13, 1, v13
    v_cmp_ne_u32 vcc, 0, v13
    s_cbranch_vccz L_rs_ok_f
    s_mov_b64 exec, vcc
    buffer_load_dwordx4 v[32:35], v1, s[8:11], s48 offen offset:0 sc1
    buffer_load_dwordx4 v[36:39], v1, s[8:11], s48 offen offset:1024 sc1
    s_mov_b64 exec, -1
    s_add_u32 s56, s56, 1
    s_cmp_gt_u32 s56, 400000
    s_cbranch_scc1 L_end
    s_branch L_rs_a_f
L_e_fail_f:
    v_mov_b64 v[16:17], 0
    v_mov_b64 v[18:19], 0
    v_mov_b64 v[20:21], 0
    v_mov_b64 v[22:23], 0
    v_mov_b64 v[24:25], 0
    v_mov_b64 v[26:27], 0
    v_mov_b64 v[28:29], 0
    v_mov_b64 v[30:31], 0
    s_waitcnt vmcnt(2)
    v_bitop3_b32 v13, v32, v33, s45 bitop3:0x7e
    v_bitop3_b32 v14, v34, v35, s45 bitop3:0x7e
    v_bitop3_b32 v13, v13, v14, 1 bitop3:0xa8
    v_cmp_ne_u32 vcc, 0, v13
    v_mov_b64 v[64:65], v[32:33]
    v_mov_b64 v[66:67], v[34:35]
    s_nop 0
    s_cbranch_vccz L_st2_f
    s_mov_b64 exec, vcc
    buffer_load_dwordx4 v[64:67], v1, s[8:11], s52 offen offset:0 sc1
    s_add_u32 s56, s56, 1
    s_cmp_gt_u32 s56, 400000
    s_cbranch_scc1 L_end
    buffer_load_dwordx4 v[32:35], v1, s[8:11], s52 offen offset:0 sc1
    s_mov_b64 exec, -1
    buffer_load_dwordx4 v[68:71], v1, s[8:11], s52 offen offset:1024 sc1
    buffer_load_dwordx4 v[48:51], v1, s[8:11], s52 offen offset:1024 sc1
    s_branch L_step_f
L_l_fail_f:
    s_mov_b64 exec, vcc
    buffer_load_dwordx4 v[68:71], v1, s[8:11], s52 offen offset:1024 sc1
    s_mov_b64 exec, -1
    s_add_u32 s56, s56, 1
    s_cmp_gt_u32 s56, 400000
    s_cbranch_scc1 L_end
    s_waitcnt vmcnt(1)
    v_bitop3_b32 v13, v48, v49, s45 bitop3:0x7e
    v_bitop3_b32 v14, v50, v51, s45 bitop3:0x7e
    v_bitop3_b32 v13, v13, v14, 1 bitop3:0xa8
    v_cmp_ne_u32 vcc, 0, v13
    s_cbranch_vccnz L_l_fail2_f
    v_mov_b64 v[68:69], v[48:49]
    v_mov_b64 v[70:71], v[50:51]
    s_nop 1
    s_branch L_l_ok_f
L_l_fail2_f:
    s_mov_b64 exec, vcc
    buffer_load_dwordx4 v[48:51], v1, s[8:11], s52 offen offset:1024 sc1
    s_mov_b64 exec, -1
    s_branch L_l_chk_f
L_sfb_f:
    v_max3_f32 v14, v16, v17, v18
    v_max3_f32 v14, v14, v19, v20
    v_max3_f32 v14, v14, v21, v22
    v_max3_f32 v14, v14, v23, v28
    v_max_f32 v14, v14, v29
    v_mov_b32 v13, v14
    s_nop 1
    v_permlane16_swap_b32 v14, v13
    v_max_f32 v14, v14, v13
    v_mov_b32 v13, v14
    s_nop 1
    v_permlane32_swap_b32 v14, v13
    v_max_f32 v14, v14, v13
    v_sub_f32 v16, v16, v14
    v_exp_f32 v16, v16
    v_sub_f32 v17, v17, v14
    v_exp_f32 v17, v17
    v_sub_f32 v18, v18, v14
    v_exp_f32 v18, v18
    v_sub_f32 v19, v19, v14
    v_exp_f32 v19, v19
    v_sub_f32 v20, v20, v14
    v_exp_f32 v20, v20
    v_sub_f32 v21, v21, v14
    v_exp_f32 v21, v21
    v_sub_f32 v22, v22, v14
    v_exp_f32 v22, v22
    v_sub_f32 v23, v23, v14
    v_exp_f32 v23, v23
    v_sub_f32 v28, v28, v14
    v_exp_f32 v28, v28
    v_sub_f32 v29, v29, v14
    v_exp_f32 v29, v29
    v_cvt_pk_bf16_f32 v64, v16, v17
    v_cvt_pk_bf16_f32 v65, v18, v19
    v_cvt_pk_bf16_f32 v66, v20, v21
    v_cvt_pk_bf16_f32 v67, v22, v23
    v_cvt_pk_bf16_f32 v72, v28, v29
    s_nop 0
    v_mfma_f32_16x16x32_bf16 v[76:79], v[68:71], v[64:67], 0
    v_mfma_f32_16x16x32_bf16 v[80:83], v[40:43], v[64:67], 0
    s_nop 1
    v_mfma_f32_16x16x16_bf16 v[76:79], v[68:69], v[72:73], v[76:79]
    v_mfma_f32_16x16x32_bf16 v[84:87], v[44:47], v[64:67], 0
    v_mfma_f32_16x16x16_bf16 v[80:83], v[24:25], v[72:73], v[80:83]
    s_nop 1
    v_mfma_f32_16x16x16_bf16 v[84:87], v[26:27], v[72:73], v[84:87]
    v_mov_b32 v13, 0
    v_mov_b64 v[48:49], 0
    v_mov_b64 v[50:51], 0
    v_mov_b64 v[52:53], 0
    v_mov_b64 v[54:55], 0
    s_nop 7
    v_rcp_f32 v14, v76
    s_branch L_sfr_f
L_fl_f:
    buffer_load_dword v12, off, s[8:11], s62 sc1
    s_add_u32 s56, s56, 1
    s_cmp_gt_u32 s56, 400000
    s_cbranch_scc1 L_end
    s_waitcnt vmcnt(0)
    v_cmp_eq_u32 vcc, 0, v12
    s_cbranch_vccnz L_fl_f
    s_branch L_fl_ok_f
    s_branch L_step_s
.p2align 7
    s_endpgm
L_step_s:
    s_waitcnt vmcnt(3) lgkmcnt(0)
L_st2_s:
    v_smfmac_f32_16x16x64_bf16 v[16:19], v[64:67], v[72:79], v9
    ds_write_b128 v4, v[64:67]
    v_bitop3_b32 v13, v64, v65, s45 bitop3:0x7e
    v_smfmac_f32_16x16x64_bf16 v[20:23], v[64:67], v[80:87], v9
    v_bitop3_b32 v14, v66, v67, s45 bitop3:0x7e
    v_smfmac_f32_16x16x64_bf16 v[24:27], v[64:67], v[88:95], v9
    v_bitop3_b32 v13, v13, v14, s50 bitop3:0xa8
    v_smfmac_f32_16x16x64_bf16 v[28:31], v[64:67], v[56:63], v9
    v_cmp_ne_u32 vcc, 0, v13
    s_cbranch_vccnz L_e_fail_s
L_l_chk_s:
    s_waitcnt vmcnt(1)
    v_bitop3_b32 v13, v68, v69, s45 bitop3:0x7e
    v_bitop3_b32 v14, v70, v71, s45 bitop3:0x7e
    v_bitop3_b32 v13, v13, v14, s50 bitop3:0xa8
    v_cmp_ne_u32 vcc, 0, v13
    s_cbranch_vccnz L_l_fail_s
L_l_ok_s:
    v_smfmac_f32_16x16x64_bf16 v[16:19], v[68:71], v[112:119], v9
    s_waitcnt lgkmcnt(0)
    s_barrier
    ds_read_b128 v[72:75], v5 offset:0
    buffer_store_dwordx4 v[52:55], v1, s[8:11], s63 offen sc1
    v_lshlrev_b32 v13, 1, v1
    v_smfmac_f32_16x16x64_bf16 v[20:23], v[68:71], v[120:127], v9
    ds_read_b128 v[76:79], v6 offset:0
    ds_write_b128 v4, v[68:71] offset:4096
    v_smfmac_f32_16x16x64_bf16 v[24:27], v[68:71], v[96:103], v9
    buffer_load_dword v12, v13, s[8:11], s49 offen sc1
    ds_read_b128 v[80:83], v7 offset:0
    v_smfmac_f32_16x16x64_bf16 v[28:31], v[68:71], v[104:111], v9
    buffer_load_dword v12, off, s[8:11], s62 sc1
    s_waitcnt lgkmcnt(3)
    v_smfmac_f32_16x16x64_bf16 v[16:19], v[72:75], a[0:7], v9
    s_xor_b32 s45, s45, 1
    v_mov_b64 v[32:33], 0
    v_smfmac_f32_16x16x64_bf16 v[20:23], v[72:75], a[8:15], v9
    buffer_load_dwordx4 v1, s[8:11], s57 offen offset:0 sc1 lds
    s_waitcnt lgkmcnt(2)
    v_smfmac_f32_16x16x64_bf16 v[16:19], v[76:79], a[32:39], v9
    s_waitcnt lgkmcnt(0)
    s_barrier
    ds_read_b128 v[84:87], v5 offset:4096
    v_smfmac_f32_16x16x64_bf16 v[20:23], v[76:79], a[40:47], v9
    ds_read_b128 v[88:91], v6 offset:4096
    v_smfmac_f32_16x16x64_bf16 v[16:19], v[80:83], a[64:71], v9
    ds_read_b128 v[92:95], v7 offset:4096
    v_smfmac_f32_16x16x64_bf16 v[20:23], v[80:83], a[72:79], v9
    buffer_load_dwordx4 v1, s[8:11], s57 offen offset:1024 sc1 lds
    v_mov_b64 v[34:35], 0
    v_smfmac_f32_16x16x64_bf16 v[24:27], v[72:75], a[96:103], v9
    ds_read_b128 v[96:99], v0 offset:16384
    v_smfmac_f32_16x16x64_bf16 v[24:27], v[76:79], a[120:127], v9
    ds_read_b128 v[100:103], v0 offset:17408
    s_waitcnt lgkmcnt(2)
    v_smfmac_f32_16x16x64_bf16 v[16:19], v[84:87], a[16:23], v9
    ds_read_b128 v[104:107], v0 offset:18432
    v_smfmac_f32_16x16x64_bf16 v[16:19], v[88:91], a[48:55], v9
    ds_read_b128 v[108:111], v0 offset:19456
    v_smfmac_f32_16x16x64_bf16 v[16:19], v[92:95], a[80:87], v9
    ds_read_b128 v[112:115], v0 offset:20480
    v_smfmac_f32_16x16x64_bf16 v[20:23], v[84:87], a[24:31], v9
    ds_read_b128 v[116:119], v0 offset:21504
    v_smfmac_f32_16x16x64_bf16 v[20:23], v[88:91], a[56:63], v9
    ds_read_b128 v[120:123], v0 offset:22528
    v_add_f32 v16, v16, v18
    v_smfmac_f32_16x16x64_bf16 v[20:23], v[92:95], a[88:95], v9
    ds_read_b128 v[124:127], v0 offset:23552
    v_add_f32 v17, v17, v19
    v_smfmac_f32_16x16x64_bf16 v[24:27], v[80:83], a[152:159], v9
    s_waitcnt lgkmcnt(4)
    v_smfmac_f32_16x16x64_bf16 v[24:27], v[84:87], v[96:103], v9
    v_add_f32 v20, v20, v22
    v_add_f32 v21, v21, v23
    v_smfmac_f32_16x16x64_bf16 v[24:27], v[88:91], a[136:143], v9
    v_cvt_pk_bf16_f32 v16, v16, v20
    v_cvt_pk_bf16_f32 v17, v17, v21
    v_smfmac_f32_16x16x64_bf16 v[24:27], v[92:95], v[104:111], v9
    ds_write2_b32 v2, v16, v17 offset0:0 offset1:68
    v_smfmac_f32_16x16x64_bf16 v[28:31], v[72:75], a[104:111], v9
    ds_read_b128 v[96:99], v11 offset:0
    v_smfmac_f32_16x16x64_bf16 v[28:31], v[76:79], a[128:135], v9
    ds_read_b128 v[100:103], v11 offset:2048
    v_add_f32 v24, v24, v26
    v_smfmac_f32_16x16x64_bf16 v[28:31], v[80:83], a[160:167], v9
    ds_read_b128 v[104:107], v11 offset:4096
    v_add_f32 v25, v25, v27
    v_smfmac_f32_16x16x64_bf16 v[28:31], v[84:87], a[112:119], v9
    ds_read_b128 v[108:111], v11 offset:6144
    v_add_u32_sdwa v13, v3, v9 dst_sel:DWORD dst_unused:UNUSED_PAD src0_sel:DWORD src1_sel:WORD_1
    v_smfmac_f32_16x16x64_bf16 v[28:31], v[88:91], a[144:151], v9
    s_waitcnt lgkmcnt(4) vmcnt(5)
    s_barrier
    ds_read_b128 v[48:51], v3 offset:7168
    v_smfmac_f32_16x16x64_bf16 v[28:31], v[92:95], a[168:175], v9
    ds_read_b128 v[52:55], v3 offset:7232
    v_smfmac_f32_16x16x64_bf16 v[32:35], v[64:67], a[176:183], v9
    ds_read_b128 v[56:59], v3 offset:7296
    v_smfmac_f32_16x16x64_bf16 v[36:39], v[64:67], a[184:191], v9
    ds_read_b128 v[60:63], v3 offset:7360
    v_add_f32 v28, v28, v30
    v_add_f32 v29, v29, v31
    v_smfmac_f32_16x16x64_bf16 v[32:35], v[68:71], v[112:119], v9
    v_cvt_pk_bf16_f32 v27, v25, v29
    v_cvt_pk_bf16_f32 v25, v24, v28
    v_smfmac_f32_16x16x64_bf16 v[36:39], v[68:71], v[120:127], v9
    ds_write2_b32 v15, v25, v27 offset0:0 offset1:68
    v_smfmac_f32_16x16x64_bf16 v[32:35], v[72:75], a[192:199], v9
    ds_read_b128 v[112:115], v11 offset:1024
    v_smfmac_f32_16x16x64_bf16 v[36:39], v[72:75], a[200:207], v9
    ds_read_b128 v[116:119], v11 offset:3072
    s_waitcnt lgkmcnt(3)
    v_mfma_f32_16x16x32_bf16 v[16:19], v[96:99], v[48:51], 0
    ds_read_b128 v[120:123], v11 offset:5120
    v_mov_b64 v[28:29], 0
    v_mfma_f32_16x16x32_bf16 v[16:19], v[100:103], v[52:55], v[16:19]
    ds_read_b128 v[124:127], v11 offset:7168
    v_mov_b64 v[30:31], 0
    v_mfma_f32_16x16x32_bf16 v[16:19], v[104:107], v[56:59], v[16:19]
    s_waitcnt lgkmcnt(4)
    s_barrier
    ds_read_b128 v[96:99], v13 offset:0
    v_mfma_f32_16x16x32_bf16 v[16:19], v[108:111], v[60:63], v[16:19]
    ds_read_b128 v[100:103], v13 offset:64
    v_mov_b32 v73, 0
    v_smfmac_f32_16x16x64_bf16 v[32:35], v[76:79], a[224:231], v9
    ds_read_b128 v[68:71], v1 offset:25600
    v_smfmac_f32_16x16x64_bf16 v[36:39], v[76:79], a[232:239], v9
    s_waitcnt lgkmcnt(3)
    v_exp_f32 v104, v16
    v_mfma_f32_16x16x32_bf16 v[20:23], v[112:115], v[48:51], 0
    v_exp_f32 v105, v17
    v_mfma_f32_16x16x32_bf16 v[20:23], v[116:119], v[52:55], v[20:23]
    v_exp_f32 v106, v18
    v_mfma_f32_16x16x32_bf16 v[20:23], v[120:123], v[56:59], v[20:23]
    v_exp_f32 v107, v19
    v_mfma_f32_16x16x32_bf16 v[20:23], v[124:127], v[60:63], v[20:23]
    s_waitcnt lgkmcnt(0)
    v_cvt_pk_bf16_f32 v64, v104, v105
    v_smfmac_f32_16x16x64_bf16 v[28:31], v[96:99], v[48:55], v9
    v_cvt_pk_bf16_f32 v65, v106, v107
    v_smfmac_f32_16x16x64_bf16 v[28:31], v[100:103], v[56:63], v9
    v_exp_f32 v108, v20
    v_smfmac_f32_16x16x64_bf16 v[32:35], v[80:83], v[128:135], v9
    v_exp_f32 v109, v21
    v_smfmac_f32_16x16x64_bf16 v[32:35], v[84:87], a[208:215], v9
    v_exp_f32 v110, v22
    v_smfmac_f32_16x16x64_bf16 v[32:35], v[88:91], a[240:247], v9
    v_exp_f32 v111, v23
    v_smfmac_f32_16x16x64_bf16 v[32:35], v[92:95], v[144:151], v9
    v_add_f32 v28, v28, v30
    v_add_f32 v29, v29, v31
    v_smfmac_f32_16x16x64_bf16 v[36:39], v[80:83], v[136:143], v9
    v_exp_f32 v30, v28
    v_smfmac_f32_16x16x64_bf16 v[36:39], v[84:87], a[216:223], v9
    v_exp_f32 v31, v29
    v_smfmac_f32_16x16x64_bf16 v[36:39], v[88:91], a[248:255], v9
    v_cvt_pk_bf16_f32 v66, v108, v109
    v_cvt_pk_bf16_f32 v67, v110, v111
    v_smfmac_f32_16x16x64_bf16 v[36:39], v[92:95], v[152:159], v9
    v_cvt_pk_bf16_f32 v72, v30, v31
    v_add_f32 v32, v32, v34
    v_mfma_f32_16x16x32_bf16 v[76:79], v[68:71], v[64:67], 0
    v_add_f32 v33, v33, v35
    v_cvt_pk_bf16_f32 v24, v32, v33
    v_mfma_f32_16x16x32_bf16 v[80:83], v[40:43], v[64:67], 0
    v_add_f32 v36, v36, v38
    v_add_f32 v37, v37, v39
    v_mfma_f32_16x16x16_bf16 v[76:79], v[68:69], v[72:73], v[76:79]
    v_cvt_pk_bf16_f32 v26, v36, v37
    ds_read_b128 v[48:51], v1 offset:24576
    v_mfma_f32_16x16x32_bf16 v[84:87], v[44:47], v[64:67], 0
    ds_read_b128 v[52:55], v1 offset:24576
    ds_read_b128 v[56:59], v1 offset:24576
    v_mfma_f32_16x16x16_bf16 v[80:83], v[24:25], v[72:73], v[80:83]
    ds_read_b128 v[60:63], v1 offset:24576
    s_nop 0
    v_mfma_f32_16x16x16_bf16 v[84:87], v[26:27], v[72:73], v[84:87]
    v_rcp_f32 v14, v76
    v_subrev_u32 v13, 0x2b800000, v76
L_sfr_s:
    s_nop 2
    v_pk_mul_f32 v[80:81], v[80:81], v[14:15] op_sel_hi:[1,0]
    v_pk_mul_f32 v[82:83], v[82:83], v[14:15] op_sel_hi:[1,0]
    s_nop 0
    v_pk_mul_f32 v[84:85], v[84:85], v[14:15] op_sel_hi:[1,0]
    v_cvt_pk_bf16_f32 v64, v80, v84
    v_cvt_pk_bf16_f32 v65, v81, v85
    v_pk_mul_f32 v[86:87], v[86:87], v[14:15] op_sel_hi:[1,0]
    v_cvt_pk_bf16_f32 v66, v82, v86
    v_cvt_pk_bf16_f32 v67, v83, v87
    ds_write_b128 v4, v[64:67]
    s_waitcnt lgkmcnt(1)
    v_smfmac_f32_16x16x64_bf16 v[48:51], v[64:67], v[160:167], v9
    v_smfmac_f32_16x16x64_bf16 v[52:55], v[64:67], v[168:175], v9
    v_cmp_lt_u32 vcc, 0x28000000, v13
    s_cbranch_vccnz L_sfb_s
    v_smfmac_f32_16x16x64_bf16 v[56:59], v[64:67], v[176:183], v9
    buffer_load_dwordx4 v[40:43], v1, s[8:11], s61 offen offset:0 sc1
    v_smfmac_f32_16x16x64_bf16 v[60:63], v[64:67], v[184:191], v9
    s_waitcnt lgkmcnt(0)
    s_barrier
    ds_read_b128 v[68:71], v5 offset:0
    ds_read_b128 v[72:75], v6 offset:0
    ds_read_b128 v[76:79], v7 offset:0
    ds_read_b128 v[112:115], v0 offset:28672
    ds_read_b128 v[116:119], v0 offset:29696
    ds_read_b128 v[120:123], v0 offset:30720
    ds_read_b128 v[124:127], v0 offset:31744
    buffer_load_dwordx4 v[44:47], v1, s[8:11], s61 offen offset:1024 sc1
    s_waitcnt lgkmcnt(6)
    v_smfmac_f32_16x16x64_bf16 v[48:51], v[68:71], v[192:199], v9
    s_waitcnt lgkmcnt(4)
    ds_read_b128 v[96:99], v0 offset:24576
    v_smfmac_f32_16x16x64_bf16 v[48:51], v[72:75], v[216:223], v9
    ds_read_b128 v[100:103], v0 offset:25600
    v_smfmac_f32_16x16x64_bf16 v[48:51], v[76:79], v[240:247], v9
    ds_read_b128 v[104:107], v0 offset:26624
    v_smfmac_f32_16x16x64_bf16 v[52:55], v[68:71], v[200:207], v9
    ds_read_b128 v[108:111], v0 offset:27648
    v_smfmac_f32_16x16x64_bf16 v[52:55], v[72:75], v[224:231], v9
    v_cvt_pk_bf16_f32 v48, v48, v50
    v_smfmac_f32_16x16x64_bf16 v[52:55], v[76:79], v[248:255], v9
    v_cvt_pk_bf16_f32 v49, v49, v51
    v_smfmac_f32_16x16x64_bf16 v[56:59], v[68:71], v[208:215], v9
    v_and_or_b32 v48, v48, -2, s45
    v_smfmac_f32_16x16x64_bf16 v[56:59], v[72:75], v[232:239], v9
    v_cvt_pk_bf16_f32 v50, v52, v54
    s_waitcnt lgkmcnt(0)
    v_smfmac_f32_16x16x64_bf16 v[56:59], v[76:79], v[112:119], v9
    v_cvt_pk_bf16_f32 v51, v53, v55
    v_smfmac_f32_16x16x64_bf16 v[60:63], v[68:71], v[120:127], v9
    buffer_store_dwordx4 v[48:51], v8, s[8:11], s46 offen sc1
    v_mov_b32 v52, v25
    v_smfmac_f32_16x16x64_bf16 v[60:63], v[72:75], v[96:103], v9
    v_cvt_pk_bf16_f32 v56, v56, v58
    v_smfmac_f32_16x16x64_bf16 v[60:63], v[76:79], v[104:111], v9
    s_cmp_lt_u32 s41, 2
    v_cvt_pk_bf16_f32 v57, v57, v59
    v_and_or_b32 v56, v56, -2, s45
    v_mov_b32 v53, v27
    v_mov_b32 v54, v24
    v_mov_b32 v55, v26
    s_nop 1
    v_cvt_pk_bf16_f32 v58, v60, v62
    v_cvt_pk_bf16_f32 v59, v61, v63
    buffer_store_dwordx4 v[56:59], v8, s[8:11], s47 offen sc1
    s_cbranch_scc1 L_rs_e_s
    ds_read_b128 v[64:67], v1 offset:26624
    ds_read_b128 v[80:83], v0 offset:2048
    ds_read_b128 v[84:87], v0 offset:3072
    s_waitcnt lgkmcnt(0)
    ds_read_b128 v[88:91], v0 offset:4096
    ds_read_b128 v[92:95], v0 offset:5120
    ds_read_b128 v[112:115], v0 offset:12288
    s_waitcnt lgkmcnt(0)
    ds_read_b128 v[116:119], v0 offset:13312
    ds_read_b128 v[120:123], v0 offset:14336
    ds_read_b128 v[124:127], v0 offset:15360
    s_waitcnt lgkmcnt(0)
    s_add_u32 s42, s42, 1
    s_add_u32 s61, s61, 524288
    s_add_u32 s49, s49, 524288
    s_add_u32 s57, s57, 524288
    s_add_u32 s63, s63, 131072
    s_xor_b32 m0, m0, 0x2000
    v_xor_b32 v11, 0x2000, v11
    s_mov_b32 s50, 1
    s_mov_b32 s56, 0
    s_cmp_lt_u32 s42, 62
    s_cselect_b32 s54, 2048, 0
    buffer_load_dwordx4 v[16:19], v1, s[8:11], s48 offen offset:0 sc1
    buffer_load_dwordx4 v[20:23], v1, s[8:11], s48 offen offset:1024 sc1
    ds_read_b128 v[96:99], v0 offset:8192
    ds_read_b128 v[100:103], v0 offset:9216
    ds_read_b128 v[104:107], v0 offset:10240
    s_waitcnt lgkmcnt(0)
    buffer_load_dwordx4 v[32:35], v1, s[8:11], s48 offen offset:0 sc1
    buffer_load_dwordx4 v[36:39], v1, s[8:11], s48 offen offset:1024 sc1
    ds_read_b128 v[108:111], v0 offset:11264
L_rs_j_s:
    s_waitcnt lgkmcnt(0)
L_rs_a_s:
    s_waitcnt vmcnt(3)
    v_mfma_f32_16x16x32_bf16 v[28:31], v[64:67], v[16:19], 0
    s_waitcnt vmcnt(2)
    v_mfma_f32_16x16x32_bf16 v[28:31], v[64:67], v[20:23], v[28:31]
    v_bitop3_b32 v13, v16, v20, s45 bitop3:0x7e
    v_and_b32 v13, 1, v13
    v_cmp_ne_u32 vcc, 0, v13
    s_cbranch_vccnz L_rs_b_s
L_rs_ok_s:
    s_nop 3
    v_add_f32_dpp v28, v28, v28 row_ror:4 row_mask:0xf bank_mask:0xf
    v_add_f32_dpp v29, v29, v29 row_ror:4 row_mask:0xf bank_mask:0xf
    s_nop 0
    v_add_f32_dpp v28, v28, v28 row_ror:8 row_mask:0xf bank_mask:0xf
    v_add_f32_dpp v29, v29, v29 row_ror:8 row_mask:0xf bank_mask:0xf
    v_cvt_pk_bf16_f32 v28, v28, v29
    v_and_or_b32 v28, v28, -2, s45
    buffer_store_dword v28, v10, s[8:11], s51 offen sc1
    s_barrier
    v_cmp_eq_u32 vcc, 0, v12
    s_cbranch_vccnz L_fl_s
L_fl_ok_s:
    s_add_u32 s62, s62, s54
    v_mov_b64 v[24:25], 0
    v_mov_b64 v[26:27], 0
    v_mov_b64 v[28:29], 0
    v_mov_b64 v[30:31], 0
    ds_read_b128 v[72:75], v0 offset:0
    s_waitcnt lgkmcnt(0)
    buffer_load_dwordx4 v[64:67], v1, s[8:11], s52 offen offset:0 sc1
    s_waitcnt vmcnt(2)
    v_mov_b64 v[16:17], 0
    v_mov_b64 v[18:19], 0
    v_mov_b64 v[20:21], 0
    v_mov_b64 v[22:23], 0
    v_mov_b64 v[36:37], 0
    v_mov_b64 v[38:39], 0
    buffer_load_dwordx4 v[32:35], v1, s[8:11], s52 offen offset:0 sc1
    ds_read_b128 v[76:79], v0 offset:1024
    ds_read_b128 v[56:59], v0 offset:6144
    s_waitcnt lgkmcnt(0)
    buffer_load_dwordx4 v[68:71], v1, s[8:11], s52 offen offset:1024 sc1
    ds_read_b128 v[60:63], v0 offset:7168
    s_waitcnt lgkmcnt(0)
    buffer_load_dwordx4 v[48:51], v1, s[8:11], s52 offen offset:1024 sc1
    s_cmp_lt_u32 s42, 63
    s_cbranch_scc1 L_step_s
    s_branch L_ch_last
L_rs_e_s:
    ds_read_b128 v[64:67], v1 offset:26624
    ds_read_b128 v[80:83], v0 offset:2048
    ds_read_b128 v[84:87], v0 offset:3072
    s_waitcnt lgkmcnt(0)
    ds_read_b128 v[88:91], v0 offset:4096
    ds_read_b128 v[92:95], v0 offset:5120
    ds_read_b128 v[112:115], v0 offset:12288
    s_waitcnt lgkmcnt(0)
    s_add_u32 s42, s42, 1
    s_add_u32 s61, s61, 524288
    s_add_u32 s49, s49, 524288
    s_add_u32 s57, s57, 524288
    s_add_u32 s63, s63, 131072
    s_xor_b32 m0, m0, 0x2000
    v_xor_b32 v11, 0x2000, v11
    s_mov_b32 s50, 1
    s_mov_b32 s56, 0
    s_cmp_lt_u32 s42, 62
    s_cselect_b32 s54, 2048, 0
    buffer_load_dwordx4 v[16:19], v1, s[8:11], s48 offen offset:0 sc1
    buffer_load_dwordx4 v[20:23], v1, s[8:11], s48 offen offset:1024 sc1
    ds_read_b128 v[116:119], v0 offset:13312
    ds_read_b128 v[120:123], v0 offset:14336
    ds_read_b128 v[124:127], v0 offset:15360
    s_waitcnt lgkmcnt(0)
    buffer_load_dwordx4 v[32:35], v1, s[8:11], s48 offen offset:0 sc1
    buffer_load_dwordx4 v[36:39], v1, s[8:11], s48 offen offset:1024 sc1
    ds_read_b128 v[96:99], v0 offset:8192
    ds_read_b128 v[100:103], v0 offset:9216
    ds_read_b128 v[104:107], v0 offset:10240
    ds_read_b128 v[108:111], v0 offset:11264
    s_branch L_rs_j_s
L_rs_b_s:
    s_mov_b64 exec, vcc
    buffer_load_dwordx4 v[16:19], v1, s[8:11], s48 offen offset:0 sc1
    buffer_load_dwordx4 v[20:23], v1, s[8:11], s48 offen offset:1024 sc1
    s_mov_b64 exec, -1
    s_add_u32 s56, s56, 1
    s_cmp_gt_u32 s56, 400000
    s_cbranch_scc1 L_end
    s_waitcnt vmcnt(3)
    v_mfma_f32_16x16x32_bf16 v[28:31], v[64:67], v[32:35], 0
    s_waitcnt vmcnt(2)
    v_mfma_f32_16x16x32_bf16 v[28:31], v[64:67], v[36:39], v[28:31]
    v_bitop3_b32 v13, v32, v36, s45 bitop3:0x7e
    v_and_b32 v13, 1, v13
    v_cmp_ne_u32 vcc, 0, v13
    s_cbranch_vccz L_rs_ok_s
    s_mov_b64 exec, vcc
    buffer_load_dwordx4 v[32:35], v1, s[8:11], s48 offen offset:0 sc1
    buffer_load_dwordx4 v[36:39], v1, s[8:11], s48 offen offset:1024 sc1
    s_mov_b64 exec, -1
    s_add_u32 s56, s56, 1
    s_cmp_gt_u32 s56, 400000
    s_cbranch_scc1 L_end
    s_branch L_rs_a_s
L_e_fail_s:
    v_mov_b64 v[16:17], 0
    v_mov_b64 v[18:19], 0
    v_mov_b64 v[20:21], 0
    v_mov_b64 v[22:23], 0
    v_mov_b64 v[24:25], 0
    v_mov_b64 v[26:27], 0
    v_mov_b64 v[28:29], 0
    v_mov_b64 v[30:31], 0
    s_waitcnt vmcnt(2)
    v_bitop3_b32 v13, v32, v33, s45 bitop3:0x7e
    v_bitop3_b32 v14, v34, v35, s45 bitop3:0x7e
    v_bitop3_b32 v13, v13, v14, 1 bitop3:0xa8
    v_cmp_ne_u32 vcc, 0, v13
    v_mov_b64 v[64:65], v[32:33]
    v_mov_b64 v[66:67], v[34:35]
    s_nop 0
    s_cbranch_vccz L_st2_s
    s_mov_b64 exec, vcc
    buffer_load_dwordx4 v[64:67], v1, s[8:11], s52 offen offset:0 sc1
    s_add_u32 s56, s56, 1
    s_cmp_gt_u32 s56, 400000
    s_cbranch_scc1 L_end
    buffer_load_dwordx4 v[32:35], v1, s[8:11], s52 offen offset:0 sc1
    s_mov_b64 exec, -1
    buffer_load_dwordx4 v[68:71], v1, s[8:11], s52 offen offset:1024 sc1
    buffer_load_dwordx4 v[48:51], v1, s[8:11], s52 offen offset:1024 sc1
    s_branch L_step_s
L_l_fail_s:
    s_mov_b64 exec, vcc
    buffer_load_dwordx4 v[68:71], v1, s[8:11], s52 offen offset:1024 sc1
    s_mov_b64 exec, -1
    s_add_u32 s56, s56, 1
    s_cmp_gt_u32 s56, 400000
    s_cbranch_scc1 L_end
    s_waitcnt vmcnt(1)
    v_bitop3_b32 v13, v48, v49, s45 bitop3:0x7e
    v_bitop3_b32 v14, v50, v51, s45 bitop3:0x7e
    v_bitop3_b32 v13, v13, v14, 1 bitop3:0xa8
    v_cmp_ne_u32 vcc, 0, v13
    s_cbranch_vccnz L_l_fail2_s
    v_mov_b64 v[68:69], v[48:49]
    v_mov_b64 v[70:71], v[50:51]
    s_nop 1
    s_branch L_l_ok_s
L_l_fail2_s:
    s_mov_b64 exec, vcc
    buffer_load_dwordx4 v[48:51], v1, s[8:11], s52 offen offset:1024 sc1
    s_mov_b64 exec, -1
    s_branch L_l_chk_s
L_sfb_s:
    v_max3_f32 v14, v16, v17, v18
    v_max3_f32 v14, v14, v19, v20
    v_max3_f32 v14, v14, v21, v22
    v_max3_f32 v14, v14, v23, v28
    v_max_f32 v14, v14, v29
    v_mov_b32 v13, v14
    s_nop 1
    v_permlane16_swap_b32 v14, v13
    v_max_f32 v14, v14, v13
    v_mov_b32 v13, v14
    s_nop 1
    v_permlane32_swap_b32 v14, v13
    v_max_f32 v14, v14, v13
    v_sub_f32 v16, v16, v14
    v_exp_f32 v16, v16
    v_sub_f32 v17, v17, v14
    v_exp_f32 v17, v17
    v_sub_f32 v18, v18, v14
    v_exp_f32 v18, v18
    v_sub_f32 v19, v19, v14
    v_exp_f32 v19, v19
    v_sub_f32 v20, v20, v14
    v_exp_f32 v20, v20
    v_sub_f32 v21, v21, v14
    v_exp_f32 v21, v21
    v_sub_f32 v22, v22, v14
    v_exp_f32 v22, v22
    v_sub_f32 v23, v23, v14
    v_exp_f32 v23, v23
    v_sub_f32 v28, v28, v14
    v_exp_f32 v28, v28
    v_sub_f32 v29, v29, v14
    v_exp_f32 v29, v29
    v_cvt_pk_bf16_f32 v64, v16, v17
    v_cvt_pk_bf16_f32 v65, v18, v19
    v_cvt_pk_bf16_f32 v66, v20, v21
    v_cvt_pk_bf16_f32 v67, v22, v23
    v_cvt_pk_bf16_f32 v72, v28, v29
    s_nop 0
    v_mfma_f32_16x16x32_bf16 v[76:79], v[68:71], v[64:67], 0
    v_mfma_f32_16x16x32_bf16 v[80:83], v[40:43], v[64:67], 0
    s_nop 1
    v_mfma_f32_16x16x16_bf16 v[76:79], v[68:69], v[72:73], v[76:79]
    v_mfma_f32_16x16x32_bf16 v[84:87], v[44:47], v[64:67], 0
    v_mfma_f32_16x16x16_bf16 v[80:83], v[24:25], v[72:73], v[80:83]
    s_nop 1
    v_mfma_f32_16x16x16_bf16 v[84:87], v[26:27], v[72:73], v[84:87]
    v_mov_b32 v13, 0
    v_mov_b64 v[48:49], 0
    v_mov_b64 v[50:51], 0
    v_mov_b64 v[52:53], 0
    v_mov_b64 v[54:55], 0
    s_nop 7
    v_rcp_f32 v14, v76
    s_branch L_sfr_s
L_fl_s:
    buffer_load_dword v12, off, s[8:11], s62 sc1
    s_add_u32 s56, s56, 1
    s_cmp_gt_u32 s56, 400000
    s_cbranch_scc1 L_end
    s_waitcnt vmcnt(0)
    v_cmp_eq_u32 vcc, 0, v12
    s_cbranch_vccnz L_fl_s
    s_branch L_fl_ok_s
L_ch_lretry:
    buffer_load_dwordx4 v[64:67], v1, s[8:11], s52 offen sc1
    buffer_load_dwordx4 v[68:71], v1, s[8:11], s52 offen offset:1024 sc1
    s_add_u32 s56, s56, 1
    s_cmp_gt_u32 s56, 400000
    s_cbranch_scc1 L_end
L_ch_last:
    s_waitcnt vmcnt(0)
    v_bitop3_b32 v13, v64, v65, s45 bitop3:0x7e
    v_bitop3_b32 v14, v66, v67, s45 bitop3:0x7e
    v_or_b32 v13, v13, v14
    v_bitop3_b32 v14, v68, v69, s45 bitop3:0x7e
    v_or_b32 v13, v13, v14
    v_bitop3_b32 v14, v70, v71, s45 bitop3:0x7e
    v_bitop3_b32 v13, v13, v14, 1 bitop3:0xa8
    v_cmp_ne_u32 vcc, 0, v13
    s_cbranch_vccnz L_ch_lretry
    ds_write_b128 v4, v[64:67]
    ds_write_b128 v4, v[68:71] offset:4096
    buffer_store_dwordx4 v[52:55], v1, s[8:11], s63 offen sc1
    s_add_u32 s63, s63, 131072
    s_waitcnt lgkmcnt(0)
    s_barrier
    v_mov_b64 v[32:33], 0
    v_mov_b64 v[34:35], 0
    v_mov_b64 v[36:37], 0
    v_mov_b64 v[38:39], 0
    ds_read_b128 v[112:115], v0 offset:20480
    ds_read_b128 v[116:119], v0 offset:21504
    ds_read_b128 v[120:123], v0 offset:22528
    ds_read_b128 v[124:127], v0 offset:23552
    v_smfmac_f32_16x16x64_bf16 v[24:27], v[64:67], v[88:95], v9
    v_smfmac_f32_16x16x64_bf16 v[28:31], v[64:67], v[56:63], v9
    v_smfmac_f32_16x16x64_bf16 v[32:35], v[64:67], a[176:183], v9
    v_smfmac_f32_16x16x64_bf16 v[36:39], v[64:67], a[184:191], v9
    ds_read_b128 v[72:75], v5 offset:0
    ds_read_b128 v[84:87], v5 offset:4096
    ds_read_b128 v[76:79], v6 offset:0
    ds_read_b128 v[88:91], v6 offset:4096
    ds_read_b128 v[80:83], v7 offset:0
    ds_read_b128 v[92:95], v7 offset:4096
    s_waitcnt lgkmcnt(6)
    v_smfmac_f32_16x16x64_bf16 v[24:27], v[68:71], v[96:103], v9
    v_smfmac_f32_16x16x64_bf16 v[28:31], v[68:71], v[104:111], v9
    v_smfmac_f32_16x16x64_bf16 v[32:35], v[68:71], v[112:119], v9
    v_smfmac_f32_16x16x64_bf16 v[36:39], v[68:71], v[120:127], v9
    ds_read_b128 v[96:99], v0 offset:16384
    ds_read_b128 v[100:103], v0 offset:17408
    ds_read_b128 v[104:107], v0 offset:18432
    ds_read_b128 v[108:111], v0 offset:19456
    s_waitcnt lgkmcnt(9)
    v_smfmac_f32_16x16x64_bf16 v[24:27], v[72:75], a[96:103], v9
    v_smfmac_f32_16x16x64_bf16 v[28:31], v[72:75], a[104:111], v9
    v_smfmac_f32_16x16x64_bf16 v[32:35], v[72:75], a[192:199], v9
    v_smfmac_f32_16x16x64_bf16 v[36:39], v[72:75], a[200:207], v9
    s_waitcnt lgkmcnt(0)
    v_smfmac_f32_16x16x64_bf16 v[24:27], v[84:87], v[96:103], v9
    v_smfmac_f32_16x16x64_bf16 v[28:31], v[84:87], a[112:119], v9
    v_smfmac_f32_16x16x64_bf16 v[32:35], v[84:87], a[208:215], v9
    v_smfmac_f32_16x16x64_bf16 v[36:39], v[84:87], a[216:223], v9
    v_smfmac_f32_16x16x64_bf16 v[24:27], v[76:79], a[120:127], v9
    v_smfmac_f32_16x16x64_bf16 v[28:31], v[76:79], a[128:135], v9
    v_smfmac_f32_16x16x64_bf16 v[32:35], v[76:79], a[224:231], v9
    v_smfmac_f32_16x16x64_bf16 v[36:39], v[76:79], a[232:239], v9
    v_smfmac_f32_16x16x64_bf16 v[24:27], v[88:91], a[136:143], v9
    v_smfmac_f32_16x16x64_bf16 v[28:31], v[88:91], a[144:151], v9
    v_smfmac_f32_16x16x64_bf16 v[32:35], v[88:91], a[240:247], v9
    v_smfmac_f32_16x16x64_bf16 v[36:39], v[88:91], a[248:255], v9
    v_smfmac_f32_16x16x64_bf16 v[24:27], v[80:83], a[152:159], v9
    v_smfmac_f32_16x16x64_bf16 v[28:31], v[80:83], a[160:167], v9
    v_smfmac_f32_16x16x64_bf16 v[32:35], v[80:83], v[128:135], v9
    v_smfmac_f32_16x16x64_bf16 v[36:39], v[80:83], v[136:143], v9
    v_smfmac_f32_16x16x64_bf16 v[24:27], v[92:95], v[104:111], v9
    v_smfmac_f32_16x16x64_bf16 v[28:31], v[92:95], a[168:175], v9
    v_smfmac_f32_16x16x64_bf16 v[32:35], v[92:95], v[144:151], v9
    v_smfmac_f32_16x16x64_bf16 v[36:39], v[92:95], v[152:159], v9
    v_pk_add_f32 v[24:25], v[24:25], v[26:27]
    v_pk_add_f32 v[28:29], v[28:29], v[30:31]
    v_cvt_pk_bf16_f32 v24, v24, v28
    v_cvt_pk_bf16_f32 v25, v25, v29
    v_pk_add_f32 v[32:33], v[32:33], v[34:35]
    s_nop 2
    v_pk_add_f32 v[36:37], v[36:37], v[38:39]
    v_cvt_pk_bf16_f32 v26, v32, v33
    v_cvt_pk_bf16_f32 v27, v36, v37
    buffer_store_dwordx4 v[24:27], v1, s[8:11], s63 offen sc1
    s_waitcnt vmcnt(0)
    s_branch L_end
L_end:
    s_endpgm
.section .rodata,"a"
.p2align 6
.amdhsa_kernel parallel_sum__memory_aug_recurrent_mem_tr__geglu_ffn__prompt_kernel
  .amdhsa_next_free_vgpr 512
  .amdhsa_next_free_sgpr 102
  .amdhsa_accum_offset 256
  .amdhsa_group_segment_fixed_size 0
  .amdhsa_kernarg_size 112
  .amdhsa_user_sgpr_count 2
  .amdhsa_user_sgpr_kernarg_segment_ptr 1
  .amdhsa_system_sgpr_workgroup_id_x 1
.end_amdhsa_kernel
```
